```python
import torch

def _softmax(x, axis=-1):
    return torch.softmax(x, dim=axis)

def _gelu(x):
    return torch.nn.functional.gelu(x, approximate='tanh')

def _silu(x):
    return torch.nn.functional.silu(x)

def _sigmoid(x):
    return torch.sigmoid(x)

def _layernorm(x, axis=-1, eps=1e-05):
    m = x.mean(dim=axis, keepdim=True)
    v = x.var(dim=axis, keepdim=True, unbiased=False)
    return (x - m) / torch.sqrt(v + eps)

def _scatter_add(tgt, idx, src, axis=0):
    return tgt.clone().index_add_(axis, idx, src)

def _segment_sum(src, seg, n):
    out = torch.zeros((n,) + src.shape[1:], dtype=src.dtype)
    return out.index_add_(0, seg, src)

def _pad(x, pw):
    flat = tuple((v for pair in reversed(pw) for v in pair))
    return torch.nn.functional.pad(x, flat)
kernel_name = 'adaLN_cond__ssm_conv_s4__mixer_gmlp__prompt'

def setup_inputs():

    _w = lambda a: (lambda t: t.to(torch.bfloat16) if t.is_floating_point() else t)(torch.as_tensor(a))

    def _A_setup():
        B, L, D, N = (1, 2048, 512, 128)
        A_re = -(lambda _x: torch.exp(torch.as_tensor(_x)))((lambda *s: torch.randn(*s, dtype=torch.bfloat16) * 3.2)(D, N))
        A_im = torch.pi * (lambda *s: torch.randn(*s, dtype=torch.bfloat16) * 0.2)(D, N)
        B_re = (lambda *s: torch.randn(*s, dtype=torch.bfloat16) * 0.2)(D, N)
        B_im = (lambda *s: torch.randn(*s, dtype=torch.bfloat16) * 0.2)(D, N)
        C_re = (lambda *s: torch.randn(*s, dtype=torch.bfloat16) * 0.2)(D, N)
        C_im = (lambda *s: torch.randn(*s, dtype=torch.bfloat16) * 0.2)(D, N)
        log_dt = (lambda *s: torch.randn(*s, dtype=torch.bfloat16) * 0.2)(D) * 0.5 - 4.0
        Dskip = (lambda *s: torch.randn(*s, dtype=torch.bfloat16) * 0.2)(D)
        return {'u': _w((lambda *s: torch.randn(*s, dtype=torch.bfloat16) * 0.05)(B, L, D)), 'A_re': _w(A_re), 'A_im': _w(A_im), 'B_re': _w(B_re), 'B_im': _w(B_im), 'C_re': _w(C_re), 'C_im': _w(C_im), 'log_dt': _w(log_dt), 'Dskip': _w(Dskip)}
    _A_in = _A_setup()

    def _B_setup():
        B, S, D, F = (1, 2048, 512, 1792)
        Fh = F // 2
        return {'x': _w((lambda *s: torch.randn(*s, dtype=torch.bfloat16) * 0.05)(B, S, D)), 'w_in': _w((lambda *s: torch.randn(*s, dtype=torch.bfloat16) * 0.2)(D, 2 * Fh)), 'w_sp': _w(0.01 * (lambda *s: torch.randn(*s, dtype=torch.bfloat16) * 0.2)(S, S)), 'b_sp': _w(1.0 + 0.01 * (lambda *s: torch.randn(*s, dtype=torch.bfloat16) * 0.05)(S)), 'w_out': _w((lambda *s: torch.randn(*s, dtype=torch.bfloat16) * 0.05)(Fh, D))}
    _B_in = _B_setup()
    return {'A_u': _A_in['u'], 'A_A_re': _A_in['A_re'], 'A_A_im': _A_in['A_im'], 'A_B_re': _A_in['B_re'], 'A_B_im': _A_in['B_im'], 'A_C_re': _A_in['C_re'], 'A_C_im': _A_in['C_im'], 'A_log_dt': _A_in['log_dt'], 'A_Dskip': _A_in['Dskip'], 'B_x': _B_in['x'], 'B_w_in': _B_in['w_in'], 'B_w_sp': _B_in['w_sp'], 'B_b_sp': _B_in['b_sp'], 'B_w_out': _B_in['w_out'], 'c': _w((lambda *s: torch.randn(*s, dtype=torch.bfloat16) * 0.1)(1, 512) * 8.0), 'w_mod': _w((lambda *s: torch.randn(*s, dtype=torch.bfloat16) * 0.1)(512, 6 * 512) * 512 ** (-0.5) * 8.0)}

def reference(A_u, A_A_re, A_A_im, A_B_re, A_B_im, A_C_re, A_C_im, A_log_dt, A_Dskip, B_x, B_w_in, B_w_sp, B_b_sp, B_w_out, c, w_mod):

    def _A_ref(u, A_re, A_im, B_re, B_im, C_re, C_im, log_dt, Dskip):
        Bsz, L, D = u.shape
        dt = torch.exp(log_dt)[:, None]
        A = A_re + 1j * A_im
        Bc = B_re + 1j * B_im
        Cc = C_re + 1j * C_im
        logdA = dt * A
        dB = dt * Bc
        l = (lambda x, dt: x.to(dt))(torch.arange(L), A_re.dtype)
        P = torch.exp(logdA[:, :, None] * l[None, None, :])
        K = torch.einsum('dn,dnl,dn->dl', Cc, P, dB).real
        L2 = 2 * L
        Kp = _pad(K, ((0, 0), (0, L)))
        up = (lambda x, *d: x.permute(*d))(u, 0, 2, 1)
        up = _pad(up, ((0, 0), (0, 0), (0, L)))
        Kf = (lambda x, axes=(-2, -1): torch.fft.rfft2(x.float(), dim=axes))(Kp[:, None, :], axes=(-2, -1))
        Uf = (lambda x, axes=(-2, -1): torch.fft.rfft2(x.float(), dim=axes))(up[:, :, None, :], axes=(-2, -1))
        Yf = Uf * Kf[None, :, :, :]
        y = (lambda x, s, axes=(-2, -1): torch.fft.irfft2(x, s=s, dim=axes).to(torch.bfloat16))(Yf, (1, L2), axes=(-2, -1))[:, :, 0, :L]
        y = (lambda x, *d: x.permute(*d))(y, 0, 2, 1) + u * Dskip[None, None, :]
        return y

    def _B_ref(x, w_in, w_sp, b_sp, w_out):
        B, S, D = x.shape
        F = w_in.shape[-1]
        Fh = F // 2
        z = _gelu(torch.einsum('bsd,df->bsf', x, w_in))
        z1 = z[..., :Fh].clone()
        z2 = _layernorm(z[..., Fh:], axis=-1)
        g = torch.einsum('ts,bsf->btf', w_sp, z2) + b_sp[None, :, None]
        return torch.einsum('bsf,fd->bsd', z1 * g, w_out)
    x = A_u
    mod = (_silu(c) @ w_mod).reshape(c.shape[0], 6, 1, -1)
    sa, ca, ga, sb, cb, gb = (mod[:, 0].clone(), mod[:, 1].clone(), mod[:, 2].clone(), mod[:, 3].clone(), mod[:, 4].clone(), mod[:, 5].clone())
    h = _layernorm(x, axis=-1) * (1 + ca) + sa
    x = x + ga * _A_ref(h, A_A_re, A_A_im, A_B_re, A_B_im, A_C_re, A_C_im, A_log_dt, A_Dskip)
    h = _layernorm(x, axis=-1) * (1 + cb) + sb
    x = x + gb * _B_ref(h, B_w_in, B_w_sp, B_b_sp, B_w_out)
    return x
```

```asm
; @launch kernel=k1_prep_kernel grid=(813,1,1) block=(256,1,1) lds=37968
; @launch kernel=k2_conv_kernel grid=(256,1,1) block=(1024,1,1) lds=67648
; @launch kernel=k3_mega_kernel grid=(256,1,1) block=(1024,1,1) lds=157696
.amdgcn_target "amdgcn-amd-amdhsa--gfx950"
.text
.globl k1_prep_kernel
.p2align 8
.type k1_prep_kernel,@function
k1_prep_kernel:
  s_cmp_ge_u32 s2, 512
  s_cbranch_scc1 V1_disp
  s_load_dwordx16 s[20:35], s[0:1], 8
  s_load_dwordx2 s[4:5], s[0:1], 144
  s_and_b32 s11, s2, 7
  s_lshl_b32 s11, s11, 6
  s_lshr_b32 s12, s2, 3
  s_add_u32 s11, s11, s12
  v_and_b32 v7, 127, v0
  s_lshl_b32 s15, s11, 8
  v_lshlrev_b32 v5, 1, v7
  v_add_u32 v5, s15, v5
  s_lshl_b32 s15, s11, 1
  v_mov_b32 v6, s15
  s_waitcnt lgkmcnt(0)
  global_load_ushort v8, v5, s[20:21]
  global_load_ushort v9, v5, s[22:23]
  global_load_ushort v10, v5, s[24:25]
  global_load_ushort v11, v5, s[26:27]
  global_load_ushort v12, v5, s[28:29]
  global_load_ushort v13, v5, s[30:31]
  global_load_ushort v14, v6, s[32:33]
  v_lshrrev_b32 v1, 6, v0
  s_nop 0
  v_readfirstlane_b32 s8, v1
  v_and_b32 v1, 63, v0
  v_lshlrev_b32 v2, 4, v1
  v_lshrrev_b32 v3, 4, v1
  v_and_b32 v4, 15, v1
  s_mov_b32 s10, s8
  s_add_u32 s36, s4, 4194304
  s_addc_u32 s37, s5, 0
  s_mov_b32 s38, 4259840
  s_mov_b32 s39, 0x20000
  v_lshlrev_b32 v7, 2, v7
  s_waitcnt vmcnt(0)
  v_lshlrev_b32 v8, 16, v8
  v_lshlrev_b32 v9, 16, v9
  v_lshlrev_b32 v10, 16, v10
  v_lshlrev_b32 v11, 16, v11
  v_lshlrev_b32 v12, 16, v12
  v_lshlrev_b32 v13, 16, v13
  v_lshlrev_b32 v14, 16, v14
  v_mul_f32 v14, 0x3fb8aa3b, v14
  v_exp_f32 v14, v14
  s_nop 0
  v_cvt_pk_bf16_f32 v14, v14, v14
  v_and_b32 v14, 0xffff0000, v14
  v_mul_f32 v16, v14, v8
  v_mul_f32 v17, v14, v9
  v_mul_f32 v16, 0x3fb8aa3b, v16
  v_mul_f32 v17, 0x3e22f983, v17
  s_cmp_ge_u32 s10, 2
  s_cbranch_scc1 V1_U_1
  v_mul_f32 v30, 0x41000000, v16
  v_mul_f32 v31, 0x41000000, v17
  v_exp_f32 v30, v30
  v_fract_f32 v31, v31
  v_cos_f32 v20, v31
  v_sin_f32 v21, v31
  v_mul_f32 v20, v20, v30
  v_mul_f32 v21, v21, v30
  v_pk_mul_f32 v[22:23], v[20:21], v[20:21] op_sel:[0,0] op_sel_hi:[0,1]
  v_pk_fma_f32 v[22:23], v[20:21], v[20:21], v[22:23] op_sel:[1,1,0] op_sel_hi:[1,0,1] neg_lo:[1,0,0]
  v_mov_b32 v24, 1.0
  v_mov_b32 v25, 0
  v_mov_b32 v26, v20
  v_mov_b32 v27, v21
  v_cvt_pk_bf16_f32 v36, v24, v25
  ds_write_b32 v7, v36 offset:16896
  v_cvt_pk_bf16_f32 v37, v26, v27
  ds_write_b32 v7, v37 offset:17424
  v_pk_mul_f32 v[32:33], v[24:25], v[22:23] op_sel:[0,0] op_sel_hi:[0,1]
  v_pk_fma_f32 v[32:33], v[24:25], v[22:23], v[32:33] op_sel:[1,1,0] op_sel_hi:[1,0,1] neg_lo:[1,0,0]
  v_pk_mul_f32 v[34:35], v[26:27], v[22:23] op_sel:[0,0] op_sel_hi:[0,1]
  v_pk_fma_f32 v[34:35], v[26:27], v[22:23], v[34:35] op_sel:[1,1,0] op_sel_hi:[1,0,1] neg_lo:[1,0,0]
  v_cvt_pk_bf16_f32 v38, v32, v33
  ds_write_b32 v7, v38 offset:17952
  v_cvt_pk_bf16_f32 v39, v34, v35
  ds_write_b32 v7, v39 offset:18480
  v_pk_mul_f32 v[24:25], v[32:33], v[22:23] op_sel:[0,0] op_sel_hi:[0,1]
  v_pk_fma_f32 v[24:25], v[32:33], v[22:23], v[24:25] op_sel:[1,1,0] op_sel_hi:[1,0,1] neg_lo:[1,0,0]
  v_pk_mul_f32 v[26:27], v[34:35], v[22:23] op_sel:[0,0] op_sel_hi:[0,1]
  v_pk_fma_f32 v[26:27], v[34:35], v[22:23], v[26:27] op_sel:[1,1,0] op_sel_hi:[1,0,1] neg_lo:[1,0,0]
  v_cvt_pk_bf16_f32 v36, v24, v25
  ds_write_b32 v7, v36 offset:19008
  v_cvt_pk_bf16_f32 v37, v26, v27
  ds_write_b32 v7, v37 offset:19536
  v_pk_mul_f32 v[32:33], v[24:25], v[22:23] op_sel:[0,0] op_sel_hi:[0,1]
  v_pk_fma_f32 v[32:33], v[24:25], v[22:23], v[32:33] op_sel:[1,1,0] op_sel_hi:[1,0,1] neg_lo:[1,0,0]
  v_pk_mul_f32 v[34:35], v[26:27], v[22:23] op_sel:[0,0] op_sel_hi:[0,1]
  v_pk_fma_f32 v[34:35], v[26:27], v[22:23], v[34:35] op_sel:[1,1,0] op_sel_hi:[1,0,1] neg_lo:[1,0,0]
  v_cvt_pk_bf16_f32 v38, v32, v33
  ds_write_b32 v7, v38 offset:20064
  v_cvt_pk_bf16_f32 v39, v34, v35
  ds_write_b32 v7, v39 offset:20592
  v_pk_mul_f32 v[24:25], v[32:33], v[22:23] op_sel:[0,0] op_sel_hi:[0,1]
  v_pk_fma_f32 v[24:25], v[32:33], v[22:23], v[24:25] op_sel:[1,1,0] op_sel_hi:[1,0,1] neg_lo:[1,0,0]
  v_pk_mul_f32 v[26:27], v[34:35], v[22:23] op_sel:[0,0] op_sel_hi:[0,1]
  v_pk_fma_f32 v[26:27], v[34:35], v[22:23], v[26:27] op_sel:[1,1,0] op_sel_hi:[1,0,1] neg_lo:[1,0,0]
  v_cvt_pk_bf16_f32 v36, v24, v25
  ds_write_b32 v7, v36 offset:21120
  v_cvt_pk_bf16_f32 v37, v26, v27
  ds_write_b32 v7, v37 offset:21648
  v_pk_mul_f32 v[32:33], v[24:25], v[22:23] op_sel:[0,0] op_sel_hi:[0,1]
  v_pk_fma_f32 v[32:33], v[24:25], v[22:23], v[32:33] op_sel:[1,1,0] op_sel_hi:[1,0,1] neg_lo:[1,0,0]
  v_pk_mul_f32 v[34:35], v[26:27], v[22:23] op_sel:[0,0] op_sel_hi:[0,1]
  v_pk_fma_f32 v[34:35], v[26:27], v[22:23], v[34:35] op_sel:[1,1,0] op_sel_hi:[1,0,1] neg_lo:[1,0,0]
  v_cvt_pk_bf16_f32 v38, v32, v33
  ds_write_b32 v7, v38 offset:22176
  v_cvt_pk_bf16_f32 v39, v34, v35
  ds_write_b32 v7, v39 offset:22704
  v_pk_mul_f32 v[24:25], v[32:33], v[22:23] op_sel:[0,0] op_sel_hi:[0,1]
  v_pk_fma_f32 v[24:25], v[32:33], v[22:23], v[24:25] op_sel:[1,1,0] op_sel_hi:[1,0,1] neg_lo:[1,0,0]
  v_pk_mul_f32 v[26:27], v[34:35], v[22:23] op_sel:[0,0] op_sel_hi:[0,1]
  v_pk_fma_f32 v[26:27], v[34:35], v[22:23], v[26:27] op_sel:[1,1,0] op_sel_hi:[1,0,1] neg_lo:[1,0,0]
  v_cvt_pk_bf16_f32 v36, v24, v25
  ds_write_b32 v7, v36 offset:23232
  v_cvt_pk_bf16_f32 v37, v26, v27
  ds_write_b32 v7, v37 offset:23760
  v_pk_mul_f32 v[32:33], v[24:25], v[22:23] op_sel:[0,0] op_sel_hi:[0,1]
  v_pk_fma_f32 v[32:33], v[24:25], v[22:23], v[32:33] op_sel:[1,1,0] op_sel_hi:[1,0,1] neg_lo:[1,0,0]
  v_pk_mul_f32 v[34:35], v[26:27], v[22:23] op_sel:[0,0] op_sel_hi:[0,1]
  v_pk_fma_f32 v[34:35], v[26:27], v[22:23], v[34:35] op_sel:[1,1,0] op_sel_hi:[1,0,1] neg_lo:[1,0,0]
  v_cvt_pk_bf16_f32 v38, v32, v33
  ds_write_b32 v7, v38 offset:24288
  v_cvt_pk_bf16_f32 v39, v34, v35
  ds_write_b32 v7, v39 offset:24816
  v_pk_mul_f32 v[24:25], v[32:33], v[22:23] op_sel:[0,0] op_sel_hi:[0,1]
  v_pk_fma_f32 v[24:25], v[32:33], v[22:23], v[24:25] op_sel:[1,1,0] op_sel_hi:[1,0,1] neg_lo:[1,0,0]
  v_pk_mul_f32 v[26:27], v[34:35], v[22:23] op_sel:[0,0] op_sel_hi:[0,1]
  v_pk_fma_f32 v[26:27], v[34:35], v[22:23], v[26:27] op_sel:[1,1,0] op_sel_hi:[1,0,1] neg_lo:[1,0,0]
  v_cvt_pk_bf16_f32 v36, v24, v25
  ds_write_b32 v7, v36 offset:25344
  v_cvt_pk_bf16_f32 v37, v26, v27
  ds_write_b32 v7, v37 offset:25872
  v_pk_mul_f32 v[32:33], v[24:25], v[22:23] op_sel:[0,0] op_sel_hi:[0,1]
  v_pk_fma_f32 v[32:33], v[24:25], v[22:23], v[32:33] op_sel:[1,1,0] op_sel_hi:[1,0,1] neg_lo:[1,0,0]
  v_pk_mul_f32 v[34:35], v[26:27], v[22:23] op_sel:[0,0] op_sel_hi:[0,1]
  v_pk_fma_f32 v[34:35], v[26:27], v[22:23], v[34:35] op_sel:[1,1,0] op_sel_hi:[1,0,1] neg_lo:[1,0,0]
  v_cvt_pk_bf16_f32 v38, v32, v33
  ds_write_b32 v7, v38 offset:26400
  v_cvt_pk_bf16_f32 v39, v34, v35
  ds_write_b32 v7, v39 offset:26928
  v_pk_mul_f32 v[24:25], v[32:33], v[22:23] op_sel:[0,0] op_sel_hi:[0,1]
  v_pk_fma_f32 v[24:25], v[32:33], v[22:23], v[24:25] op_sel:[1,1,0] op_sel_hi:[1,0,1] neg_lo:[1,0,0]
  v_pk_mul_f32 v[26:27], v[34:35], v[22:23] op_sel:[0,0] op_sel_hi:[0,1]
  v_pk_fma_f32 v[26:27], v[34:35], v[22:23], v[26:27] op_sel:[1,1,0] op_sel_hi:[1,0,1] neg_lo:[1,0,0]
  v_cvt_pk_bf16_f32 v36, v24, v25
  ds_write_b32 v7, v36 offset:27456
  v_cvt_pk_bf16_f32 v37, v26, v27
  ds_write_b32 v7, v37 offset:27984
  v_pk_mul_f32 v[32:33], v[24:25], v[22:23] op_sel:[0,0] op_sel_hi:[0,1]
  v_pk_fma_f32 v[32:33], v[24:25], v[22:23], v[32:33] op_sel:[1,1,0] op_sel_hi:[1,0,1] neg_lo:[1,0,0]
  v_pk_mul_f32 v[34:35], v[26:27], v[22:23] op_sel:[0,0] op_sel_hi:[0,1]
  v_pk_fma_f32 v[34:35], v[26:27], v[22:23], v[34:35] op_sel:[1,1,0] op_sel_hi:[1,0,1] neg_lo:[1,0,0]
  v_cvt_pk_bf16_f32 v38, v32, v33
  ds_write_b32 v7, v38 offset:28512
  v_cvt_pk_bf16_f32 v39, v34, v35
  ds_write_b32 v7, v39 offset:29040
  v_pk_mul_f32 v[24:25], v[32:33], v[22:23] op_sel:[0,0] op_sel_hi:[0,1]
  v_pk_fma_f32 v[24:25], v[32:33], v[22:23], v[24:25] op_sel:[1,1,0] op_sel_hi:[1,0,1] neg_lo:[1,0,0]
  v_pk_mul_f32 v[26:27], v[34:35], v[22:23] op_sel:[0,0] op_sel_hi:[0,1]
  v_pk_fma_f32 v[26:27], v[34:35], v[22:23], v[26:27] op_sel:[1,1,0] op_sel_hi:[1,0,1] neg_lo:[1,0,0]
  v_cvt_pk_bf16_f32 v36, v24, v25
  ds_write_b32 v7, v36 offset:29568
  v_cvt_pk_bf16_f32 v37, v26, v27
  ds_write_b32 v7, v37 offset:30096
  v_pk_mul_f32 v[32:33], v[24:25], v[22:23] op_sel:[0,0] op_sel_hi:[0,1]
  v_pk_fma_f32 v[32:33], v[24:25], v[22:23], v[32:33] op_sel:[1,1,0] op_sel_hi:[1,0,1] neg_lo:[1,0,0]
  v_pk_mul_f32 v[34:35], v[26:27], v[22:23] op_sel:[0,0] op_sel_hi:[0,1]
  v_pk_fma_f32 v[34:35], v[26:27], v[22:23], v[34:35] op_sel:[1,1,0] op_sel_hi:[1,0,1] neg_lo:[1,0,0]
  v_cvt_pk_bf16_f32 v38, v32, v33
  ds_write_b32 v7, v38 offset:30624
  v_cvt_pk_bf16_f32 v39, v34, v35
  ds_write_b32 v7, v39 offset:31152
  v_pk_mul_f32 v[24:25], v[32:33], v[22:23] op_sel:[0,0] op_sel_hi:[0,1]
  v_pk_fma_f32 v[24:25], v[32:33], v[22:23], v[24:25] op_sel:[1,1,0] op_sel_hi:[1,0,1] neg_lo:[1,0,0]
  v_pk_mul_f32 v[26:27], v[34:35], v[22:23] op_sel:[0,0] op_sel_hi:[0,1]
  v_pk_fma_f32 v[26:27], v[34:35], v[22:23], v[26:27] op_sel:[1,1,0] op_sel_hi:[1,0,1] neg_lo:[1,0,0]
  v_cvt_pk_bf16_f32 v36, v24, v25
  ds_write_b32 v7, v36 offset:31680
  v_cvt_pk_bf16_f32 v37, v26, v27
  ds_write_b32 v7, v37 offset:32208
  v_pk_mul_f32 v[32:33], v[24:25], v[22:23] op_sel:[0,0] op_sel_hi:[0,1]
  v_pk_fma_f32 v[32:33], v[24:25], v[22:23], v[32:33] op_sel:[1,1,0] op_sel_hi:[1,0,1] neg_lo:[1,0,0]
  v_pk_mul_f32 v[34:35], v[26:27], v[22:23] op_sel:[0,0] op_sel_hi:[0,1]
  v_pk_fma_f32 v[34:35], v[26:27], v[22:23], v[34:35] op_sel:[1,1,0] op_sel_hi:[1,0,1] neg_lo:[1,0,0]
  v_cvt_pk_bf16_f32 v38, v32, v33
  ds_write_b32 v7, v38 offset:32736
  v_cvt_pk_bf16_f32 v39, v34, v35
  ds_write_b32 v7, v39 offset:33264
  s_branch V1_join_2
V1_U_1:
  v_mul_f32 v10, v14, v10
  v_mul_f32 v11, v14, v11
  v_pk_mul_f32 v[18:19], v[12:13], v[10:11] op_sel:[0,0] op_sel_hi:[0,1]
  v_pk_fma_f32 v[18:19], v[12:13], v[10:11], v[18:19] op_sel:[1,1,0] op_sel_hi:[1,0,1] neg_lo:[1,0,0]
  v_mul_f32 v30, 0x3f800000, v16
  v_mul_f32 v31, 0x3f800000, v17
  v_exp_f32 v30, v30
  v_fract_f32 v31, v31
  v_cos_f32 v20, v31
  v_sin_f32 v21, v31
  v_mul_f32 v20, v20, v30
  v_mul_f32 v21, v21, v30
  v_mul_f32 v32, 0x43800000, v16
  v_mul_f32 v33, 0x43800000, v17
  v_exp_f32 v32, v32
  v_fract_f32 v33, v33
  v_cos_f32 v22, v33
  v_sin_f32 v23, v33
  v_mul_f32 v22, v22, v32
  v_mul_f32 v23, v23, v32
  v_pk_mul_f32 v[24:25], v[20:21], v[20:21] op_sel:[0,0] op_sel_hi:[0,1]
  v_pk_fma_f32 v[24:25], v[20:21], v[20:21], v[24:25] op_sel:[1,1,0] op_sel_hi:[1,0,1] neg_lo:[1,0,0]
  v_pk_mul_f32 v[26:27], v[24:25], v[24:25] op_sel:[0,0] op_sel_hi:[0,1]
  v_pk_fma_f32 v[26:27], v[24:25], v[24:25], v[26:27] op_sel:[1,1,0] op_sel_hi:[1,0,1] neg_lo:[1,0,0]
  v_cvt_pk_bf16_f32 v40, v18, -v19
  ds_write_b32 v7, v40 offset:0
  v_pk_mul_f32 v[38:39], v[18:19], v[22:23] op_sel:[0,0] op_sel_hi:[0,1]
  v_pk_fma_f32 v[38:39], v[18:19], v[22:23], v[38:39] op_sel:[1,1,0] op_sel_hi:[1,0,1] neg_lo:[1,0,0]
  v_pk_mul_f32 v[36:37], v[18:19], v[20:21] op_sel:[0,0] op_sel_hi:[0,1]
  v_pk_fma_f32 v[36:37], v[18:19], v[20:21], v[36:37] op_sel:[1,1,0] op_sel_hi:[1,0,1] neg_lo:[1,0,0]
  v_cvt_pk_bf16_f32 v41, v36, -v37
  ds_write_b32 v7, v41 offset:528
  v_pk_mul_f32 v[34:35], v[36:37], v[20:21] op_sel:[0,0] op_sel_hi:[0,1]
  v_pk_fma_f32 v[34:35], v[36:37], v[20:21], v[34:35] op_sel:[1,1,0] op_sel_hi:[1,0,1] neg_lo:[1,0,0]
  v_cvt_pk_bf16_f32 v42, v34, -v35
  ds_write_b32 v7, v42 offset:1056
  v_pk_mul_f32 v[36:37], v[34:35], v[20:21] op_sel:[0,0] op_sel_hi:[0,1]
  v_pk_fma_f32 v[36:37], v[34:35], v[20:21], v[36:37] op_sel:[1,1,0] op_sel_hi:[1,0,1] neg_lo:[1,0,0]
  v_cvt_pk_bf16_f32 v43, v36, -v37
  ds_write_b32 v7, v43 offset:1584
  v_pk_mul_f32 v[34:35], v[36:37], v[20:21] op_sel:[0,0] op_sel_hi:[0,1]
  v_pk_fma_f32 v[34:35], v[36:37], v[20:21], v[34:35] op_sel:[1,1,0] op_sel_hi:[1,0,1] neg_lo:[1,0,0]
  v_cvt_pk_bf16_f32 v40, v34, -v35
  ds_write_b32 v7, v40 offset:2112
  v_pk_mul_f32 v[36:37], v[34:35], v[20:21] op_sel:[0,0] op_sel_hi:[0,1]
  v_pk_fma_f32 v[36:37], v[34:35], v[20:21], v[36:37] op_sel:[1,1,0] op_sel_hi:[1,0,1] neg_lo:[1,0,0]
  v_cvt_pk_bf16_f32 v41, v36, -v37
  ds_write_b32 v7, v41 offset:2640
  v_pk_mul_f32 v[34:35], v[36:37], v[20:21] op_sel:[0,0] op_sel_hi:[0,1]
  v_pk_fma_f32 v[34:35], v[36:37], v[20:21], v[34:35] op_sel:[1,1,0] op_sel_hi:[1,0,1] neg_lo:[1,0,0]
  v_cvt_pk_bf16_f32 v42, v34, -v35
  ds_write_b32 v7, v42 offset:3168
  v_pk_mul_f32 v[36:37], v[34:35], v[20:21] op_sel:[0,0] op_sel_hi:[0,1]
  v_pk_fma_f32 v[36:37], v[34:35], v[20:21], v[36:37] op_sel:[1,1,0] op_sel_hi:[1,0,1] neg_lo:[1,0,0]
  v_cvt_pk_bf16_f32 v43, v36, -v37
  ds_write_b32 v7, v43 offset:3696
  v_cvt_pk_bf16_f32 v40, v38, -v39
  ds_write_b32 v7, v40 offset:4224
  v_pk_mul_f32 v[36:37], v[38:39], v[24:25] op_sel:[0,0] op_sel_hi:[0,1]
  v_pk_fma_f32 v[36:37], v[38:39], v[24:25], v[36:37] op_sel:[1,1,0] op_sel_hi:[1,0,1] neg_lo:[1,0,0]
  v_cvt_pk_bf16_f32 v41, v36, -v37
  ds_write_b32 v7, v41 offset:4752
  v_pk_mul_f32 v[34:35], v[36:37], v[24:25] op_sel:[0,0] op_sel_hi:[0,1]
  v_pk_fma_f32 v[34:35], v[36:37], v[24:25], v[34:35] op_sel:[1,1,0] op_sel_hi:[1,0,1] neg_lo:[1,0,0]
  v_cvt_pk_bf16_f32 v42, v34, -v35
  ds_write_b32 v7, v42 offset:5280
  v_pk_mul_f32 v[36:37], v[34:35], v[24:25] op_sel:[0,0] op_sel_hi:[0,1]
  v_pk_fma_f32 v[36:37], v[34:35], v[24:25], v[36:37] op_sel:[1,1,0] op_sel_hi:[1,0,1] neg_lo:[1,0,0]
  v_cvt_pk_bf16_f32 v43, v36, -v37
  ds_write_b32 v7, v43 offset:5808
  v_pk_mul_f32 v[44:45], v[38:39], v[22:23] op_sel:[0,0] op_sel_hi:[0,1]
  v_pk_fma_f32 v[44:45], v[38:39], v[22:23], v[44:45] op_sel:[1,1,0] op_sel_hi:[1,0,1] neg_lo:[1,0,0]
  v_cvt_pk_bf16_f32 v40, v44, -v45
  ds_write_b32 v7, v40 offset:6336
  v_pk_mul_f32 v[34:35], v[44:45], v[26:27] op_sel:[0,0] op_sel_hi:[0,1]
  v_pk_fma_f32 v[34:35], v[44:45], v[26:27], v[34:35] op_sel:[1,1,0] op_sel_hi:[1,0,1] neg_lo:[1,0,0]
  v_cvt_pk_bf16_f32 v41, v34, -v35
  ds_write_b32 v7, v41 offset:6864
  v_pk_mul_f32 v[46:47], v[44:45], v[22:23] op_sel:[0,0] op_sel_hi:[0,1]
  v_pk_fma_f32 v[46:47], v[44:45], v[22:23], v[46:47] op_sel:[1,1,0] op_sel_hi:[1,0,1] neg_lo:[1,0,0]
  v_cvt_pk_bf16_f32 v42, v46, -v47
  ds_write_b32 v7, v42 offset:7392
  v_pk_mul_f32 v[34:35], v[46:47], v[26:27] op_sel:[0,0] op_sel_hi:[0,1]
  v_pk_fma_f32 v[34:35], v[46:47], v[26:27], v[34:35] op_sel:[1,1,0] op_sel_hi:[1,0,1] neg_lo:[1,0,0]
  v_cvt_pk_bf16_f32 v43, v34, -v35
  ds_write_b32 v7, v43 offset:7920
  v_pk_mul_f32 v[44:45], v[46:47], v[22:23] op_sel:[0,0] op_sel_hi:[0,1]
  v_pk_fma_f32 v[44:45], v[46:47], v[22:23], v[44:45] op_sel:[1,1,0] op_sel_hi:[1,0,1] neg_lo:[1,0,0]
  v_cvt_pk_bf16_f32 v40, v44, -v45
  ds_write_b32 v7, v40 offset:8448
  v_pk_mul_f32 v[46:47], v[44:45], v[22:23] op_sel:[0,0] op_sel_hi:[0,1]
  v_pk_fma_f32 v[46:47], v[44:45], v[22:23], v[46:47] op_sel:[1,1,0] op_sel_hi:[1,0,1] neg_lo:[1,0,0]
  v_cvt_pk_bf16_f32 v41, v46, -v47
  ds_write_b32 v7, v41 offset:8976
  v_pk_mul_f32 v[44:45], v[46:47], v[22:23] op_sel:[0,0] op_sel_hi:[0,1]
  v_pk_fma_f32 v[44:45], v[46:47], v[22:23], v[44:45] op_sel:[1,1,0] op_sel_hi:[1,0,1] neg_lo:[1,0,0]
  v_cvt_pk_bf16_f32 v42, v44, -v45
  ds_write_b32 v7, v42 offset:9504
  v_pk_mul_f32 v[46:47], v[44:45], v[22:23] op_sel:[0,0] op_sel_hi:[0,1]
  v_pk_fma_f32 v[46:47], v[44:45], v[22:23], v[46:47] op_sel:[1,1,0] op_sel_hi:[1,0,1] neg_lo:[1,0,0]
  v_cvt_pk_bf16_f32 v43, v46, -v47
  ds_write_b32 v7, v43 offset:10032
  v_pk_mul_f32 v[44:45], v[46:47], v[22:23] op_sel:[0,0] op_sel_hi:[0,1]
  v_pk_fma_f32 v[44:45], v[46:47], v[22:23], v[44:45] op_sel:[1,1,0] op_sel_hi:[1,0,1] neg_lo:[1,0,0]
  v_cvt_pk_bf16_f32 v40, v44, -v45
  ds_write_b32 v7, v40 offset:10560
V1_join_2:
  v_mov_b32 v8, 0
  v_mov_b32 v9, 0
  v_mov_b32 v6, 33792
  ds_write_b64 v6, v[8:9] offset:8
  s_waitcnt lgkmcnt(0)
  s_barrier
  s_lshr_b32 s28, s10, 1
  s_and_b32 s29, s10, 1
  s_mul_i32 s30, s28, 8448
  s_mul_i32 s31, s29, 8448
  s_add_u32 s31, s31, 16896
  v_mul_u32_u24 v7, 528, v4
  v_lshl_add_u32 v7, v3, 4, v7
  v_add_u32 v5, s30, v7
  v_add_u32 v6, s31, v7
  ds_read_b128 v[16:19], v5 offset:0
  ds_read_b128 v[20:23], v6 offset:0
  ds_read_b128 v[24:27], v5 offset:64
  ds_read_b128 v[28:31], v6 offset:64
  ds_read_b128 v[32:35], v5 offset:128
  ds_read_b128 v[36:39], v6 offset:128
  ds_read_b128 v[40:43], v5 offset:192
  ds_read_b128 v[44:47], v6 offset:192
  ds_read_b128 v[48:51], v5 offset:256
  ds_read_b128 v[52:55], v6 offset:256
  ds_read_b128 v[56:59], v5 offset:320
  ds_read_b128 v[60:63], v6 offset:320
  ds_read_b128 v[64:67], v5 offset:384
  ds_read_b128 v[68:71], v6 offset:384
  ds_read_b128 v[72:75], v5 offset:448
  ds_read_b128 v[76:79], v6 offset:448
  s_lshl_b32 s30, s29, 4
  v_add_u32 v7, s30, v4
  v_lshlrev_b32 v7, 3, v7
  s_cmp_eq_u32 s28, 1
  s_cbranch_scc1 V1_rt1_3
  v_max_u32 v12, 1, v3
  v_add_u32 v12, -1, v12
  v_mov_b32 v13, 1
  v_lshlrev_b32 v12, v12, v13
  v_lshlrev_b32 v13, 7, v12
  v_lshlrev_b32 v14, 2, v3
  v_cmp_gt_u32 vcc, 2, v3
  s_nop 1
  v_cndmask_b32 v13, v13, v14, vcc
  v_mov_b32 v14, 0
  v_mov_b32 v15, 248
  v_cmp_eq_u32 vcc, 3, v3
  s_nop 1
  v_cndmask_b32 v14, v14, v15, vcc
  v_add_u32 v84, v13, v7
  v_add_u32 v85, v84, v12
  v_add_u32 v86, v85, v12
  v_add_u32 v87, v86, v12
  v_add_u32 v86, v86, v14
  v_add_u32 v87, v87, v14
  s_branch V1_sc_4
V1_rt1_3:
  v_add_u32 v84, 1024, v7
  v_add_u32 v85, 1280, v7
  v_add_u32 v86, 1536, v7
  v_add_u32 v87, 1792, v7
  v_mov_b32 v12, 2056
  v_cmp_lt_u32 vcc, 0, v3
  s_nop 1
  v_cndmask_b32 v84, v84, v12, vcc
  v_cndmask_b32 v85, v85, v12, vcc
  v_cndmask_b32 v86, v86, v12, vcc
  v_cndmask_b32 v87, v87, v12, vcc
  v_lshl_or_b32 v13, v3, 12, v7
  v_mov_b32 v14, 2048
  v_cmp_eq_u32 vcc, 0x1000, v13
  s_nop 1
  v_cndmask_b32 v84, v84, v14, vcc
V1_sc_4:
  v_lshlrev_b32 v84, 1, v84
  v_lshlrev_b32 v85, 1, v85
  v_lshlrev_b32 v86, 1, v86
  v_lshlrev_b32 v87, 1, v87
  s_waitcnt lgkmcnt(14)
  v_mfma_f32_16x16x32_bf16 v[8:11], v[16:19], v[20:23], 0
  s_waitcnt lgkmcnt(12)
  v_mfma_f32_16x16x32_bf16 v[8:11], v[24:27], v[28:31], v[8:11]
  s_waitcnt lgkmcnt(10)
  v_mfma_f32_16x16x32_bf16 v[8:11], v[32:35], v[36:39], v[8:11]
  s_waitcnt lgkmcnt(8)
  v_mfma_f32_16x16x32_bf16 v[8:11], v[40:43], v[44:47], v[8:11]
  s_waitcnt lgkmcnt(6)
  v_mfma_f32_16x16x32_bf16 v[8:11], v[48:51], v[52:55], v[8:11]
  s_waitcnt lgkmcnt(4)
  v_mfma_f32_16x16x32_bf16 v[8:11], v[56:59], v[60:63], v[8:11]
  s_waitcnt lgkmcnt(2)
  v_mfma_f32_16x16x32_bf16 v[8:11], v[64:67], v[68:71], v[8:11]
  s_waitcnt lgkmcnt(0)
  v_mfma_f32_16x16x32_bf16 v[8:11], v[72:75], v[76:79], v[8:11]
  s_nop 7
  v_cvt_pk_bf16_f32 v12, v8, v9
  v_cvt_pk_bf16_f32 v13, v10, v11
  ds_write_b16 v84, v12 offset:33808
  ds_write_b16_d16_hi v85, v12 offset:33808
  ds_write_b16 v86, v13 offset:33808
  ds_write_b16_d16_hi v87, v13 offset:33808
  v_lshlrev_b32 v7, 4, v0
  v_sub_u32 v14, 4094, v7
  v_cvt_f32_i32 v14, v14
  v_add_f32 v16, 0x80000000, v14
  v_add_f32 v17, 0xc0000000, v14
  v_cvt_pk_bf16_f32 v18, v16, v17
  v_lshlrev_b32 v16, 16, v18
  v_and_b32 v17, 0xffff0000, v18
  v_cvt_i32_f32 v20, v16
  v_cvt_i32_f32 v21, v17
  v_add_f32 v16, 0xc0800000, v14
  v_add_f32 v17, 0xc0c00000, v14
  v_cvt_pk_bf16_f32 v18, v16, v17
  v_lshlrev_b32 v16, 16, v18
  v_and_b32 v17, 0xffff0000, v18
  v_cvt_i32_f32 v22, v16
  v_cvt_i32_f32 v23, v17
  v_add_f32 v16, 0xc1000000, v14
  v_add_f32 v17, 0xc1200000, v14
  v_cvt_pk_bf16_f32 v18, v16, v17
  v_lshlrev_b32 v16, 16, v18
  v_and_b32 v17, 0xffff0000, v18
  v_cvt_i32_f32 v24, v16
  v_cvt_i32_f32 v25, v17
  v_add_f32 v16, 0xc1400000, v14
  v_add_f32 v17, 0xc1600000, v14
  v_cvt_pk_bf16_f32 v18, v16, v17
  v_lshlrev_b32 v16, 16, v18
  v_and_b32 v17, 0xffff0000, v18
  v_cvt_i32_f32 v26, v16
  v_cvt_i32_f32 v27, v17
  v_add_f32 v16, 0xc1800000, v14
  v_add_f32 v17, 0xc1900000, v14
  v_cvt_pk_bf16_f32 v18, v16, v17
  v_lshlrev_b32 v16, 16, v18
  v_and_b32 v17, 0xffff0000, v18
  v_cvt_i32_f32 v28, v16
  v_cvt_i32_f32 v29, v17
  s_waitcnt lgkmcnt(0)
  s_barrier
  ds_read_u16 v48, v20 offset:33808
  ds_read_u16 v49, v21 offset:33808
  ds_read_u16 v50, v22 offset:33808
  ds_read_u16 v51, v23 offset:33808
  ds_read_u16 v52, v24 offset:33808
  ds_read_u16 v53, v25 offset:33808
  ds_read_u16 v54, v26 offset:33808
  ds_read_u16 v55, v27 offset:33808
  ds_read_u16 v56, v28 offset:33808
  s_mul_i32 s30, s11, 8320
  s_add_u32 s31, s30, 4160
  v_and_b32 v5, 3, v0
  v_lshlrev_b32 v5, 4, v5
  v_add_u32 v5, 4096, v5
  v_lshrrev_b32 v6, 2, v0
  v_mul_u32_u24 v6, 4160, v6
  v_add_u32 v5, v5, v6
  v_mov_b32 v44, 0
  v_mov_b32 v45, 0
  v_mov_b32 v46, 0
  v_mov_b32 v47, 0
  v_cmp_gt_u32 vcc, 8, v0
  s_and_saveexec_b64 s[32:33], vcc
  s_cbranch_execz V1_z_5
  buffer_store_dwordx4 v[44:47], v5, s[36:39], s30 offen
V1_z_5:
  s_mov_b64 exec, s[32:33]
  s_waitcnt lgkmcnt(0)
  v_lshl_or_b32 v32, v49, 16, v48
  v_lshl_or_b32 v40, v50, 16, v49
  v_lshl_or_b32 v33, v51, 16, v50
  v_lshl_or_b32 v41, v52, 16, v51
  v_lshl_or_b32 v34, v53, 16, v52
  v_lshl_or_b32 v42, v54, 16, v53
  v_lshl_or_b32 v35, v55, 16, v54
  v_lshl_or_b32 v43, v56, 16, v55
  buffer_store_dwordx4 v[32:35], v7, s[36:39], s30 offen
  buffer_store_dwordx4 v[40:43], v7, s[36:39], s31 offen
  s_endpgm
V1_disp:
  s_cmp_lt_u32 s2, 704
  s_cbranch_scc1 V1_G
  s_cmp_lt_u32 s2, 768
  s_cbranch_scc1 V1_A
  s_cmp_lt_u32 s2, 796
  s_cbranch_scc1 V1_D
  s_cmp_lt_u32 s2, 813
  s_cbranch_scc1 V1_E
  s_endpgm
V1_G:
  s_load_dwordx2 s[4:5], s[0:1], 144
  s_load_dwordx2 s[20:21], s[0:1], 120
  s_load_dwordx2 s[22:23], s[0:1], 112
  v_lshrrev_b32 v1, 6, v0
  s_nop 0
  v_readfirstlane_b32 s8, v1
  v_and_b32 v1, 63, v0
  v_lshlrev_b32 v2, 4, v1
  v_lshrrev_b32 v3, 4, v1
  v_and_b32 v4, 15, v1
  s_sub_u32 s9, s2, 512
  s_and_b32 s10, s9, 7
  s_mul_i32 s10, s10, 24
  s_lshr_b32 s11, s9, 3
  s_add_u32 s10, s10, s11
  v_lshrrev_b32 v5, 1, v1
  v_and_b32 v6, 1, v1
  s_lshl_b32 s11, s8, 8
  v_lshlrev_b32 v7, 3, v5
  v_add_u32 v7, s11, v7
  s_mov_b32 s11, 24576
  v_mul_lo_u32 v8, v5, s11
  v_lshl_add_u32 v8, v6, 4, v8
  s_mul_i32 s11, s8, 786432
  s_lshl_b32 s28, s10, 5
  s_add_u32 s11, s11, s28
  s_waitcnt lgkmcnt(0)
  s_mov_b32 s12, s20
  s_mov_b32 s13, s21
  s_mov_b32 s14, 3145728
  s_mov_b32 s15, 0x20000
  s_mov_b32 s16, s22
  s_mov_b32 s17, s23
  s_mov_b32 s18, 1024
  s_mov_b32 s19, 0x20000
  s_mov_b32 s24, s4
  s_mov_b32 s25, s5
  s_mov_b32 s26, 12288
  s_mov_b32 s27, 0x20000
  buffer_load_dwordx2 v[12:13], v7, s[16:19], 0 offen
  s_add_u32 s28, s11, 0
  buffer_load_dwordx4 v[40:43], v8, s[12:15], s28 offen
  s_add_u32 s28, s11, 6144
  buffer_load_dwordx4 v[44:47], v8, s[12:15], s28 offen
  s_add_u32 s28, s11, 12288
  buffer_load_dwordx4 v[48:51], v8, s[12:15], s28 offen
  s_add_u32 s28, s11, 18432
  buffer_load_dwordx4 v[52:55], v8, s[12:15], s28 offen
  s_waitcnt vmcnt(4)
  v_lshlrev_b32 v20, 16, v12
  v_and_b32 v21, 0xffff0000, v12
  v_lshlrev_b32 v22, 16, v13
  v_and_b32 v23, 0xffff0000, v13
  s_mov_b32 s29, 0xbfb8aa3b
  v_mul_f32 v64, s29, v20
  v_mul_f32 v65, s29, v21
  v_mul_f32 v66, s29, v22
  v_mul_f32 v67, s29, v23
  v_exp_f32 v64, v64
  v_exp_f32 v65, v65
  v_exp_f32 v66, v66
  v_exp_f32 v67, v67
  v_add_f32 v64, 1.0, v64
  v_add_f32 v65, 1.0, v65
  v_add_f32 v66, 1.0, v66
  v_add_f32 v67, 1.0, v67
  v_rcp_f32 v64, v64
  v_rcp_f32 v65, v65
  v_rcp_f32 v66, v66
  v_rcp_f32 v67, v67
  v_mul_f32 v20, v20, v64
  v_mul_f32 v21, v21, v65
  v_mul_f32 v22, v22, v66
  v_mul_f32 v23, v23, v67
  s_waitcnt vmcnt(3)
  v_lshlrev_b32 v64, 16, v40
  v_and_b32 v65, 0xffff0000, v40
  v_lshlrev_b32 v66, 16, v41
  v_and_b32 v67, 0xffff0000, v41
  v_lshlrev_b32 v68, 16, v42
  v_and_b32 v69, 0xffff0000, v42
  v_lshlrev_b32 v70, 16, v43
  v_and_b32 v71, 0xffff0000, v43
  v_mul_f32 v72, v20, v64
  v_mul_f32 v73, v20, v65
  v_mul_f32 v74, v20, v66
  v_mul_f32 v75, v20, v67
  v_mul_f32 v76, v20, v68
  v_mul_f32 v77, v20, v69
  v_mul_f32 v78, v20, v70
  v_mul_f32 v79, v20, v71
  s_waitcnt vmcnt(2)
  v_lshlrev_b32 v64, 16, v44
  v_and_b32 v65, 0xffff0000, v44
  v_lshlrev_b32 v66, 16, v45
  v_and_b32 v67, 0xffff0000, v45
  v_lshlrev_b32 v68, 16, v46
  v_and_b32 v69, 0xffff0000, v46
  v_lshlrev_b32 v70, 16, v47
  v_and_b32 v71, 0xffff0000, v47
  v_fmac_f32 v72, v21, v64
  v_fmac_f32 v73, v21, v65
  v_fmac_f32 v74, v21, v66
  v_fmac_f32 v75, v21, v67
  v_fmac_f32 v76, v21, v68
  v_fmac_f32 v77, v21, v69
  v_fmac_f32 v78, v21, v70
  v_fmac_f32 v79, v21, v71
  s_waitcnt vmcnt(1)
  v_lshlrev_b32 v64, 16, v48
  v_and_b32 v65, 0xffff0000, v48
  v_lshlrev_b32 v66, 16, v49
  v_and_b32 v67, 0xffff0000, v49
  v_lshlrev_b32 v68, 16, v50
  v_and_b32 v69, 0xffff0000, v50
  v_lshlrev_b32 v70, 16, v51
  v_and_b32 v71, 0xffff0000, v51
  v_fmac_f32 v72, v22, v64
  v_fmac_f32 v73, v22, v65
  v_fmac_f32 v74, v22, v66
  v_fmac_f32 v75, v22, v67
  v_fmac_f32 v76, v22, v68
  v_fmac_f32 v77, v22, v69
  v_fmac_f32 v78, v22, v70
  v_fmac_f32 v79, v22, v71
  s_waitcnt vmcnt(0)
  v_lshlrev_b32 v64, 16, v52
  v_and_b32 v65, 0xffff0000, v52
  v_lshlrev_b32 v66, 16, v53
  v_and_b32 v67, 0xffff0000, v53
  v_lshlrev_b32 v68, 16, v54
  v_and_b32 v69, 0xffff0000, v54
  v_lshlrev_b32 v70, 16, v55
  v_and_b32 v71, 0xffff0000, v55
  v_fmac_f32 v72, v23, v64
  v_fmac_f32 v73, v23, v65
  v_fmac_f32 v74, v23, v66
  v_fmac_f32 v75, v23, v67
  v_fmac_f32 v76, v23, v68
  v_fmac_f32 v77, v23, v69
  v_fmac_f32 v78, v23, v70
  v_fmac_f32 v79, v23, v71
  v_add_f32_dpp v72, v72, v72 quad_perm:[2,3,0,1] row_mask:0xf bank_mask:0xf
  v_add_f32_dpp v73, v73, v73 quad_perm:[2,3,0,1] row_mask:0xf bank_mask:0xf
  v_add_f32_dpp v74, v74, v74 quad_perm:[2,3,0,1] row_mask:0xf bank_mask:0xf
  v_add_f32_dpp v75, v75, v75 quad_perm:[2,3,0,1] row_mask:0xf bank_mask:0xf
  v_add_f32_dpp v76, v76, v76 quad_perm:[2,3,0,1] row_mask:0xf bank_mask:0xf
  v_add_f32_dpp v77, v77, v77 quad_perm:[2,3,0,1] row_mask:0xf bank_mask:0xf
  v_add_f32_dpp v78, v78, v78 quad_perm:[2,3,0,1] row_mask:0xf bank_mask:0xf
  v_add_f32_dpp v79, v79, v79 quad_perm:[2,3,0,1] row_mask:0xf bank_mask:0xf
  v_add_f32_dpp v72, v72, v72 row_ror:4 row_mask:0xf bank_mask:0xf
  v_add_f32_dpp v73, v73, v73 row_ror:4 row_mask:0xf bank_mask:0xf
  v_add_f32_dpp v74, v74, v74 row_ror:4 row_mask:0xf bank_mask:0xf
  v_add_f32_dpp v75, v75, v75 row_ror:4 row_mask:0xf bank_mask:0xf
  v_add_f32_dpp v76, v76, v76 row_ror:4 row_mask:0xf bank_mask:0xf
  v_add_f32_dpp v77, v77, v77 row_ror:4 row_mask:0xf bank_mask:0xf
  v_add_f32_dpp v78, v78, v78 row_ror:4 row_mask:0xf bank_mask:0xf
  v_add_f32_dpp v79, v79, v79 row_ror:4 row_mask:0xf bank_mask:0xf
  v_add_f32_dpp v72, v72, v72 row_ror:8 row_mask:0xf bank_mask:0xf
  v_add_f32_dpp v73, v73, v73 row_ror:8 row_mask:0xf bank_mask:0xf
  v_add_f32_dpp v74, v74, v74 row_ror:8 row_mask:0xf bank_mask:0xf
  v_add_f32_dpp v75, v75, v75 row_ror:8 row_mask:0xf bank_mask:0xf
  v_add_f32_dpp v76, v76, v76 row_ror:8 row_mask:0xf bank_mask:0xf
  v_add_f32_dpp v77, v77, v77 row_ror:8 row_mask:0xf bank_mask:0xf
  v_add_f32_dpp v78, v78, v78 row_ror:8 row_mask:0xf bank_mask:0xf
  v_add_f32_dpp v79, v79, v79 row_ror:8 row_mask:0xf bank_mask:0xf
  v_permlane32_swap_b32 v72, v76
  v_permlane32_swap_b32 v73, v77
  v_permlane32_swap_b32 v74, v78
  v_permlane32_swap_b32 v75, v79
  v_add_f32 v72, v72, v76
  v_add_f32 v73, v73, v77
  v_add_f32 v74, v74, v78
  v_add_f32 v75, v75, v79
  v_mov_b32 v76, v72
  v_mov_b32 v77, v73
  v_mov_b32 v78, v74
  v_mov_b32 v79, v75
  v_permlane16_swap_b32 v72, v76
  v_permlane16_swap_b32 v73, v77
  v_permlane16_swap_b32 v74, v78
  v_permlane16_swap_b32 v75, v79
  v_add_f32 v72, v72, v76
  v_add_f32 v73, v73, v77
  v_add_f32 v74, v74, v78
  v_add_f32 v75, v75, v79
  v_lshlrev_b32 v7, 5, v6
  v_lshrrev_b32 v5, 5, v1
  v_lshl_add_u32 v7, v5, 4, v7
  s_lshl_b32 s11, s8, 6
  v_add_u32 v7, s11, v7
  s_mov_b32 exec_lo, 3
  s_mov_b32 exec_hi, 3
  ds_write_b128 v7, v[72:75]
  s_mov_b64 exec, -1
  s_waitcnt lgkmcnt(0)
  s_barrier
  s_cmp_lg_u32 s8, 0
  s_cbranch_scc1 V1_gx_6
  v_lshlrev_b32 v7, 2, v4
  ds_read_b32 v20, v7 offset:0
  ds_read_b32 v21, v7 offset:64
  ds_read_b32 v22, v7 offset:128
  ds_read_b32 v23, v7 offset:192
  s_waitcnt lgkmcnt(0)
  v_add_f32 v20, v20, v21
  v_add_f32 v22, v22, v23
  v_add_f32 v20, v20, v22
  s_lshl_b32 s11, s10, 6
  s_mov_b64 exec, 0xffff
  buffer_store_dword v20, v7, s[24:27], s11 offen
V1_gx_6:
  s_endpgm
V1_A:
  s_load_dwordx2 s[4:5], s[0:1], 144
  s_load_dwordx2 s[20:21], s[0:1], 0
  v_lshrrev_b32 v1, 6, v0
  s_nop 0
  v_readfirstlane_b32 s8, v1
  v_and_b32 v1, 63, v0
  v_lshlrev_b32 v2, 4, v1
  v_lshrrev_b32 v3, 4, v1
  v_and_b32 v4, 15, v1
  v_add_u32 v5, 4096, v2
  s_sub_u32 s9, s2, 704
  s_lshl_b32 s9, s9, 2
  s_add_u32 s9, s9, s8
  s_lshl_b32 s10, s9, 13
  s_waitcnt lgkmcnt(0)
  s_mov_b32 s12, s20
  s_mov_b32 s13, s21
  s_mov_b32 s14, 2097152
  s_mov_b32 s15, 0x20000
  s_add_u32 s16, s4, 1048576
  s_addc_u32 s17, s5, 0
  s_mov_b32 s18, 2097152
  s_mov_b32 s19, 0x20000
  s_add_u32 s24, s4, 16384
  s_addc_u32 s25, s5, 0
  s_mov_b32 s26, 16384
  s_mov_b32 s27, 0x20000
  buffer_load_dwordx4 v[8:11], v2, s[12:15], s10 offen offset:0
  buffer_load_dwordx4 v[12:15], v2, s[12:15], s10 offen offset:1024
  buffer_load_dwordx4 v[16:19], v2, s[12:15], s10 offen offset:2048
  buffer_load_dwordx4 v[20:23], v2, s[12:15], s10 offen offset:3072
  buffer_load_dwordx4 v[24:27], v5, s[12:15], s10 offen offset:0
  buffer_load_dwordx4 v[28:31], v5, s[12:15], s10 offen offset:1024
  buffer_load_dwordx4 v[32:35], v5, s[12:15], s10 offen offset:2048
  buffer_load_dwordx4 v[36:39], v5, s[12:15], s10 offen offset:3072
  s_mov_b32 s28, 0x3f803f80
  s_mov_b32 s29, 0x05040100
  s_mov_b32 s30, 0x07060302
  s_waitcnt vmcnt(7)
  v_mov_b32 v40, 0
  v_mov_b32 v48, 0
  v_dot2_f32_bf16 v40, v8, s28, v40
  v_dot2_f32_bf16 v48, v8, v8, v48
  v_dot2_f32_bf16 v40, v9, s28, v40
  v_dot2_f32_bf16 v48, v9, v9, v48
  v_dot2_f32_bf16 v40, v10, s28, v40
  v_dot2_f32_bf16 v48, v10, v10, v48
  v_dot2_f32_bf16 v40, v11, s28, v40
  v_dot2_f32_bf16 v48, v11, v11, v48
  s_waitcnt vmcnt(6)
  v_mov_b32 v41, 0
  v_mov_b32 v49, 0
  v_dot2_f32_bf16 v41, v12, s28, v41
  v_dot2_f32_bf16 v49, v12, v12, v49
  v_dot2_f32_bf16 v41, v13, s28, v41
  v_dot2_f32_bf16 v49, v13, v13, v49
  v_dot2_f32_bf16 v41, v14, s28, v41
  v_dot2_f32_bf16 v49, v14, v14, v49
  v_dot2_f32_bf16 v41, v15, s28, v41
  v_dot2_f32_bf16 v49, v15, v15, v49
  s_waitcnt vmcnt(5)
  v_mov_b32 v42, 0
  v_mov_b32 v50, 0
  v_dot2_f32_bf16 v42, v16, s28, v42
  v_dot2_f32_bf16 v50, v16, v16, v50
  v_dot2_f32_bf16 v42, v17, s28, v42
  v_dot2_f32_bf16 v50, v17, v17, v50
  v_dot2_f32_bf16 v42, v18, s28, v42
  v_dot2_f32_bf16 v50, v18, v18, v50
  v_dot2_f32_bf16 v42, v19, s28, v42
  v_dot2_f32_bf16 v50, v19, v19, v50
  s_waitcnt vmcnt(4)
  v_mov_b32 v43, 0
  v_mov_b32 v51, 0
  v_dot2_f32_bf16 v43, v20, s28, v43
  v_dot2_f32_bf16 v51, v20, v20, v51
  v_dot2_f32_bf16 v43, v21, s28, v43
  v_dot2_f32_bf16 v51, v21, v21, v51
  v_dot2_f32_bf16 v43, v22, s28, v43
  v_dot2_f32_bf16 v51, v22, v22, v51
  v_dot2_f32_bf16 v43, v23, s28, v43
  v_dot2_f32_bf16 v51, v23, v23, v51
  s_waitcnt vmcnt(3)
  v_mov_b32 v44, 0
  v_mov_b32 v52, 0
  v_dot2_f32_bf16 v44, v24, s28, v44
  v_dot2_f32_bf16 v52, v24, v24, v52
  v_dot2_f32_bf16 v44, v25, s28, v44
  v_dot2_f32_bf16 v52, v25, v25, v52
  v_dot2_f32_bf16 v44, v26, s28, v44
  v_dot2_f32_bf16 v52, v26, v26, v52
  v_dot2_f32_bf16 v44, v27, s28, v44
  v_dot2_f32_bf16 v52, v27, v27, v52
  s_waitcnt vmcnt(2)
  v_mov_b32 v45, 0
  v_mov_b32 v53, 0
  v_dot2_f32_bf16 v45, v28, s28, v45
  v_dot2_f32_bf16 v53, v28, v28, v53
  v_dot2_f32_bf16 v45, v29, s28, v45
  v_dot2_f32_bf16 v53, v29, v29, v53
  v_dot2_f32_bf16 v45, v30, s28, v45
  v_dot2_f32_bf16 v53, v30, v30, v53
  v_dot2_f32_bf16 v45, v31, s28, v45
  v_dot2_f32_bf16 v53, v31, v31, v53
  s_waitcnt vmcnt(1)
  v_mov_b32 v46, 0
  v_mov_b32 v54, 0
  v_dot2_f32_bf16 v46, v32, s28, v46
  v_dot2_f32_bf16 v54, v32, v32, v54
  v_dot2_f32_bf16 v46, v33, s28, v46
  v_dot2_f32_bf16 v54, v33, v33, v54
  v_dot2_f32_bf16 v46, v34, s28, v46
  v_dot2_f32_bf16 v54, v34, v34, v54
  v_dot2_f32_bf16 v46, v35, s28, v46
  v_dot2_f32_bf16 v54, v35, v35, v54
  s_waitcnt vmcnt(0)
  v_mov_b32 v47, 0
  v_mov_b32 v55, 0
  v_dot2_f32_bf16 v47, v36, s28, v47
  v_dot2_f32_bf16 v55, v36, v36, v55
  v_dot2_f32_bf16 v47, v37, s28, v47
  v_dot2_f32_bf16 v55, v37, v37, v55
  v_dot2_f32_bf16 v47, v38, s28, v47
  v_dot2_f32_bf16 v55, v38, v38, v55
  v_dot2_f32_bf16 v47, v39, s28, v47
  v_dot2_f32_bf16 v55, v39, v39, v55
  v_and_b32 v6, 3, v1
  v_xor_b32 v6, s8, v6
  v_lshlrev_b32 v6, 4, v6
  v_lshl_add_u32 v6, v1, 9, v6
  v_perm_b32 v64, v12, v8, s29
  v_perm_b32 v65, v20, v16, s29
  v_perm_b32 v66, v28, v24, s29
  v_perm_b32 v67, v36, v32, s29
  ds_write_b128 v6, v[64:67] offset:0
  v_perm_b32 v68, v12, v8, s30
  v_perm_b32 v69, v20, v16, s30
  v_perm_b32 v70, v28, v24, s30
  v_perm_b32 v71, v36, v32, s30
  ds_write_b128 v6, v[68:71] offset:64
  v_perm_b32 v72, v13, v9, s29
  v_perm_b32 v73, v21, v17, s29
  v_perm_b32 v74, v29, v25, s29
  v_perm_b32 v75, v37, v33, s29
  ds_write_b128 v6, v[72:75] offset:128
  v_perm_b32 v76, v13, v9, s30
  v_perm_b32 v77, v21, v17, s30
  v_perm_b32 v78, v29, v25, s30
  v_perm_b32 v79, v37, v33, s30
  ds_write_b128 v6, v[76:79] offset:192
  v_perm_b32 v80, v14, v10, s29
  v_perm_b32 v81, v22, v18, s29
  v_perm_b32 v82, v30, v26, s29
  v_perm_b32 v83, v38, v34, s29
  ds_write_b128 v6, v[80:83] offset:256
  v_perm_b32 v84, v14, v10, s30
  v_perm_b32 v85, v22, v18, s30
  v_perm_b32 v86, v30, v26, s30
  v_perm_b32 v87, v38, v34, s30
  ds_write_b128 v6, v[84:87] offset:320
  v_perm_b32 v88, v15, v11, s29
  v_perm_b32 v89, v23, v19, s29
  v_perm_b32 v90, v31, v27, s29
  v_perm_b32 v91, v39, v35, s29
  ds_write_b128 v6, v[88:91] offset:384
  v_perm_b32 v92, v15, v11, s30
  v_perm_b32 v93, v23, v19, s30
  v_perm_b32 v94, v31, v27, s30
  v_perm_b32 v95, v39, v35, s30
  ds_write_b128 v6, v[92:95] offset:448
  s_lshl_b32 s33, s8, 1
  v_lshrrev_b32 v6, 5, v1
  v_add_u32 v6, s33, v6
  v_and_b32 v6, 3, v6
  v_and_b32 v7, 3, v1
  v_xor_b32 v6, v6, v7
  v_lshlrev_b32 v6, 4, v6
  v_lshrrev_b32 v7, 2, v1
  s_lshl_b32 s33, s8, 4
  v_add_u32 v7, s33, v7
  v_lshl_add_u32 v7, v7, 6, v6
  s_waitcnt lgkmcnt(0)
  s_barrier
  ds_read_b128 v[64:67], v7 offset:0
  ds_read_b128 v[68:71], v7 offset:4096
  ds_read_b128 v[72:75], v7 offset:8192
  ds_read_b128 v[76:79], v7 offset:12288
  ds_read_b128 v[80:83], v7 offset:16384
  ds_read_b128 v[84:87], v7 offset:20480
  ds_read_b128 v[88:91], v7 offset:24576
  ds_read_b128 v[92:95], v7 offset:28672
  s_sub_u32 s33, s2, 704
  s_lshl_b32 s33, s33, 15
  s_lshl_b32 s34, s8, 10
  s_add_u32 s33, s33, s34
  s_waitcnt lgkmcnt(7)
  s_add_u32 s34, s33, 0
  buffer_store_dwordx4 v[64:67], v2, s[16:19], s34 offen
  s_waitcnt lgkmcnt(6)
  s_add_u32 s34, s33, 4096
  buffer_store_dwordx4 v[68:71], v2, s[16:19], s34 offen
  s_waitcnt lgkmcnt(5)
  s_add_u32 s34, s33, 8192
  buffer_store_dwordx4 v[72:75], v2, s[16:19], s34 offen
  s_waitcnt lgkmcnt(4)
  s_add_u32 s34, s33, 12288
  buffer_store_dwordx4 v[76:79], v2, s[16:19], s34 offen
  s_waitcnt lgkmcnt(3)
  s_add_u32 s34, s33, 16384
  buffer_store_dwordx4 v[80:83], v2, s[16:19], s34 offen
  s_waitcnt lgkmcnt(2)
  s_add_u32 s34, s33, 20480
  buffer_store_dwordx4 v[84:87], v2, s[16:19], s34 offen
  s_waitcnt lgkmcnt(1)
  s_add_u32 s34, s33, 24576
  buffer_store_dwordx4 v[88:91], v2, s[16:19], s34 offen
  s_waitcnt lgkmcnt(0)
  s_add_u32 s34, s33, 28672
  buffer_store_dwordx4 v[92:95], v2, s[16:19], s34 offen
  v_permlane32_swap_b32 v40, v48
  v_permlane32_swap_b32 v41, v49
  v_permlane32_swap_b32 v42, v50
  v_permlane32_swap_b32 v43, v51
  v_permlane32_swap_b32 v44, v52
  v_permlane32_swap_b32 v45, v53
  v_permlane32_swap_b32 v46, v54
  v_permlane32_swap_b32 v47, v55
  v_add_f32 v40, v40, v48
  v_add_f32 v41, v41, v49
  v_add_f32 v42, v42, v50
  v_add_f32 v43, v43, v51
  v_add_f32 v44, v44, v52
  v_add_f32 v45, v45, v53
  v_add_f32 v46, v46, v54
  v_add_f32 v47, v47, v55
  v_permlane16_swap_b32 v40, v44
  v_permlane16_swap_b32 v41, v45
  v_permlane16_swap_b32 v42, v46
  v_permlane16_swap_b32 v43, v47
  v_add_f32 v40, v40, v44
  v_add_f32 v41, v41, v45
  v_add_f32 v42, v42, v46
  v_add_f32 v43, v43, v47
  v_add_f32_dpp v40, v40, v40 row_ror:8 row_mask:0xf bank_mask:0xf
  v_add_f32_dpp v41, v41, v41 row_ror:8 row_mask:0xf bank_mask:0xf
  v_add_f32_dpp v42, v42, v42 row_ror:8 row_mask:0xf bank_mask:0xf
  v_add_f32_dpp v43, v43, v43 row_ror:8 row_mask:0xf bank_mask:0xf
  v_add_f32_dpp v40, v40, v40 row_ror:4 row_mask:0xf bank_mask:0xf
  v_add_f32_dpp v41, v41, v41 row_ror:4 row_mask:0xf bank_mask:0xf
  v_add_f32_dpp v42, v42, v42 row_ror:4 row_mask:0xf bank_mask:0xf
  v_add_f32_dpp v43, v43, v43 row_ror:4 row_mask:0xf bank_mask:0xf
  v_add_f32_dpp v40, v40, v40 row_ror:2 row_mask:0xf bank_mask:0xf
  v_add_f32_dpp v41, v41, v41 row_ror:2 row_mask:0xf bank_mask:0xf
  v_add_f32_dpp v42, v42, v42 row_ror:2 row_mask:0xf bank_mask:0xf
  v_add_f32_dpp v43, v43, v43 row_ror:2 row_mask:0xf bank_mask:0xf
  v_add_f32_dpp v40, v40, v40 row_ror:1 row_mask:0xf bank_mask:0xf
  v_add_f32_dpp v41, v41, v41 row_ror:1 row_mask:0xf bank_mask:0xf
  v_add_f32_dpp v42, v42, v42 row_ror:1 row_mask:0xf bank_mask:0xf
  v_add_f32_dpp v43, v43, v43 row_ror:1 row_mask:0xf bank_mask:0xf
  v_mov_b32 v44, v40
  v_mov_b32 v45, v41
  v_mov_b32 v46, v42
  v_mov_b32 v47, v43
  v_permlane32_swap_b32 v40, v44
  v_permlane32_swap_b32 v41, v45
  v_permlane32_swap_b32 v42, v46
  v_permlane32_swap_b32 v43, v47
  s_mov_b32 s31, 0x3b000000
  s_mov_b32 s32, 0x3727c5ac
  v_mul_f32 v40, s31, v40
  v_mul_f32 v44, s31, v44
  v_fma_f32 v44, -v40, v40, v44
  v_max_f32 v44, 0, v44
  v_add_f32 v44, s32, v44
  v_rsq_f32 v48, v44
  s_nop 0
  v_mul_f32 v49, v40, v48
  v_mul_f32 v41, s31, v41
  v_mul_f32 v45, s31, v45
  v_fma_f32 v45, -v41, v41, v45
  v_max_f32 v45, 0, v45
  v_add_f32 v45, s32, v45
  v_rsq_f32 v50, v45
  s_nop 0
  v_mul_f32 v51, v41, v50
  v_mul_f32 v42, s31, v42
  v_mul_f32 v46, s31, v46
  v_fma_f32 v46, -v42, v42, v46
  v_max_f32 v46, 0, v46
  v_add_f32 v46, s32, v46
  v_rsq_f32 v52, v46
  s_nop 0
  v_mul_f32 v53, v42, v52
  v_mul_f32 v43, s31, v43
  v_mul_f32 v47, s31, v47
  v_fma_f32 v47, -v43, v43, v47
  v_max_f32 v47, 0, v47
  v_add_f32 v47, s32, v47
  v_rsq_f32 v54, v47
  s_nop 0
  v_mul_f32 v55, v43, v54
  v_lshlrev_b32 v6, 13, v3
  s_lshl_b32 s11, s9, 4
  s_mov_b64 exec, 0x10001
  buffer_store_dwordx2 v[48:49], v6, s[24:27], s11 offen offset:0
  buffer_store_dwordx2 v[50:51], v6, s[24:27], s11 offen offset:8
  s_add_u32 s11, s11, 4096
  buffer_store_dwordx2 v[52:53], v6, s[24:27], s11 offen offset:0
  buffer_store_dwordx2 v[54:55], v6, s[24:27], s11 offen offset:8
  s_endpgm
V1_D:
  s_load_dwordx2 s[4:5], s[0:1], 144
  s_load_dwordx2 s[20:21], s[0:1], 104
  v_lshrrev_b32 v1, 6, v0
  s_nop 0
  v_readfirstlane_b32 s8, v1
  v_and_b32 v1, 63, v0
  v_lshlrev_b32 v2, 4, v1
  v_lshrrev_b32 v3, 4, v1
  v_and_b32 v4, 15, v1
  s_sub_u32 s3, s2, 768
  s_mov_b32 s11, s8
  s_cmp_ge_u32 s3, 24
  s_cbranch_scc1 V1D_hi_7
  s_mul_i32 s9, s3, 0x5556
  s_lshr_b32 s9, s9, 16
  s_mul_i32 s10, s9, 3
  s_sub_u32 s10, s3, s10
  s_mul_i32 s9, s9, 7
  s_lshl_b32 s10, s10, 1
  s_add_u32 s9, s9, s10
  s_add_u32 s10, s9, 1
  s_branch V1D_go_8
V1D_hi_7:
  s_sub_u32 s9, s3, 24
  s_mul_i32 s9, s9, 14
  s_add_u32 s9, s9, 6
  s_add_u32 s10, s9, 7
V1D_go_8:
  s_waitcnt lgkmcnt(0)
  s_mov_b32 s12, s20
  s_mov_b32 s13, s21
  s_mov_b32 s14, 917504
  s_mov_b32 s15, 0x20000
  s_add_u32 s16, s4, 14680064
  s_addc_u32 s17, s5, 0
  s_mov_b32 s18, 917504
  s_mov_b32 s19, 0x20000
  v_lshlrev_b32 v5, 10, v3
  v_lshl_add_u32 v5, v4, 4, v5
  s_lshl_b32 s9, s9, 14
  s_lshl_b32 s10, s10, 14
  s_lshl_b32 s22, s11, 8
  s_add_u32 s9, s9, s22
  s_add_u32 s10, s10, s22
  s_add_u32 s23, s9, 0
  buffer_load_dwordx4 v[8:11], v5, s[12:15], s23 offen
  s_add_u32 s23, s9, 4096
  buffer_load_dwordx4 v[12:15], v5, s[12:15], s23 offen
  s_add_u32 s23, s9, 8192
  buffer_load_dwordx4 v[16:19], v5, s[12:15], s23 offen
  s_add_u32 s23, s9, 12288
  buffer_load_dwordx4 v[20:23], v5, s[12:15], s23 offen
  s_add_u32 s23, s10, 0
  buffer_load_dwordx4 v[24:27], v5, s[12:15], s23 offen
  s_add_u32 s23, s10, 4096
  buffer_load_dwordx4 v[28:31], v5, s[12:15], s23 offen
  s_add_u32 s23, s10, 8192
  buffer_load_dwordx4 v[32:35], v5, s[12:15], s23 offen
  s_add_u32 s23, s10, 12288
  buffer_load_dwordx4 v[36:39], v5, s[12:15], s23 offen
  s_mul_i32 s24, s11, 8704
  v_mul_u32_u24 v6, 272, v3
  v_lshl_add_u32 v6, v4, 4, v6
  v_add_u32 v6, s24, v6
  s_waitcnt vmcnt(7)
  ds_write_b128 v6, v[8:11] offset:0
  s_waitcnt vmcnt(6)
  ds_write_b128 v6, v[12:15] offset:1088
  s_waitcnt vmcnt(5)
  ds_write_b128 v6, v[16:19] offset:2176
  s_waitcnt vmcnt(4)
  ds_write_b128 v6, v[20:23] offset:3264
  s_waitcnt vmcnt(3)
  ds_write_b128 v6, v[24:27] offset:4352
  s_waitcnt vmcnt(2)
  ds_write_b128 v6, v[28:31] offset:5440
  s_waitcnt vmcnt(1)
  ds_write_b128 v6, v[32:35] offset:6528
  s_waitcnt vmcnt(0)
  ds_write_b128 v6, v[36:39] offset:7616
  v_lshlrev_b32 v7, 3, v3
  v_bfe_u32 v5, v1, 2, 2
  v_add_u32 v7, v7, v5
  v_mul_u32_u24 v7, 272, v7
  v_and_b32 v5, 3, v1
  v_lshl_add_u32 v7, v5, 3, v7
  v_add_u32 v7, s24, v7
  s_waitcnt lgkmcnt(0)
  ds_read_b64_tr_b16 v[40:41], v7 offset:0
  ds_read_b64_tr_b16 v[42:43], v7 offset:1088
  ds_read_b64_tr_b16 v[44:45], v7 offset:32
  ds_read_b64_tr_b16 v[46:47], v7 offset:1120
  ds_read_b64_tr_b16 v[48:49], v7 offset:64
  ds_read_b64_tr_b16 v[50:51], v7 offset:1152
  ds_read_b64_tr_b16 v[52:53], v7 offset:96
  ds_read_b64_tr_b16 v[54:55], v7 offset:1184
  ds_read_b64_tr_b16 v[56:57], v7 offset:128
  ds_read_b64_tr_b16 v[58:59], v7 offset:1216
  ds_read_b64_tr_b16 v[60:61], v7 offset:160
  ds_read_b64_tr_b16 v[62:63], v7 offset:1248
  ds_read_b64_tr_b16 v[64:65], v7 offset:192
  ds_read_b64_tr_b16 v[66:67], v7 offset:1280
  ds_read_b64_tr_b16 v[68:69], v7 offset:224
  ds_read_b64_tr_b16 v[70:71], v7 offset:1312
  s_mul_i32 s9, s11, 229376
  s_lshl_b32 s10, s3, 10
  s_add_u32 s9, s9, s10
  s_waitcnt lgkmcnt(14)
  s_add_u32 s10, s9, 0
  buffer_store_dwordx4 v[40:43], v2, s[16:19], s10 offen
  s_waitcnt lgkmcnt(12)
  s_add_u32 s10, s9, 28672
  buffer_store_dwordx4 v[44:47], v2, s[16:19], s10 offen
  s_waitcnt lgkmcnt(10)
  s_add_u32 s10, s9, 57344
  buffer_store_dwordx4 v[48:51], v2, s[16:19], s10 offen
  s_waitcnt lgkmcnt(8)
  s_add_u32 s10, s9, 86016
  buffer_store_dwordx4 v[52:55], v2, s[16:19], s10 offen
  s_waitcnt lgkmcnt(6)
  s_add_u32 s10, s9, 114688
  buffer_store_dwordx4 v[56:59], v2, s[16:19], s10 offen
  s_waitcnt lgkmcnt(4)
  s_add_u32 s10, s9, 143360
  buffer_store_dwordx4 v[60:63], v2, s[16:19], s10 offen
  s_waitcnt lgkmcnt(2)
  s_add_u32 s10, s9, 172032
  buffer_store_dwordx4 v[64:67], v2, s[16:19], s10 offen
  s_waitcnt lgkmcnt(0)
  s_add_u32 s10, s9, 200704
  buffer_store_dwordx4 v[68:71], v2, s[16:19], s10 offen
  s_endpgm
V1_E:
  s_load_dwordx2 s[6:7], s[0:1], 144
  v_lshlrev_b32 v1, 4, v0
  v_mov_b32 v4, 0
  v_mov_b32 v5, 0
  v_mov_b32 v6, 0
  v_mov_b32 v7, 0
  s_waitcnt lgkmcnt(0)
  s_cmp_gt_u32 s2, 796
  s_cbranch_scc1 V1E_p_9
  s_add_u32 s12, s6, 196608
  s_addc_u32 s13, s7, 0
  s_mov_b32 s14, 32768
  s_mov_b32 s15, 0x20000
  s_mov_b32 s8, 0
  buffer_store_dwordx4 v[4:7], v1, s[12:15], s8 offen
  s_mov_b32 s8, 4096
  buffer_store_dwordx4 v[4:7], v1, s[12:15], s8 offen
  s_mov_b32 s8, 8192
  buffer_store_dwordx4 v[4:7], v1, s[12:15], s8 offen
  s_mov_b32 s8, 12288
  buffer_store_dwordx4 v[4:7], v1, s[12:15], s8 offen
  s_mov_b32 s8, 16384
  buffer_store_dwordx4 v[4:7], v1, s[12:15], s8 offen
  s_mov_b32 s8, 20480
  buffer_store_dwordx4 v[4:7], v1, s[12:15], s8 offen
  s_mov_b32 s8, 24576
  buffer_store_dwordx4 v[4:7], v1, s[12:15], s8 offen
  s_mov_b32 s8, 28672
  buffer_store_dwordx4 v[4:7], v1, s[12:15], s8 offen
  s_add_u32 s16, s6, 262144
  s_addc_u32 s17, s7, 0
  s_mov_b32 s18, 786432
  s_mov_b32 s19, 0x20000
  v_lshlrev_b32 v2, 12, v0
  buffer_store_dword v4, v2, s[16:19], 0 offen
  s_endpgm
V1E_p_9:
  s_add_u32 s12, s6, 33554432
  s_addc_u32 s13, s7, 0
  s_mov_b32 s14, 262144
  s_mov_b32 s15, 0x20000
  s_sub_u32 s8, s2, 797
  s_lshl_b32 s8, s8, 14
  s_add_u32 s9, s8, 0
  buffer_store_dwordx4 v[4:7], v1, s[12:15], s9 offen
  s_add_u32 s9, s8, 4096
  buffer_store_dwordx4 v[4:7], v1, s[12:15], s9 offen
  s_add_u32 s9, s8, 8192
  buffer_store_dwordx4 v[4:7], v1, s[12:15], s9 offen
  s_add_u32 s9, s8, 12288
  buffer_store_dwordx4 v[4:7], v1, s[12:15], s9 offen
  s_endpgm

.globl k2_conv_kernel
.p2align 8
.type k2_conv_kernel,@function
k2_conv_kernel:
  s_cmp_lt_u32 s2, 256
  s_cbranch_scc1 V2_go
  s_endpgm
V2_go:
  s_load_dwordx2 s[4:5], s[0:1], 144
  s_load_dwordx2 s[6:7], s[0:1], 88
  s_load_dwordx2 s[20:21], s[0:1], 64
  s_load_dwordx2 s[40:41], s[0:1], 80
  v_lshrrev_b32 v1, 6, v0
  s_nop 0
  v_readfirstlane_b32 s8, v1
  v_and_b32 v1, 63, v0
  v_lshlrev_b32 v2, 4, v1
  v_lshrrev_b32 v3, 4, v1
  v_and_b32 v4, 15, v1
  s_cmp_lg_u32 s8, 0
  s_cbranch_scc1 V2_z0_1
  v_lshlrev_b32 v5, 2, v1
  v_add_u32 v5, 67584, v5
  v_mov_b32 v6, 0
  s_mov_b64 exec, 0xffff
  ds_write_b32 v5, v6
  s_mov_b64 exec, -1
  s_waitcnt lgkmcnt(0)
V2_z0_1:
  s_cmp_ge_u32 s8, 8
  s_cbranch_scc1 V2_w
  s_lshr_b32 s9, s8, 2
  s_and_b32 s10, s8, 3
  s_and_b32 s11, s2, 7
  s_lshl_b32 s11, s11, 6
  s_lshr_b32 s12, s2, 3
  s_lshl_b32 s12, s12, 1
  s_add_u32 s11, s11, s12
  s_add_u32 s11, s11, s9
  s_mul_i32 s13, s9, 26112
  v_and_b32 v5, 255, v0
  s_waitcnt lgkmcnt(0)
  s_add_u32 s24, s4, 1048576
  s_addc_u32 s25, s5, 0
  s_mov_b32 s26, 2097152
  s_mov_b32 s27, 0x20000
  s_add_u32 s28, s4, 16384
  s_addc_u32 s29, s5, 0
  s_mov_b32 s30, 16384
  s_mov_b32 s31, 0x20000
  s_add_u32 s32, s4, 9437184
  s_addc_u32 s33, s5, 0
  s_mov_b32 s34, 2097152
  s_mov_b32 s35, 0x20000
  s_mov_b32 s36, s4
  s_mov_b32 s37, s5
  s_mov_b32 s38, 12288
  s_mov_b32 s39, 0x20000
  s_add_u32 s44, s4, 4194304
  s_addc_u32 s45, s5, 0
  s_mov_b32 s46, 4259840
  s_mov_b32 s47, 0x20000
  s_lshl_b32 s14, s11, 6
  v_lshrrev_b32 v6, 2, v5
  v_lshlrev_b32 v6, 15, v6
  v_and_b32 v7, 3, v5
  v_lshl_add_u32 v6, v7, 4, v6
  s_mov_b32 s19, 4096
  buffer_load_dwordx4 v[8:11], v6, s[24:27], s14 offen
  v_lshlrev_b32 v6, 4, v5
  v_add_u32 v7, 0x2000, v6
  buffer_load_dwordx4 v[12:15], v6, s[28:31], 0 offen
  buffer_load_dwordx4 v[16:19], v6, s[28:31], s19 offen
  buffer_load_dwordx4 v[20:23], v7, s[28:31], 0 offen
  buffer_load_dwordx4 v[24:27], v7, s[28:31], s19 offen
  s_lshl_b32 s14, s11, 2
  s_add_u32 s16, s4, s14
  s_addc_u32 s17, s5, 0
  s_load_dword s48, s[16:17], 0x0
  s_load_dword s49, s[16:17], 0x800
  s_load_dword s50, s[16:17], 0x1000
  s_lshl_b32 s14, s11, 1
  s_and_b32 s15, s14, 0xfffffffc
  s_add_u32 s16, s20, s15
  s_addc_u32 s17, s21, 0
  s_load_dword s51, s[16:17], 0x0
  s_mul_i32 s14, s11, 8320
  s_and_b32 s15, s10, 1
  s_mul_i32 s15, s15, 4160
  s_add_u32 s14, s14, s15
  s_lshr_b32 s15, s10, 1
  s_lshl_b32 s15, s15, 2
  s_add_u32 s14, s14, s15
  s_mul_i32 s15, s10, 4160
  s_add_u32 s15, s15, s13
  s_add_u32 m0, s15, 0
  s_add_u32 s18, s14, 0
  buffer_load_dwordx4 v2, s[44:47], s18 offen lds
  s_add_u32 m0, s15, 1024
  s_add_u32 s18, s14, 1024
  buffer_load_dwordx4 v2, s[44:47], s18 offen lds
  s_add_u32 m0, s15, 2048
  s_add_u32 s18, s14, 2048
  buffer_load_dwordx4 v2, s[44:47], s18 offen lds
  s_add_u32 m0, s15, 3072
  s_add_u32 s18, s14, 3072
  buffer_load_dwordx4 v2, s[44:47], s18 offen lds
  s_barrier
  s_lshl_b32 s19, s9, 4
  s_add_u32 s19, s19, 67584
  v_mov_b32 v109, s19
  v_add_u32 v110, 4, v109
  v_add_u32 v112, 8, v109
  v_mov_b32 v28, 0
  v_mov_b32 v29, 0
  v_mov_b32 v30, 0
  v_mov_b32 v31, 0
  s_add_u32 s15, s15, 4096
  v_add_u32 v6, s15, v2
  s_mov_b64 exec, 0xf
  ds_write_b128 v6, v[28:31]
  s_mov_b64 exec, -1
  s_cmp_lg_u32 s10, 0
  s_cbranch_scc1 V2_nz_2
  s_add_u32 s15, s13, 16640
  v_add_u32 v6, s15, v2
  ds_write_b128 v6, v[28:31]
V2_nz_2:
  v_bfe_u32 v6, v5, 4, 1
  v_lshlrev_b32 v6, 1, v6
  v_and_b32 v7, 3, v5
  v_xor_b32 v6, v6, v7
  v_lshlrev_b32 v6, 4, v6
  v_lshrrev_b32 v7, 2, v5
  v_lshl_add_u32 v6, v7, 6, v6
  v_add_u32 v6, s13, v6
  s_and_b32 s14, s10, 1
  s_lshr_b32 s15, s10, 1
  v_and_b32 v104, 3, v4
  v_sub_u32 v104, 3, v104
  v_mul_u32_u24 v104, 4160, v104
  v_lshrrev_b32 v105, 2, v4
  v_lshlrev_b32 v105, 3, v105
  v_sub_u32 v104, v104, v105
  v_lshl_add_u32 v104, v3, 4, v104
  s_lshl_b32 s16, s14, 5
  s_lshl_b32 s17, s15, 9
  s_add_u32 s16, s16, s17
  s_sub_u32 s16, s13, s16
  s_add_u32 s16, s16, 568
  v_add_u32 v104, s16, v104
  s_lshl_b32 s17, s15, 3
  s_sub_u32 s17, 16, s17
  s_add_u32 s18, s13, 16640
  v_add_u32 v105, s17, v4
  v_bfe_u32 v106, v105, 2, 1
  v_lshlrev_b32 v106, 1, v106
  v_xor_b32 v106, v106, v3
  v_lshlrev_b32 v106, 4, v106
  v_lshl_add_u32 v106, v105, 6, v106
  v_add_u32 v96, s18, v106
  v_add_u32 v105, s17, v4
  v_add_u32 v105, -1, v105
  v_bfe_u32 v106, v105, 2, 1
  v_lshlrev_b32 v106, 1, v106
  v_xor_b32 v106, v106, v3
  v_lshlrev_b32 v106, 4, v106
  v_lshl_add_u32 v106, v105, 6, v106
  v_add_u32 v97, s18, v106
  v_add_u32 v105, s17, v4
  v_add_u32 v105, -2, v105
  v_bfe_u32 v106, v105, 2, 1
  v_lshlrev_b32 v106, 1, v106
  v_xor_b32 v106, v106, v3
  v_lshlrev_b32 v106, 4, v106
  v_lshl_add_u32 v106, v105, 6, v106
  v_add_u32 v98, s18, v106
  v_add_u32 v105, s17, v4
  v_add_u32 v105, -3, v105
  v_bfe_u32 v106, v105, 2, 1
  v_lshlrev_b32 v106, 1, v106
  v_xor_b32 v106, v106, v3
  v_lshlrev_b32 v106, 4, v106
  v_lshl_add_u32 v106, v105, 6, v106
  v_add_u32 v99, s18, v106
  v_add_u32 v105, s17, v4
  v_add_u32 v105, -4, v105
  v_bfe_u32 v106, v105, 2, 1
  v_lshlrev_b32 v106, 1, v106
  v_xor_b32 v106, v106, v3
  v_lshlrev_b32 v106, 4, v106
  v_lshl_add_u32 v106, v105, 6, v106
  v_add_u32 v100, s18, v106
  v_add_u32 v105, s17, v4
  v_add_u32 v105, -5, v105
  v_bfe_u32 v106, v105, 2, 1
  v_lshlrev_b32 v106, 1, v106
  v_xor_b32 v106, v106, v3
  v_lshlrev_b32 v106, 4, v106
  v_lshl_add_u32 v106, v105, 6, v106
  v_add_u32 v101, s18, v106
  v_add_u32 v105, s17, v4
  v_add_u32 v105, -6, v105
  v_bfe_u32 v106, v105, 2, 1
  v_lshlrev_b32 v106, 1, v106
  v_xor_b32 v106, v106, v3
  v_lshlrev_b32 v106, 4, v106
  v_lshl_add_u32 v106, v105, 6, v106
  v_add_u32 v102, s18, v106
  v_add_u32 v105, s17, v4
  v_add_u32 v105, -7, v105
  v_bfe_u32 v106, v105, 2, 1
  v_lshlrev_b32 v106, 1, v106
  v_xor_b32 v106, v106, v3
  v_lshlrev_b32 v106, 4, v106
  v_lshl_add_u32 v106, v105, 6, v106
  v_add_u32 v103, s18, v106
  s_waitcnt vmcnt(8)
  ds_write_b128 v6, v[8:11] offset:21760
  v_lshlrev_b32 v36, 16, v8
  v_and_b32 v37, 0xffff0000, v8
  v_lshlrev_b32 v38, 16, v9
  v_and_b32 v39, 0xffff0000, v9
  v_lshlrev_b32 v40, 16, v10
  v_and_b32 v41, 0xffff0000, v10
  v_lshlrev_b32 v42, 16, v11
  v_and_b32 v43, 0xffff0000, v11
  s_waitcnt vmcnt(4) lgkmcnt(0)
  v_mov_b32 v32, s48
  v_mov_b32 v33, s49
  v_mov_b32 v34, s50
  s_and_b32 s16, s11, 1
  s_lshl_b32 s16, s16, 4
  s_lshr_b32 s51, s51, s16
  s_lshl_b32 s51, s51, 16
  v_mov_b32 v35, s51
  v_add_f32 v33, 1.0, v33
  v_fma_f32 v36, v36, v12, -v13
  v_fma_f32 v37, v37, v14, -v15
  v_fma_f32 v38, v38, v16, -v17
  v_fma_f32 v39, v39, v18, -v19
  v_fma_f32 v40, v40, v20, -v21
  v_fma_f32 v41, v41, v22, -v23
  v_fma_f32 v42, v42, v24, -v25
  v_fma_f32 v43, v43, v26, -v27
  v_fma_f32 v36, v36, v33, v32
  v_fma_f32 v37, v37, v33, v32
  v_fma_f32 v38, v38, v33, v32
  v_fma_f32 v39, v39, v33, v32
  v_fma_f32 v40, v40, v33, v32
  v_fma_f32 v41, v41, v33, v32
  v_fma_f32 v42, v42, v33, v32
  v_fma_f32 v43, v43, v33, v32
  v_cvt_pk_bf16_f32 v44, v36, v37
  v_cvt_pk_bf16_f32 v45, v38, v39
  v_cvt_pk_bf16_f32 v46, v40, v41
  v_cvt_pk_bf16_f32 v47, v42, v43
  ds_write_b128 v6, v[44:47] offset:17664
  v_mov_b32 v107, v34
  v_mov_b32 v108, v35
  s_waitcnt vmcnt(0) lgkmcnt(0)
  v_mov_b32 v111, 1
  s_mov_b64 exec, 1
  ds_add_u32 v109, v111
  s_mov_b64 exec, -1
  s_mov_b32 s59, 0
GS_3:
  s_add_u32 s59, s59, 1
  s_cmp_gt_u32 s59, 0x400000
  s_cbranch_scc1 GSo_4
  ds_read_b32 v111, v109
  s_waitcnt lgkmcnt(0)
  v_readfirstlane_b32 s58, v111
  s_cmp_lt_u32 s58, 4
  s_cbranch_scc1 GS_3
GSo_4:
  ds_read_b64 v[32:33], v104 offset:3520
  ds_read_b64 v[34:35], v104 offset:3528
  ds_read_b64 v[36:37], v104 offset:2496
  ds_read_b64 v[38:39], v104 offset:2504
  ds_read_b64 v[40:41], v104 offset:1472
  ds_read_b64 v[42:43], v104 offset:1480
  ds_read_b64 v[44:45], v104 offset:448
  ds_read_b64 v[46:47], v104 offset:456
  ds_read_b128 v[48:51], v96 offset:0
  ds_read_b128 v[52:55], v96 offset:1024
  ds_read_b128 v[56:59], v96 offset:2048
  ds_read_b128 v[60:63], v96 offset:3072
  ds_read_b64 v[64:65], v104 offset:3456
  ds_read_b64 v[66:67], v104 offset:3464
  ds_read_b64 v[68:69], v104 offset:2432
  ds_read_b64 v[70:71], v104 offset:2440
  ds_read_b64 v[72:73], v104 offset:1408
  ds_read_b64 v[74:75], v104 offset:1416
  ds_read_b64 v[76:77], v104 offset:384
  ds_read_b64 v[78:79], v104 offset:392
  ds_read_b128 v[80:83], v97 offset:0
  ds_read_b128 v[84:87], v97 offset:1024
  ds_read_b128 v[88:91], v97 offset:2048
  ds_read_b128 v[92:95], v97 offset:3072
  s_waitcnt lgkmcnt(12)
  v_mfma_f32_16x16x32_bf16 v[16:19], v[32:35], v[48:51], 0
  v_mfma_f32_16x16x32_bf16 v[20:23], v[32:35], v[52:55], 0
  v_mfma_f32_16x16x32_bf16 v[20:23], v[36:39], v[48:51], v[20:23]
  v_mfma_f32_16x16x32_bf16 v[24:27], v[32:35], v[56:59], 0
  v_mfma_f32_16x16x32_bf16 v[24:27], v[36:39], v[52:55], v[24:27]
  v_mfma_f32_16x16x32_bf16 v[24:27], v[40:43], v[48:51], v[24:27]
  v_mfma_f32_16x16x32_bf16 v[28:31], v[32:35], v[60:63], 0
  v_mfma_f32_16x16x32_bf16 v[28:31], v[36:39], v[56:59], v[28:31]
  v_mfma_f32_16x16x32_bf16 v[28:31], v[40:43], v[52:55], v[28:31]
  v_mfma_f32_16x16x32_bf16 v[28:31], v[44:47], v[48:51], v[28:31]
  ds_read_b64 v[32:33], v104 offset:3392
  ds_read_b64 v[34:35], v104 offset:3400
  ds_read_b64 v[36:37], v104 offset:2368
  ds_read_b64 v[38:39], v104 offset:2376
  ds_read_b64 v[40:41], v104 offset:1344
  ds_read_b64 v[42:43], v104 offset:1352
  ds_read_b64 v[44:45], v104 offset:320
  ds_read_b64 v[46:47], v104 offset:328
  ds_read_b128 v[48:51], v98 offset:0
  ds_read_b128 v[52:55], v98 offset:1024
  ds_read_b128 v[56:59], v98 offset:2048
  ds_read_b128 v[60:63], v98 offset:3072
  s_waitcnt lgkmcnt(12)
  v_mfma_f32_16x16x32_bf16 v[16:19], v[64:67], v[80:83], v[16:19]
  v_mfma_f32_16x16x32_bf16 v[20:23], v[64:67], v[84:87], v[20:23]
  v_mfma_f32_16x16x32_bf16 v[20:23], v[68:71], v[80:83], v[20:23]
  v_mfma_f32_16x16x32_bf16 v[24:27], v[64:67], v[88:91], v[24:27]
  v_mfma_f32_16x16x32_bf16 v[24:27], v[68:71], v[84:87], v[24:27]
  v_mfma_f32_16x16x32_bf16 v[24:27], v[72:75], v[80:83], v[24:27]
  v_mfma_f32_16x16x32_bf16 v[28:31], v[64:67], v[92:95], v[28:31]
  v_mfma_f32_16x16x32_bf16 v[28:31], v[68:71], v[88:91], v[28:31]
  v_mfma_f32_16x16x32_bf16 v[28:31], v[72:75], v[84:87], v[28:31]
  v_mfma_f32_16x16x32_bf16 v[28:31], v[76:79], v[80:83], v[28:31]
  ds_read_b64 v[64:65], v104 offset:3328
  ds_read_b64 v[66:67], v104 offset:3336
  ds_read_b64 v[68:69], v104 offset:2304
  ds_read_b64 v[70:71], v104 offset:2312
  ds_read_b64 v[72:73], v104 offset:1280
  ds_read_b64 v[74:75], v104 offset:1288
  ds_read_b64 v[76:77], v104 offset:256
  ds_read_b64 v[78:79], v104 offset:264
  ds_read_b128 v[80:83], v99 offset:0
  ds_read_b128 v[84:87], v99 offset:1024
  ds_read_b128 v[88:91], v99 offset:2048
  ds_read_b128 v[92:95], v99 offset:3072
  s_waitcnt lgkmcnt(12)
  v_mfma_f32_16x16x32_bf16 v[16:19], v[32:35], v[48:51], v[16:19]
  v_mfma_f32_16x16x32_bf16 v[20:23], v[32:35], v[52:55], v[20:23]
  v_mfma_f32_16x16x32_bf16 v[20:23], v[36:39], v[48:51], v[20:23]
  v_mfma_f32_16x16x32_bf16 v[24:27], v[32:35], v[56:59], v[24:27]
  v_mfma_f32_16x16x32_bf16 v[24:27], v[36:39], v[52:55], v[24:27]
  v_mfma_f32_16x16x32_bf16 v[24:27], v[40:43], v[48:51], v[24:27]
  v_mfma_f32_16x16x32_bf16 v[28:31], v[32:35], v[60:63], v[28:31]
  v_mfma_f32_16x16x32_bf16 v[28:31], v[36:39], v[56:59], v[28:31]
  v_mfma_f32_16x16x32_bf16 v[28:31], v[40:43], v[52:55], v[28:31]
  v_mfma_f32_16x16x32_bf16 v[28:31], v[44:47], v[48:51], v[28:31]
  ds_read_b64 v[32:33], v104 offset:3264
  ds_read_b64 v[34:35], v104 offset:3272
  ds_read_b64 v[36:37], v104 offset:2240
  ds_read_b64 v[38:39], v104 offset:2248
  ds_read_b64 v[40:41], v104 offset:1216
  ds_read_b64 v[42:43], v104 offset:1224
  ds_read_b64 v[44:45], v104 offset:192
  ds_read_b64 v[46:47], v104 offset:200
  ds_read_b128 v[48:51], v100 offset:0
  ds_read_b128 v[52:55], v100 offset:1024
  ds_read_b128 v[56:59], v100 offset:2048
  ds_read_b128 v[60:63], v100 offset:3072
  s_waitcnt lgkmcnt(12)
  v_mfma_f32_16x16x32_bf16 v[16:19], v[64:67], v[80:83], v[16:19]
  v_mfma_f32_16x16x32_bf16 v[20:23], v[64:67], v[84:87], v[20:23]
  v_mfma_f32_16x16x32_bf16 v[20:23], v[68:71], v[80:83], v[20:23]
  v_mfma_f32_16x16x32_bf16 v[24:27], v[64:67], v[88:91], v[24:27]
  v_mfma_f32_16x16x32_bf16 v[24:27], v[68:71], v[84:87], v[24:27]
  v_mfma_f32_16x16x32_bf16 v[24:27], v[72:75], v[80:83], v[24:27]
  v_mfma_f32_16x16x32_bf16 v[28:31], v[64:67], v[92:95], v[28:31]
  v_mfma_f32_16x16x32_bf16 v[28:31], v[68:71], v[88:91], v[28:31]
  v_mfma_f32_16x16x32_bf16 v[28:31], v[72:75], v[84:87], v[28:31]
  v_mfma_f32_16x16x32_bf16 v[28:31], v[76:79], v[80:83], v[28:31]
  ds_read_b64 v[64:65], v104 offset:3200
  ds_read_b64 v[66:67], v104 offset:3208
  ds_read_b64 v[68:69], v104 offset:2176
  ds_read_b64 v[70:71], v104 offset:2184
  ds_read_b64 v[72:73], v104 offset:1152
  ds_read_b64 v[74:75], v104 offset:1160
  ds_read_b64 v[76:77], v104 offset:128
  ds_read_b64 v[78:79], v104 offset:136
  ds_read_b128 v[80:83], v101 offset:0
  ds_read_b128 v[84:87], v101 offset:1024
  ds_read_b128 v[88:91], v101 offset:2048
  ds_read_b128 v[92:95], v101 offset:3072
  s_waitcnt lgkmcnt(12)
  v_mfma_f32_16x16x32_bf16 v[16:19], v[32:35], v[48:51], v[16:19]
  v_mfma_f32_16x16x32_bf16 v[20:23], v[32:35], v[52:55], v[20:23]
  v_mfma_f32_16x16x32_bf16 v[20:23], v[36:39], v[48:51], v[20:23]
  v_mfma_f32_16x16x32_bf16 v[24:27], v[32:35], v[56:59], v[24:27]
  v_mfma_f32_16x16x32_bf16 v[24:27], v[36:39], v[52:55], v[24:27]
  v_mfma_f32_16x16x32_bf16 v[24:27], v[40:43], v[48:51], v[24:27]
  v_mfma_f32_16x16x32_bf16 v[28:31], v[32:35], v[60:63], v[28:31]
  v_mfma_f32_16x16x32_bf16 v[28:31], v[36:39], v[56:59], v[28:31]
  v_mfma_f32_16x16x32_bf16 v[28:31], v[40:43], v[52:55], v[28:31]
  v_mfma_f32_16x16x32_bf16 v[28:31], v[44:47], v[48:51], v[28:31]
  ds_read_b64 v[32:33], v104 offset:3136
  ds_read_b64 v[34:35], v104 offset:3144
  ds_read_b64 v[36:37], v104 offset:2112
  ds_read_b64 v[38:39], v104 offset:2120
  ds_read_b64 v[40:41], v104 offset:1088
  ds_read_b64 v[42:43], v104 offset:1096
  ds_read_b64 v[44:45], v104 offset:64
  ds_read_b64 v[46:47], v104 offset:72
  ds_read_b128 v[48:51], v102 offset:0
  ds_read_b128 v[52:55], v102 offset:1024
  ds_read_b128 v[56:59], v102 offset:2048
  ds_read_b128 v[60:63], v102 offset:3072
  s_waitcnt lgkmcnt(12)
  v_mfma_f32_16x16x32_bf16 v[16:19], v[64:67], v[80:83], v[16:19]
  v_mfma_f32_16x16x32_bf16 v[20:23], v[64:67], v[84:87], v[20:23]
  v_mfma_f32_16x16x32_bf16 v[20:23], v[68:71], v[80:83], v[20:23]
  v_mfma_f32_16x16x32_bf16 v[24:27], v[64:67], v[88:91], v[24:27]
  v_mfma_f32_16x16x32_bf16 v[24:27], v[68:71], v[84:87], v[24:27]
  v_mfma_f32_16x16x32_bf16 v[24:27], v[72:75], v[80:83], v[24:27]
  v_mfma_f32_16x16x32_bf16 v[28:31], v[64:67], v[92:95], v[28:31]
  v_mfma_f32_16x16x32_bf16 v[28:31], v[68:71], v[88:91], v[28:31]
  v_mfma_f32_16x16x32_bf16 v[28:31], v[72:75], v[84:87], v[28:31]
  v_mfma_f32_16x16x32_bf16 v[28:31], v[76:79], v[80:83], v[28:31]
  ds_read_b64 v[64:65], v104 offset:3072
  ds_read_b64 v[66:67], v104 offset:3080
  ds_read_b64 v[68:69], v104 offset:2048
  ds_read_b64 v[70:71], v104 offset:2056
  ds_read_b64 v[72:73], v104 offset:1024
  ds_read_b64 v[74:75], v104 offset:1032
  ds_read_b64 v[76:77], v104 offset:0
  ds_read_b64 v[78:79], v104 offset:8
  ds_read_b128 v[80:83], v103 offset:0
  ds_read_b128 v[84:87], v103 offset:1024
  ds_read_b128 v[88:91], v103 offset:2048
  ds_read_b128 v[92:95], v103 offset:3072
  s_waitcnt lgkmcnt(12)
  v_mfma_f32_16x16x32_bf16 v[16:19], v[32:35], v[48:51], v[16:19]
  v_mfma_f32_16x16x32_bf16 v[20:23], v[32:35], v[52:55], v[20:23]
  v_mfma_f32_16x16x32_bf16 v[20:23], v[36:39], v[48:51], v[20:23]
  v_mfma_f32_16x16x32_bf16 v[24:27], v[32:35], v[56:59], v[24:27]
  v_mfma_f32_16x16x32_bf16 v[24:27], v[36:39], v[52:55], v[24:27]
  v_mfma_f32_16x16x32_bf16 v[24:27], v[40:43], v[48:51], v[24:27]
  v_mfma_f32_16x16x32_bf16 v[28:31], v[32:35], v[60:63], v[28:31]
  v_mfma_f32_16x16x32_bf16 v[28:31], v[36:39], v[56:59], v[28:31]
  v_mfma_f32_16x16x32_bf16 v[28:31], v[40:43], v[52:55], v[28:31]
  v_mfma_f32_16x16x32_bf16 v[28:31], v[44:47], v[48:51], v[28:31]
  s_waitcnt lgkmcnt(0)
  v_mfma_f32_16x16x32_bf16 v[16:19], v[64:67], v[80:83], v[16:19]
  v_mfma_f32_16x16x32_bf16 v[20:23], v[64:67], v[84:87], v[20:23]
  v_mfma_f32_16x16x32_bf16 v[20:23], v[68:71], v[80:83], v[20:23]
  v_mfma_f32_16x16x32_bf16 v[24:27], v[64:67], v[88:91], v[24:27]
  v_mfma_f32_16x16x32_bf16 v[24:27], v[68:71], v[84:87], v[24:27]
  v_mfma_f32_16x16x32_bf16 v[24:27], v[72:75], v[80:83], v[24:27]
  v_mfma_f32_16x16x32_bf16 v[28:31], v[64:67], v[92:95], v[28:31]
  v_mfma_f32_16x16x32_bf16 v[28:31], v[68:71], v[88:91], v[28:31]
  v_mfma_f32_16x16x32_bf16 v[28:31], v[72:75], v[84:87], v[28:31]
  v_mfma_f32_16x16x32_bf16 v[28:31], v[76:79], v[80:83], v[28:31]
  v_mov_b32 v111, 1
  s_mov_b64 exec, 1
  ds_add_u32 v110, v111
  s_mov_b64 exec, -1
  s_mov_b32 s59, 0
GS_5:
  s_add_u32 s59, s59, 1
  s_cmp_gt_u32 s59, 0x400000
  s_cbranch_scc1 GSo_6
  ds_read_b32 v111, v110
  s_waitcnt lgkmcnt(0)
  v_readfirstlane_b32 s58, v111
  s_cmp_lt_u32 s58, 4
  s_cbranch_scc1 GS_5
GSo_6:
  s_lshl_b32 s16, s14, 1
  s_sub_u32 s17, 1, s15
  s_add_u32 s16, s16, s17
  s_lshl_b32 s16, s16, 11
  s_add_u32 s16, s16, s13
  v_add_u32 v11, s16, v2
  s_lshl_b32 s16, s14, 1
  s_add_u32 s16, s16, s15
  s_lshl_b32 s16, s16, 11
  s_add_u32 s16, s16, s13
  v_add_u32 v12, s16, v2
  s_cmp_eq_u32 s15, 1
  s_cbranch_scc1 V2_rh1_7
  s_nop 7
  ds_write_b128 v11, v[24:27]
  ds_write_b128 v11, v[28:31] offset:1024
  s_branch V2_ex_8
V2_rh1_7:
  s_nop 7
  ds_write_b128 v11, v[16:19]
  ds_write_b128 v11, v[20:23] offset:1024
  v_mov_b32 v16, v24
  v_mov_b32 v17, v25
  v_mov_b32 v18, v26
  v_mov_b32 v19, v27
  v_mov_b32 v20, v28
  v_mov_b32 v21, v29
  v_mov_b32 v22, v30
  v_mov_b32 v23, v31
V2_ex_8:
  v_bfe_u32 v13, v4, 2, 1
  v_lshlrev_b32 v13, 1, v13
  v_lshrrev_b32 v14, 1, v3
  s_lshl_b32 s16, s14, 1
  v_add_u32 v14, s16, v14
  v_xor_b32 v13, v13, v14
  v_lshlrev_b32 v13, 4, v13
  v_lshl_add_u32 v13, v4, 6, v13
  v_and_b32 v14, 1, v3
  v_lshl_add_u32 v13, v14, 3, v13
  s_lshl_b32 s16, s15, 11
  s_add_u32 s16, s16, s13
  v_add_u32 v13, s16, v13
  ds_read_b64 v[80:81], v13 offset:17664
  ds_read_b64 v[84:85], v13 offset:21760
  ds_read_b64 v[82:83], v13 offset:18688
  ds_read_b64 v[86:87], v13 offset:22784
  v_lshlrev_b32 v14, 6, v4
  v_lshl_add_u32 v14, v3, 3, v14
  s_lshl_b32 s16, s14, 5
  v_add_u32 v14, s16, v14
  s_lshl_b32 s16, s11, 12
  s_lshl_b32 s17, s15, 11
  s_add_u32 s16, s16, s17
  s_waitcnt lgkmcnt(0)
  v_lshlrev_b32 v88, 16, v80
  v_and_b32 v89, 0xffff0000, v80
  v_lshlrev_b32 v92, 16, v84
  v_and_b32 v93, 0xffff0000, v84
  v_lshlrev_b32 v90, 16, v81
  v_and_b32 v91, 0xffff0000, v81
  v_lshlrev_b32 v94, 16, v85
  v_and_b32 v95, 0xffff0000, v85
  v_lshlrev_b32 v96, 16, v82
  v_and_b32 v97, 0xffff0000, v82
  v_lshlrev_b32 v100, 16, v86
  v_and_b32 v101, 0xffff0000, v86
  v_lshlrev_b32 v98, 16, v83
  v_and_b32 v99, 0xffff0000, v83
  v_lshlrev_b32 v102, 16, v87
  v_and_b32 v103, 0xffff0000, v87
  v_mov_b32 v111, 1
  s_mov_b64 exec, 1
  ds_add_u32 v112, v111
  s_mov_b64 exec, -1
  s_mov_b32 s59, 0
GS_9:
  s_add_u32 s59, s59, 1
  s_cmp_gt_u32 s59, 0x400000
  s_cbranch_scc1 GSo_10
  ds_read_b32 v111, v112
  s_waitcnt lgkmcnt(0)
  v_readfirstlane_b32 s58, v111
  s_cmp_lt_u32 s58, 4
  s_cbranch_scc1 GS_9
GSo_10:
  s_lshl_b32 s17, s15, 11
  s_add_u32 s17, s17, s13
  s_add_u32 s17, s17, 8192
  v_add_u32 v15, s17, v14
  ds_read_b128 v[72:75], v12
  ds_read_b128 v[76:79], v12 offset:1024
  s_waitcnt lgkmcnt(0)
  v_add_f32 v16, v16, v72
  v_add_f32 v17, v17, v73
  v_add_f32 v18, v18, v74
  v_add_f32 v19, v19, v75
  v_fma_f32 v16, v88, v108, v16
  v_fma_f32 v17, v89, v108, v17
  v_fma_f32 v18, v90, v108, v18
  v_fma_f32 v19, v91, v108, v19
  v_fma_f32 v16, v16, v107, v92
  v_fma_f32 v17, v17, v107, v93
  v_fma_f32 v18, v18, v107, v94
  v_fma_f32 v19, v19, v107, v95
  v_cvt_pk_bf16_f32 v48, v16, v17
  v_cvt_pk_bf16_f32 v49, v18, v19
  ds_write_b64 v15, v[48:49] offset:0
  v_add_f32 v20, v20, v76
  v_add_f32 v21, v21, v77
  v_add_f32 v22, v22, v78
  v_add_f32 v23, v23, v79
  v_fma_f32 v20, v96, v108, v20
  v_fma_f32 v21, v97, v108, v21
  v_fma_f32 v22, v98, v108, v22
  v_fma_f32 v23, v99, v108, v23
  v_fma_f32 v20, v20, v107, v100
  v_fma_f32 v21, v21, v107, v101
  v_fma_f32 v22, v22, v107, v102
  v_fma_f32 v23, v23, v107, v103
  v_cvt_pk_bf16_f32 v50, v20, v21
  v_cvt_pk_bf16_f32 v51, v22, v23
  ds_write_b64 v15, v[50:51] offset:1024
  s_waitcnt lgkmcnt(0)
  v_add_u32 v112, 4, v112
  v_mov_b32 v111, 1
  s_mov_b64 exec, 1
  ds_add_u32 v112, v111
  s_mov_b64 exec, -1
  s_mov_b32 s59, 0
GS_11:
  s_add_u32 s59, s59, 1
  s_cmp_gt_u32 s59, 0x400000
  s_cbranch_scc1 GSo_12
  ds_read_b32 v111, v112
  s_waitcnt lgkmcnt(0)
  v_readfirstlane_b32 s58, v111
  s_cmp_lt_u32 s58, 4
  s_cbranch_scc1 GS_11
GSo_12:
  s_lshl_b32 s17, s10, 10
  s_add_u32 s16, s17, s13
  s_add_u32 s16, s16, 8192
  v_add_u32 v14, s16, v2
  ds_read_b128 v[52:55], v14
  s_lshl_b32 s16, s11, 12
  s_add_u32 s16, s16, s17
  s_waitcnt lgkmcnt(0)
  buffer_store_dwordx4 v[52:55], v2, s[32:35], s16 offen
  s_endpgm
V2_w:
  s_sub_u32 s17, s8, 8
  s_and_b32 s10, s2, 15
  s_lshr_b32 s11, s2, 4
  v_and_b32 v5, 511, v0
  v_lshrrev_b32 v6, 4, v5
  s_lshl_b32 s12, s10, 5
  v_add_u32 v7, s12, v6
  s_mov_b32 s13, 3584
  v_mul_lo_u32 v8, v7, s13
  v_lshl_add_u32 v8, v4, 4, v8
  s_mul_i32 s16, s11, 224
  v_lshlrev_b32 v7, 2, v7
  s_waitcnt lgkmcnt(0)
  s_mov_b32 s42, 0x1c0000
  s_mov_b32 s43, 0x20000
  s_mov_b32 s36, s4
  s_mov_b32 s37, s5
  s_mov_b32 s38, 12288
  s_mov_b32 s39, 0x20000
  v_cmp_gt_u32 vcc, 14, v4
  s_and_saveexec_b64 s[28:29], vcc
  buffer_load_dwordx4 v[124:127], v8, s[40:43], s16 offen
  s_mov_b64 exec, s[28:29]
  s_mov_b32 s13, 8192
  s_mov_b32 s14, 6144
  buffer_load_dword v8, v7, s[36:39], s13 offen
  v_lshlrev_b32 v9, 4, v3
  s_lshl_b32 s15, s10, 7
  s_add_u32 s15, s15, s14
  buffer_load_dwordx4 v[12:15], v9, s[36:39], s15 offen
  buffer_load_dwordx4 v[16:19], v9, s[36:39], s15 offen offset:64
  s_barrier
  v_mov_b32 v109, 67616
  v_mul_u32_u24 v10, 240, v6
  v_lshl_add_u32 v10, v4, 4, v10
  v_add_u32 v10, 52224, v10
  s_waitcnt vmcnt(2)
  v_add_f32 v8, 1.0, v8
  v_lshlrev_b32 v20, 16, v124
  v_and_b32 v21, 0xffff0000, v124
  v_lshlrev_b32 v22, 16, v125
  v_and_b32 v23, 0xffff0000, v125
  v_lshlrev_b32 v24, 16, v126
  v_and_b32 v25, 0xffff0000, v126
  v_lshlrev_b32 v26, 16, v127
  v_and_b32 v27, 0xffff0000, v127
  v_mul_f32 v20, v20, v8
  v_mul_f32 v21, v21, v8
  v_mul_f32 v22, v22, v8
  v_mul_f32 v23, v23, v8
  v_mul_f32 v24, v24, v8
  v_mul_f32 v25, v25, v8
  v_mul_f32 v26, v26, v8
  v_mul_f32 v27, v27, v8
  v_cvt_pk_bf16_f32 v28, v20, v21
  v_cvt_pk_bf16_f32 v29, v22, v23
  v_cvt_pk_bf16_f32 v30, v24, v25
  v_cvt_pk_bf16_f32 v31, v26, v27
  v_cmp_gt_u32 vcc, 14, v4
  s_and_saveexec_b64 s[28:29], vcc
  ds_write_b128 v10, v[28:31]
  ds_write_b128 v10, v[124:127] offset:7680
  s_mov_b64 exec, s[28:29]
  s_waitcnt vmcnt(0)
  v_cvt_pk_bf16_f32 v32, v12, v13
  v_cvt_pk_bf16_f32 v33, v14, v15
  v_cvt_pk_bf16_f32 v34, v16, v17
  v_cvt_pk_bf16_f32 v35, v18, v19
  v_mov_b32 v36, 0x3f803f80
  v_mov_b32 v37, 0x3f803f80
  v_mov_b32 v38, 0x3f803f80
  v_mov_b32 v39, 0x3f803f80
  s_waitcnt lgkmcnt(0)
  v_mov_b32 v111, 1
  s_mov_b64 exec, 1
  ds_add_u32 v109, v111
  s_mov_b64 exec, -1
  s_mov_b32 s59, 0
GS_13:
  s_add_u32 s59, s59, 1
  s_cmp_gt_u32 s59, 0x400000
  s_cbranch_scc1 GSo_14
  ds_read_b32 v111, v109
  s_waitcnt lgkmcnt(0)
  v_readfirstlane_b32 s58, v111
  s_cmp_lt_u32 s58, 8
  s_cbranch_scc1 GS_13
GSo_14:
  s_cmp_eq_u32 s17, 7
  s_cbranch_scc1 V2_q7_15
  v_bfe_u32 v6, v1, 2, 2
  v_lshl_add_u32 v6, v3, 2, v6
  v_mul_u32_u24 v6, 240, v6
  v_and_b32 v7, 3, v1
  v_lshl_add_u32 v6, v7, 3, v6
  s_lshl_b32 s12, s17, 5
  s_add_u32 s12, s12, 52224
  v_add_u32 v6, s12, v6
  ds_read_b64_tr_b16 v[40:41], v6
  ds_read_b64_tr_b16 v[42:43], v6 offset:3840
  ds_read_b64_tr_b16 v[44:45], v6 offset:7680
  ds_read_b64_tr_b16 v[46:47], v6 offset:11520
  s_add_u32 s20, s4, 12582912
  s_addc_u32 s21, s5, 0
  s_mov_b32 s22, 1835008
  s_mov_b32 s23, 0x20000
  s_add_u32 s24, s4, 34603008
  s_addc_u32 s25, s5, 0
  s_mov_b32 s26, 229376
  s_mov_b32 s27, 0x20000
  s_mul_i32 s12, s11, 7
  s_add_u32 s12, s12, s17
  s_lshl_b32 s13, s12, 4
  s_add_u32 s13, s13, s10
  s_lshl_b32 s13, s13, 10
  s_waitcnt lgkmcnt(2)
  buffer_store_dwordx4 v[40:43], v2, s[20:23], s13 offen
  v_mfma_f32_16x16x32_bf16 v[48:51], v[36:39], v[40:43], 0
  s_waitcnt lgkmcnt(0)
  v_mfma_f32_16x16x32_bf16 v[52:55], v[32:35], v[44:47], 0
  v_lshlrev_b32 v7, 2, v4
  s_lshl_b32 s12, s12, 6
  s_mul_i32 s13, s10, 7168
  s_add_u32 s12, s12, s13
  s_add_u32 s13, s12, 114688
  s_mov_b64 exec, 0xffff
  buffer_store_dword v48, v7, s[24:27], s12 offen
  s_nop 0
  buffer_store_dword v52, v7, s[24:27], s13 offen
  s_mov_b64 exec, -1
V2_q7_15:
  s_and_b32 s9, s2, 3
  s_bfe_u32 s10, s2, 0x10002
  s_lshr_b32 s11, s2, 3
  s_and_b32 s12, s11, 7
  s_lshl_b32 s9, s9, 3
  s_add_u32 s12, s12, s9
  s_lshr_b32 s13, s11, 3
  s_lshl_b32 s10, s10, 2
  s_add_u32 s13, s13, s10
  s_and_b32 s18, s13, 3
  s_lshl_b32 s18, s18, 4
  s_lshl_b32 s19, s12, 6
  s_add_u32 s18, s18, s19
  s_lshl_b32 s19, s17, 1
  s_add_u32 s18, s18, s19
  s_lshl_b32 s18, s18, 12
  s_mov_b32 s28, s6
  s_mov_b32 s29, s7
  s_mov_b32 s30, 8388608
  s_mov_b32 s31, 0x20000
  s_add_u32 s19, s18, 0
  buffer_load_dwordx4 v[64:67], v2, s[28:31], s19 offen
  s_add_u32 s19, s18, 1024
  buffer_load_dwordx4 v[68:71], v2, s[28:31], s19 offen
  s_add_u32 s19, s18, 2048
  buffer_load_dwordx4 v[72:75], v2, s[28:31], s19 offen
  s_add_u32 s19, s18, 3072
  buffer_load_dwordx4 v[76:79], v2, s[28:31], s19 offen
  s_endpgm

.globl k3_mega_kernel
.p2align 8
.type k3_mega_kernel,@function
k3_mega_kernel:
  s_cmp_lt_u32 s2, 256
  s_cbranch_scc1 M4_go
  s_endpgm
M4_go:
  s_load_dwordx2 s[4:5], s[0:1], 144
  s_load_dwordx2 s[6:7], s[0:1], 88
  s_load_dwordx2 s[52:53], s[0:1], 96
  s_load_dwordx2 s[54:55], s[0:1], 128
  v_lshrrev_b32 v1, 6, v0
  s_nop 0
  v_readfirstlane_b32 s8, v1
  v_and_b32 v1, 63, v0
  v_lshlrev_b32 v2, 4, v1
  v_lshrrev_b32 v3, 4, v1
  v_and_b32 v4, 15, v1
  s_waitcnt lgkmcnt(0)
  s_and_b32 s9, s2, 3
  s_bfe_u32 s10, s2, 0x10002
  s_lshr_b32 s11, s2, 3
  s_and_b32 s12, s11, 7
  s_lshl_b32 s9, s9, 3
  s_add_u32 s12, s12, s9
  s_lshr_b32 s13, s11, 3
  s_lshl_b32 s10, s10, 2
  s_add_u32 s13, s13, s10
  s_cmp_ge_u32 s8, 8
  s_cbranch_scc0 Q_cons
  s_sub_u32 s17, s8, 8
  s_add_u32 s20, s4, 9437184
  s_addc_u32 s21, s5, 0
  s_mov_b32 s22, 2097152
  s_mov_b32 s23, 0x20000
  s_add_u32 s24, s4, 12582912
  s_addc_u32 s25, s5, 0
  s_mov_b32 s26, 1835008
  s_mov_b32 s27, 0x20000
  v_lshlrev_b32 v6, 1, v3
  v_and_b32 v7, 7, v1
  v_xor_b32 v6, v6, v7
  v_lshlrev_b32 v6, 4, v6
  v_lshrrev_b32 v7, 3, v1
  v_lshl_add_u32 v8, v7, 12, v6
  s_lshl_b32 s33, s17, 15
  s_lshl_b32 s34, s12, 7
  s_add_u32 s33, s33, s34
  s_lshl_b32 s36, s17, 10
  s_lshl_b32 s19, s17, 11
  s_lshl_b32 s35, s17, 14
  v_add_u32 v12, s35, v2
  s_mul_i32 s37, s13, 7
  s_lshl_b32 s37, s37, 14
  s_add_u32 s38, s37, 917504
  s_add_u32 s28, s4, 34603008
  s_addc_u32 s29, s5, 0
  s_mov_b32 s30, 229376
  s_mov_b32 s31, 0x20000
  s_cmp_eq_u32 s17, 7
  s_cbranch_scc1 Q_q7_1
  s_add_u32 m0, s36, 0
  s_add_u32 s39, s33, 0
  buffer_load_dwordx4 v8, s[20:23], s39 offen sc1 lds
  s_add_u32 m0, s19, 65536
  s_add_u32 s39, s38, 0
  buffer_load_dwordx4 v12, s[24:27], s39 offen sc1 lds
  buffer_load_dwordx4 v12, s[24:27], s39 offen offset:1024 sc1 lds
  s_add_u32 m0, s36, 8192
  s_add_u32 s39, s33, 262144
  buffer_load_dwordx4 v8, s[20:23], s39 offen sc1 lds
  s_add_u32 m0, s19, 79872
  s_add_u32 s39, s38, 2048
  buffer_load_dwordx4 v12, s[24:27], s39 offen sc1 lds
  buffer_load_dwordx4 v12, s[24:27], s39 offen offset:1024 sc1 lds
  s_mul_i32 s40, s17, 14
  v_add_u32 v16, s40, v4
  v_mul_u32_u24 v17, 2341, v16
  v_lshrrev_b32 v17, 16, v17
  v_mul_u32_u24 v18, 28, v17
  v_sub_u32 v18, v16, v18
  v_and_b32 v19, 1, v17
  v_mul_u32_u24 v19, 114688, v19
  v_lshrrev_b32 v20, 1, v17
  v_sub_u32 v20, 1, v20
  v_mul_u32_u24 v20, 3584, v20
  v_add_u32 v19, v19, v20
  v_lshl_add_u32 v19, v18, 4, v19
  v_mul_u32_u24 v20, 28672, v3
  v_add_u32 v19, v19, v20
  s_mul_i32 s40, s13, 448
  s_add_u32 s41, s40, 0
  buffer_load_dwordx4 v[32:35], v19, s[28:31], s41 offen sc1
  s_add_u32 s41, s40, 7168
  buffer_load_dwordx4 v[36:39], v19, s[28:31], s41 offen sc1
  s_add_u32 s41, s40, 14336
  buffer_load_dwordx4 v[40:43], v19, s[28:31], s41 offen sc1
  s_add_u32 s41, s40, 21504
  buffer_load_dwordx4 v[44:47], v19, s[28:31], s41 offen sc1
  s_waitcnt vmcnt(7)
  s_barrier
  s_add_u32 m0, s36, 16384
  s_add_u32 s39, s33, 524288
  buffer_load_dwordx4 v8, s[20:23], s39 offen sc1 lds
  s_add_u32 m0, s19, 94208
  s_add_u32 s39, s38, 4096
  buffer_load_dwordx4 v12, s[24:27], s39 offen sc1 lds
  buffer_load_dwordx4 v12, s[24:27], s39 offen offset:1024 sc1 lds
  s_add_u32 m0, s36, 24576
  s_add_u32 s39, s33, 786432
  buffer_load_dwordx4 v8, s[20:23], s39 offen sc1 lds
  s_add_u32 m0, s19, 108544
  s_add_u32 s39, s38, 6144
  buffer_load_dwordx4 v12, s[24:27], s39 offen sc1 lds
  buffer_load_dwordx4 v12, s[24:27], s39 offen offset:1024 sc1 lds
  s_add_u32 m0, s36, 32768
  s_add_u32 s39, s33, 1048576
  buffer_load_dwordx4 v8, s[20:23], s39 offen sc1 lds
  s_add_u32 m0, s19, 122880
  s_add_u32 s39, s38, 8192
  buffer_load_dwordx4 v12, s[24:27], s39 offen sc1 lds
  buffer_load_dwordx4 v12, s[24:27], s39 offen offset:1024 sc1 lds
  s_waitcnt vmcnt(9)
  v_add_f32 v32, v32, v36
  v_add_f32 v33, v33, v37
  v_add_f32 v34, v34, v38
  v_add_f32 v35, v35, v39
  v_add_f32 v32, v32, v40
  v_add_f32 v33, v33, v41
  v_add_f32 v34, v34, v42
  v_add_f32 v35, v35, v43
  v_add_f32 v32, v32, v44
  v_add_f32 v33, v33, v45
  v_add_f32 v34, v34, v46
  v_add_f32 v35, v35, v47
  v_mov_b32 v36, v32
  v_mov_b32 v37, v33
  v_mov_b32 v38, v34
  v_mov_b32 v39, v35
  v_permlane32_swap_b32 v32, v36
  v_permlane32_swap_b32 v33, v37
  v_permlane32_swap_b32 v34, v38
  v_permlane32_swap_b32 v35, v39
  v_add_f32 v32, v32, v36
  v_add_f32 v33, v33, v37
  v_add_f32 v34, v34, v38
  v_add_f32 v35, v35, v39
  v_mov_b32 v36, v32
  v_mov_b32 v37, v33
  v_mov_b32 v38, v34
  v_mov_b32 v39, v35
  v_permlane16_swap_b32 v32, v36
  v_permlane16_swap_b32 v33, v37
  v_permlane16_swap_b32 v34, v38
  v_permlane16_swap_b32 v35, v39
  v_add_f32 v32, v32, v36
  v_add_f32 v33, v33, v37
  v_add_f32 v34, v34, v38
  v_add_f32 v35, v35, v39
  v_lshlrev_b32 v16, 4, v16
  v_add_u32 v16, 151552, v16
  s_mov_b64 exec, 0x3fff
  ds_write_b128 v16, v[32:35]
  s_mov_b64 exec, -1
  s_waitcnt lgkmcnt(0)
  s_waitcnt vmcnt(13)
  s_barrier
  s_add_u32 m0, s36, 40960
  s_add_u32 s39, s33, 1310720
  buffer_load_dwordx4 v8, s[20:23], s39 offen sc1 lds
  s_add_u32 m0, s19, 137216
  s_add_u32 s39, s38, 10240
  buffer_load_dwordx4 v12, s[24:27], s39 offen sc1 lds
  buffer_load_dwordx4 v12, s[24:27], s39 offen offset:1024 sc1 lds
  s_waitcnt vmcnt(9)
  s_barrier
  s_add_u32 m0, s36, 49152
  s_add_u32 s39, s33, 1572864
  buffer_load_dwordx4 v8, s[20:23], s39 offen sc1 lds
  s_add_u32 m0, s19, 65536
  s_add_u32 s39, s38, 12288
  buffer_load_dwordx4 v12, s[24:27], s39 offen sc1 lds
  buffer_load_dwordx4 v12, s[24:27], s39 offen offset:1024 sc1 lds
  s_waitcnt vmcnt(9)
  s_barrier
  s_add_u32 m0, s36, 57344
  s_add_u32 s39, s33, 1835008
  buffer_load_dwordx4 v8, s[20:23], s39 offen sc1 lds
  s_add_u32 m0, s19, 79872
  s_add_u32 s39, s38, 14336
  buffer_load_dwordx4 v12, s[24:27], s39 offen sc1 lds
  buffer_load_dwordx4 v12, s[24:27], s39 offen offset:1024 sc1 lds
  s_waitcnt vmcnt(9)
  s_barrier
  s_add_u32 m0, s19, 94208
  s_add_u32 s39, s37, 0
  buffer_load_dwordx4 v12, s[24:27], s39 offen sc1 lds
  buffer_load_dwordx4 v12, s[24:27], s39 offen offset:1024 sc1 lds
  s_waitcnt vmcnt(8)
  s_barrier
  s_add_u32 m0, s19, 108544
  s_add_u32 s39, s37, 2048
  buffer_load_dwordx4 v12, s[24:27], s39 offen sc1 lds
  buffer_load_dwordx4 v12, s[24:27], s39 offen offset:1024 sc1 lds
  s_waitcnt vmcnt(7)
  s_barrier
  s_add_u32 m0, s19, 122880
  s_add_u32 s39, s37, 4096
  buffer_load_dwordx4 v12, s[24:27], s39 offen sc1 lds
  buffer_load_dwordx4 v12, s[24:27], s39 offen offset:1024 sc1 lds
  s_waitcnt vmcnt(6)
  s_barrier
  s_add_u32 m0, s19, 137216
  s_add_u32 s39, s37, 6144
  buffer_load_dwordx4 v12, s[24:27], s39 offen sc1 lds
  buffer_load_dwordx4 v12, s[24:27], s39 offen offset:1024 sc1 lds
  s_barrier
  s_add_u32 m0, s19, 65536
  s_add_u32 s39, s37, 8192
  buffer_load_dwordx4 v12, s[24:27], s39 offen sc1 lds
  buffer_load_dwordx4 v12, s[24:27], s39 offen offset:1024 sc1 lds
  s_add_u32 m0, s19, 79872
  s_add_u32 s39, s37, 10240
  buffer_load_dwordx4 v12, s[24:27], s39 offen sc1 lds
  buffer_load_dwordx4 v12, s[24:27], s39 offen offset:1024 sc1 lds
  s_waitcnt vmcnt(10)
  s_barrier
  s_waitcnt vmcnt(8)
  s_barrier
  s_waitcnt vmcnt(6)
  s_barrier
  s_add_u32 m0, s19, 94208
  s_add_u32 s39, s37, 12288
  buffer_load_dwordx4 v12, s[24:27], s39 offen sc1 lds
  buffer_load_dwordx4 v12, s[24:27], s39 offen offset:1024 sc1 lds
  s_waitcnt vmcnt(6)
  s_barrier
  s_add_u32 m0, s19, 108544
  s_add_u32 s39, s37, 14336
  buffer_load_dwordx4 v12, s[24:27], s39 offen sc1 lds
  buffer_load_dwordx4 v12, s[24:27], s39 offen offset:1024 sc1 lds
  s_waitcnt vmcnt(6)
  s_barrier
  s_waitcnt vmcnt(4)
  s_barrier
  s_waitcnt vmcnt(2)
  s_barrier
  s_waitcnt vmcnt(0)
  s_barrier
  s_barrier
  s_branch Q_qj_2
Q_q7_1:
  s_add_u32 m0, s36, 0
  s_add_u32 s39, s33, 0
  buffer_load_dwordx4 v8, s[20:23], s39 offen sc1 lds
  s_add_u32 m0, s36, 8192
  s_add_u32 s39, s33, 262144
  buffer_load_dwordx4 v8, s[20:23], s39 offen sc1 lds
  s_mul_i32 s40, s17, 14
  v_add_u32 v16, s40, v4
  v_mul_u32_u24 v17, 2341, v16
  v_lshrrev_b32 v17, 16, v17
  v_mul_u32_u24 v18, 28, v17
  v_sub_u32 v18, v16, v18
  v_and_b32 v19, 1, v17
  v_mul_u32_u24 v19, 114688, v19
  v_lshrrev_b32 v20, 1, v17
  v_sub_u32 v20, 1, v20
  v_mul_u32_u24 v20, 3584, v20
  v_add_u32 v19, v19, v20
  v_lshl_add_u32 v19, v18, 4, v19
  v_mul_u32_u24 v20, 28672, v3
  v_add_u32 v19, v19, v20
  s_mul_i32 s40, s13, 448
  s_add_u32 s41, s40, 0
  buffer_load_dwordx4 v[32:35], v19, s[28:31], s41 offen sc1
  s_add_u32 s41, s40, 7168
  buffer_load_dwordx4 v[36:39], v19, s[28:31], s41 offen sc1
  s_add_u32 s41, s40, 14336
  buffer_load_dwordx4 v[40:43], v19, s[28:31], s41 offen sc1
  s_add_u32 s41, s40, 21504
  buffer_load_dwordx4 v[44:47], v19, s[28:31], s41 offen sc1
  s_waitcnt vmcnt(5)
  s_barrier
  s_add_u32 m0, s36, 16384
  s_add_u32 s39, s33, 524288
  buffer_load_dwordx4 v8, s[20:23], s39 offen sc1 lds
  s_add_u32 m0, s36, 24576
  s_add_u32 s39, s33, 786432
  buffer_load_dwordx4 v8, s[20:23], s39 offen sc1 lds
  s_add_u32 m0, s36, 32768
  s_add_u32 s39, s33, 1048576
  buffer_load_dwordx4 v8, s[20:23], s39 offen sc1 lds
  s_waitcnt vmcnt(3)
  v_add_f32 v32, v32, v36
  v_add_f32 v33, v33, v37
  v_add_f32 v34, v34, v38
  v_add_f32 v35, v35, v39
  v_add_f32 v32, v32, v40
  v_add_f32 v33, v33, v41
  v_add_f32 v34, v34, v42
  v_add_f32 v35, v35, v43
  v_add_f32 v32, v32, v44
  v_add_f32 v33, v33, v45
  v_add_f32 v34, v34, v46
  v_add_f32 v35, v35, v47
  v_mov_b32 v36, v32
  v_mov_b32 v37, v33
  v_mov_b32 v38, v34
  v_mov_b32 v39, v35
  v_permlane32_swap_b32 v32, v36
  v_permlane32_swap_b32 v33, v37
  v_permlane32_swap_b32 v34, v38
  v_permlane32_swap_b32 v35, v39
  v_add_f32 v32, v32, v36
  v_add_f32 v33, v33, v37
  v_add_f32 v34, v34, v38
  v_add_f32 v35, v35, v39
  v_mov_b32 v36, v32
  v_mov_b32 v37, v33
  v_mov_b32 v38, v34
  v_mov_b32 v39, v35
  v_permlane16_swap_b32 v32, v36
  v_permlane16_swap_b32 v33, v37
  v_permlane16_swap_b32 v34, v38
  v_permlane16_swap_b32 v35, v39
  v_add_f32 v32, v32, v36
  v_add_f32 v33, v33, v37
  v_add_f32 v34, v34, v38
  v_add_f32 v35, v35, v39
  v_lshlrev_b32 v16, 4, v16
  v_add_u32 v16, 151552, v16
  s_mov_b64 exec, 0x3fff
  ds_write_b128 v16, v[32:35]
  s_mov_b64 exec, -1
  s_waitcnt lgkmcnt(0)
  s_waitcnt vmcnt(7)
  s_barrier
  s_add_u32 m0, s36, 40960
  s_add_u32 s39, s33, 1310720
  buffer_load_dwordx4 v8, s[20:23], s39 offen sc1 lds
  s_waitcnt vmcnt(3)
  s_barrier
  s_add_u32 m0, s36, 49152
  s_add_u32 s39, s33, 1572864
  buffer_load_dwordx4 v8, s[20:23], s39 offen sc1 lds
  s_waitcnt vmcnt(3)
  s_barrier
  s_add_u32 m0, s36, 57344
  s_add_u32 s39, s33, 1835008
  buffer_load_dwordx4 v8, s[20:23], s39 offen sc1 lds
  s_waitcnt vmcnt(3)
  s_barrier
  s_waitcnt vmcnt(2)
  s_barrier
  s_waitcnt vmcnt(1)
  s_barrier
  s_waitcnt vmcnt(0)
  s_barrier
  s_barrier
  s_waitcnt vmcnt(0)
  s_barrier
  s_waitcnt vmcnt(0)
  s_barrier
  s_waitcnt vmcnt(0)
  s_barrier
  s_waitcnt vmcnt(0)
  s_barrier
  s_waitcnt vmcnt(0)
  s_barrier
  s_waitcnt vmcnt(0)
  s_barrier
  s_waitcnt vmcnt(0)
  s_barrier
  s_waitcnt vmcnt(0)
  s_barrier
  s_barrier
Q_qj_2:
  s_and_b32 s9, s2, 3
  s_bfe_u32 s10, s2, 0x10002
  s_lshr_b32 s11, s2, 3
  s_and_b32 s12, s11, 7
  s_lshl_b32 s9, s9, 3
  s_add_u32 s12, s12, s9
  s_lshr_b32 s13, s11, 3
  s_lshl_b32 s10, s10, 2
  s_add_u32 s13, s13, s10
  s_sub_u32 s17, s8, 8
  s_lshl_b32 s18, s12, 6
  s_lshl_b32 s19, s17, 3
  s_add_u32 s18, s18, s19
  s_lshl_b32 s18, s18, 12
  s_add_u32 s28, s6, s18
  s_addc_u32 s29, s7, 0
  s_mov_b32 s30, 32768
  s_mov_b32 s31, 0x20000
  s_lshl_b32 s18, s17, 2
  v_add_u32 v16, s18, v3
  v_and_b32 v16, 7, v16
  v_and_b32 v17, 7, v1
  v_xor_b32 v16, v16, v17
  v_lshlrev_b32 v16, 4, v16
  v_lshrrev_b32 v17, 3, v1
  v_lshl_add_u32 v18, v17, 12, v16
  s_lshl_b32 s39, s17, 10
  s_add_u32 s39, s39, 14336
  s_mul_i32 s18, s13, 7
  s_lshl_b32 s18, s18, 16
  s_add_u32 s18, s18, 20971520
  s_add_u32 s24, s4, s18
  s_addc_u32 s25, s5, 0
  s_mov_b32 s26, 458752
  s_mov_b32 s27, 0x20000
  s_lshl_b32 s38, s17, 11
  s_lshl_b32 s18, s17, 16
  v_add_u32 v19, s18, v2
  s_add_u32 m0, s39, 0
  s_add_u32 s47, s12, 0
  s_and_b32 s47, s47, 31
  s_lshl_b32 s47, s47, 7
  buffer_load_dwordx4 v18, s[28:31], s47 offen lds
  s_add_u32 m0, s39, 22528
  s_add_u32 s47, s12, 1
  s_and_b32 s47, s47, 31
  s_lshl_b32 s47, s47, 7
  buffer_load_dwordx4 v18, s[28:31], s47 offen lds
  s_add_u32 m0, s39, 45056
  s_add_u32 s47, s12, 2
  s_and_b32 s47, s47, 31
  s_lshl_b32 s47, s47, 7
  buffer_load_dwordx4 v18, s[28:31], s47 offen lds
  s_add_u32 m0, s39, 67584
  s_add_u32 s47, s12, 3
  s_and_b32 s47, s47, 31
  s_lshl_b32 s47, s47, 7
  buffer_load_dwordx4 v18, s[28:31], s47 offen lds
  s_branch Q_pdone
Q_cons:
  s_lshr_b32 s14, s8, 2
  s_and_b32 s17, s8, 3
  v_mov_b32 v5, 153856
  v_mov_b32 v6, 0
  ds_write_b32 v5, v6
  v_bfe_u32 v6, v1, 2, 2
  v_lshl_add_u32 v7, v3, 2, v6
  v_lshrrev_b32 v6, 1, v6
  v_lshl_add_u32 v6, v3, 1, v6
  v_and_b32 v6, 3, v6
  v_lshlrev_b32 v6, 1, v6
  v_bfe_u32 v10, v1, 1, 1
  s_lshl_b32 s19, s17, 1
  v_add_u32 v10, s19, v10
  v_xor_b32 v10, v10, v6
  v_lshlrev_b32 v10, 4, v10
  v_lshl_add_u32 v10, v7, 7, v10
  v_and_b32 v6, 1, v1
  v_lshl_add_u32 v14, v6, 3, v10
  s_lshl_b32 s19, s14, 13
  v_add_u32 v16, s19, v2
  v_mov_b32 v28, 0x3f803f80
  v_mov_b32 v29, 0x3f803f80
  v_mov_b32 v30, 0x3f803f80
  v_mov_b32 v31, 0x3f803f80
  v_mov_b32 v22, 0xbdd2d3e8
  s_and_b32 s31, s13, 3
  s_lshl_b32 s30, s12, 6
  s_lshl_b32 s31, s31, 4
  s_add_u32 s30, s30, s31
  s_lshl_b32 s31, s8, 1
  s_add_u32 s30, s30, s31
  s_lshl_b32 s30, s30, 12
  s_mov_b32 s36, s6
  s_mov_b32 s37, s7
  s_mov_b32 s38, 8388608
  s_mov_b32 s39, 0x20000
  s_cmp_eq_u32 s14, 1
  s_cbranch_scc1 Q_f1_3
  s_waitcnt lgkmcnt(0)
  s_barrier
  v_add_u32 v17, 65536, v16
  ds_read_b64_tr_b16 v[64:65], v14 offset:0
  ds_read_b64_tr_b16 v[66:67], v14 offset:2048
  ds_read_b128 v[68:71], v17 offset:0
  ds_read_b128 v[72:75], v17 offset:2048
  ds_read_b128 v[76:79], v17 offset:4096
  ds_read_b128 v[80:83], v17 offset:6144
  ds_read_b64_tr_b16 v[84:85], v14 offset:4096
  ds_read_b64_tr_b16 v[86:87], v14 offset:6144
  ds_read_b128 v[88:91], v17 offset:1024
  ds_read_b128 v[92:95], v17 offset:3072
  ds_read_b128 v[96:99], v17 offset:5120
  ds_read_b128 v[100:103], v17 offset:7168
  s_barrier
  v_add_u32 v18, 79872, v16
  s_waitcnt lgkmcnt(6)
  v_mfma_f32_16x16x32_bf16 v[40:43], v[68:71], v[64:67], 0
  ds_read_b64_tr_b16 v[104:105], v14 offset:8192
  ds_read_b64_tr_b16 v[106:107], v14 offset:10240
  v_mfma_f32_16x16x32_bf16 v[44:47], v[72:75], v[64:67], 0
  ds_read_b128 v[108:111], v18 offset:0
  ds_read_b128 v[112:115], v18 offset:2048
  v_mfma_f32_16x16x32_bf16 v[48:51], v[76:79], v[64:67], 0
  ds_read_b128 v[116:119], v18 offset:4096
  ds_read_b128 v[120:123], v18 offset:6144
  v_mfma_f32_16x16x32_bf16 v[52:55], v[80:83], v[64:67], 0
  s_waitcnt lgkmcnt(6)
  v_mfma_f32_16x16x32_bf16 v[40:43], v[88:91], v[84:87], v[40:43]
  ds_read_b64_tr_b16 v[64:65], v14 offset:12288
  ds_read_b64_tr_b16 v[66:67], v14 offset:14336
  v_mfma_f32_16x16x32_bf16 v[44:47], v[92:95], v[84:87], v[44:47]
  ds_read_b128 v[68:71], v18 offset:1024
  ds_read_b128 v[72:75], v18 offset:3072
  v_mfma_f32_16x16x32_bf16 v[48:51], v[96:99], v[84:87], v[48:51]
  ds_read_b128 v[76:79], v18 offset:5120
  ds_read_b128 v[80:83], v18 offset:7168
  v_mfma_f32_16x16x32_bf16 v[52:55], v[100:103], v[84:87], v[52:55]
  s_waitcnt lgkmcnt(6)
  s_barrier
  v_add_u32 v17, 94208, v16
  s_waitcnt lgkmcnt(6)
  v_mfma_f32_16x16x32_bf16 v[40:43], v[108:111], v[104:107], v[40:43]
  ds_read_b64_tr_b16 v[84:85], v14 offset:16384
  ds_read_b64_tr_b16 v[86:87], v14 offset:18432
  v_mfma_f32_16x16x32_bf16 v[44:47], v[112:115], v[104:107], v[44:47]
  ds_read_b128 v[88:91], v17 offset:0
  ds_read_b128 v[92:95], v17 offset:2048
  v_mfma_f32_16x16x32_bf16 v[48:51], v[116:119], v[104:107], v[48:51]
  ds_read_b128 v[96:99], v17 offset:4096
  ds_read_b128 v[100:103], v17 offset:6144
  v_mfma_f32_16x16x32_bf16 v[52:55], v[120:123], v[104:107], v[52:55]
  s_waitcnt lgkmcnt(6)
  v_mfma_f32_16x16x32_bf16 v[40:43], v[68:71], v[64:67], v[40:43]
  ds_read_b64_tr_b16 v[104:105], v14 offset:20480
  ds_read_b64_tr_b16 v[106:107], v14 offset:22528
  v_mfma_f32_16x16x32_bf16 v[44:47], v[72:75], v[64:67], v[44:47]
  ds_read_b128 v[108:111], v17 offset:1024
  ds_read_b128 v[112:115], v17 offset:3072
  v_mfma_f32_16x16x32_bf16 v[48:51], v[76:79], v[64:67], v[48:51]
  ds_read_b128 v[116:119], v17 offset:5120
  ds_read_b128 v[120:123], v17 offset:7168
  v_mfma_f32_16x16x32_bf16 v[52:55], v[80:83], v[64:67], v[52:55]
  s_waitcnt lgkmcnt(6)
  s_barrier
  v_add_u32 v18, 108544, v16
  s_waitcnt lgkmcnt(6)
  v_mfma_f32_16x16x32_bf16 v[40:43], v[88:91], v[84:87], v[40:43]
  ds_read_b64_tr_b16 v[64:65], v14 offset:24576
  ds_read_b64_tr_b16 v[66:67], v14 offset:26624
  v_mfma_f32_16x16x32_bf16 v[44:47], v[92:95], v[84:87], v[44:47]
  ds_read_b128 v[68:71], v18 offset:0
  ds_read_b128 v[72:75], v18 offset:2048
  v_mfma_f32_16x16x32_bf16 v[48:51], v[96:99], v[84:87], v[48:51]
  ds_read_b128 v[76:79], v18 offset:4096
  ds_read_b128 v[80:83], v18 offset:6144
  v_mfma_f32_16x16x32_bf16 v[52:55], v[100:103], v[84:87], v[52:55]
  s_waitcnt lgkmcnt(6)
  v_mfma_f32_16x16x32_bf16 v[40:43], v[108:111], v[104:107], v[40:43]
  ds_read_b64_tr_b16 v[84:85], v14 offset:28672
  ds_read_b64_tr_b16 v[86:87], v14 offset:30720
  v_mfma_f32_16x16x32_bf16 v[44:47], v[112:115], v[104:107], v[44:47]
  ds_read_b128 v[88:91], v18 offset:1024
  ds_read_b128 v[92:95], v18 offset:3072
  v_mfma_f32_16x16x32_bf16 v[48:51], v[116:119], v[104:107], v[48:51]
  ds_read_b128 v[96:99], v18 offset:5120
  ds_read_b128 v[100:103], v18 offset:7168
  v_mfma_f32_16x16x32_bf16 v[52:55], v[120:123], v[104:107], v[52:55]
  s_waitcnt lgkmcnt(6)
  s_barrier
  v_add_u32 v17, 122880, v16
  s_waitcnt lgkmcnt(6)
  v_mfma_f32_16x16x32_bf16 v[40:43], v[68:71], v[64:67], v[40:43]
  ds_read_b64_tr_b16 v[104:105], v14 offset:32768
  ds_read_b64_tr_b16 v[106:107], v14 offset:34816
  v_mfma_f32_16x16x32_bf16 v[44:47], v[72:75], v[64:67], v[44:47]
  ds_read_b128 v[108:111], v17 offset:0
  ds_read_b128 v[112:115], v17 offset:2048
  v_mfma_f32_16x16x32_bf16 v[48:51], v[76:79], v[64:67], v[48:51]
  ds_read_b128 v[116:119], v17 offset:4096
  ds_read_b128 v[120:123], v17 offset:6144
  v_mfma_f32_16x16x32_bf16 v[52:55], v[80:83], v[64:67], v[52:55]
  s_waitcnt lgkmcnt(6)
  v_mfma_f32_16x16x32_bf16 v[40:43], v[88:91], v[84:87], v[40:43]
  ds_read_b64_tr_b16 v[64:65], v14 offset:36864
  ds_read_b64_tr_b16 v[66:67], v14 offset:38912
  v_mfma_f32_16x16x32_bf16 v[44:47], v[92:95], v[84:87], v[44:47]
  ds_read_b128 v[68:71], v17 offset:1024
  ds_read_b128 v[72:75], v17 offset:3072
  v_mfma_f32_16x16x32_bf16 v[48:51], v[96:99], v[84:87], v[48:51]
  ds_read_b128 v[76:79], v17 offset:5120
  ds_read_b128 v[80:83], v17 offset:7168
  v_mfma_f32_16x16x32_bf16 v[52:55], v[100:103], v[84:87], v[52:55]
  s_waitcnt lgkmcnt(6)
  s_barrier
  v_add_u32 v18, 137216, v16
  s_waitcnt lgkmcnt(6)
  v_mfma_f32_16x16x32_bf16 v[40:43], v[108:111], v[104:107], v[40:43]
  ds_read_b64_tr_b16 v[84:85], v14 offset:40960
  ds_read_b64_tr_b16 v[86:87], v14 offset:43008
  v_mfma_f32_16x16x32_bf16 v[44:47], v[112:115], v[104:107], v[44:47]
  ds_read_b128 v[88:91], v18 offset:0
  ds_read_b128 v[92:95], v18 offset:2048
  v_mfma_f32_16x16x32_bf16 v[48:51], v[116:119], v[104:107], v[48:51]
  ds_read_b128 v[96:99], v18 offset:4096
  ds_read_b128 v[100:103], v18 offset:6144
  v_mfma_f32_16x16x32_bf16 v[52:55], v[120:123], v[104:107], v[52:55]
  s_waitcnt lgkmcnt(6)
  v_mfma_f32_16x16x32_bf16 v[40:43], v[68:71], v[64:67], v[40:43]
  ds_read_b64_tr_b16 v[104:105], v14 offset:45056
  ds_read_b64_tr_b16 v[106:107], v14 offset:47104
  v_mfma_f32_16x16x32_bf16 v[44:47], v[72:75], v[64:67], v[44:47]
  ds_read_b128 v[108:111], v18 offset:1024
  ds_read_b128 v[112:115], v18 offset:3072
  v_mfma_f32_16x16x32_bf16 v[48:51], v[76:79], v[64:67], v[48:51]
  ds_read_b128 v[116:119], v18 offset:5120
  ds_read_b128 v[120:123], v18 offset:7168
  v_mfma_f32_16x16x32_bf16 v[52:55], v[80:83], v[64:67], v[52:55]
  s_waitcnt lgkmcnt(6)
  s_barrier
  v_add_u32 v17, 65536, v16
  s_waitcnt lgkmcnt(6)
  v_mfma_f32_16x16x32_bf16 v[40:43], v[88:91], v[84:87], v[40:43]
  ds_read_b64_tr_b16 v[64:65], v14 offset:49152
  ds_read_b64_tr_b16 v[66:67], v14 offset:51200
  v_mfma_f32_16x16x32_bf16 v[44:47], v[92:95], v[84:87], v[44:47]
  ds_read_b128 v[68:71], v17 offset:0
  ds_read_b128 v[72:75], v17 offset:2048
  v_mfma_f32_16x16x32_bf16 v[48:51], v[96:99], v[84:87], v[48:51]
  ds_read_b128 v[76:79], v17 offset:4096
  ds_read_b128 v[80:83], v17 offset:6144
  v_mfma_f32_16x16x32_bf16 v[52:55], v[100:103], v[84:87], v[52:55]
  s_waitcnt lgkmcnt(6)
  v_mfma_f32_16x16x32_bf16 v[40:43], v[108:111], v[104:107], v[40:43]
  ds_read_b64_tr_b16 v[84:85], v14 offset:53248
  ds_read_b64_tr_b16 v[86:87], v14 offset:55296
  v_mfma_f32_16x16x32_bf16 v[44:47], v[112:115], v[104:107], v[44:47]
  ds_read_b128 v[88:91], v17 offset:1024
  ds_read_b128 v[92:95], v17 offset:3072
  v_mfma_f32_16x16x32_bf16 v[48:51], v[116:119], v[104:107], v[48:51]
  ds_read_b128 v[96:99], v17 offset:5120
  ds_read_b128 v[100:103], v17 offset:7168
  v_mfma_f32_16x16x32_bf16 v[52:55], v[120:123], v[104:107], v[52:55]
  s_waitcnt lgkmcnt(6)
  s_barrier
  v_add_u32 v18, 79872, v16
  s_waitcnt lgkmcnt(6)
  v_mfma_f32_16x16x32_bf16 v[40:43], v[68:71], v[64:67], v[40:43]
  ds_read_b64_tr_b16 v[104:105], v14 offset:57344
  ds_read_b64_tr_b16 v[106:107], v14 offset:59392
  v_mfma_f32_16x16x32_bf16 v[44:47], v[72:75], v[64:67], v[44:47]
  ds_read_b128 v[108:111], v18 offset:0
  ds_read_b128 v[112:115], v18 offset:2048
  v_mfma_f32_16x16x32_bf16 v[48:51], v[76:79], v[64:67], v[48:51]
  ds_read_b128 v[116:119], v18 offset:4096
  ds_read_b128 v[120:123], v18 offset:6144
  v_mfma_f32_16x16x32_bf16 v[52:55], v[80:83], v[64:67], v[52:55]
  s_waitcnt lgkmcnt(6)
  v_mfma_f32_16x16x32_bf16 v[40:43], v[88:91], v[84:87], v[40:43]
  ds_read_b64_tr_b16 v[64:65], v14 offset:61440
  ds_read_b64_tr_b16 v[66:67], v14 offset:63488
  v_mfma_f32_16x16x32_bf16 v[44:47], v[92:95], v[84:87], v[44:47]
  ds_read_b128 v[68:71], v18 offset:1024
  ds_read_b128 v[72:75], v18 offset:3072
  v_mfma_f32_16x16x32_bf16 v[48:51], v[96:99], v[84:87], v[48:51]
  ds_read_b128 v[76:79], v18 offset:5120
  ds_read_b128 v[80:83], v18 offset:7168
  v_mfma_f32_16x16x32_bf16 v[52:55], v[100:103], v[84:87], v[52:55]
  s_waitcnt lgkmcnt(6)
  v_mfma_f32_16x16x32_bf16 v[40:43], v[108:111], v[104:107], v[40:43]
  v_mfma_f32_16x16x32_bf16 v[44:47], v[112:115], v[104:107], v[44:47]
  v_mfma_f32_16x16x32_bf16 v[48:51], v[116:119], v[104:107], v[48:51]
  v_mfma_f32_16x16x32_bf16 v[52:55], v[120:123], v[104:107], v[52:55]
  s_waitcnt lgkmcnt(0)
  v_mfma_f32_16x16x32_bf16 v[40:43], v[68:71], v[64:67], v[40:43]
  v_mfma_f32_16x16x32_bf16 v[44:47], v[72:75], v[64:67], v[44:47]
  v_mfma_f32_16x16x32_bf16 v[48:51], v[76:79], v[64:67], v[48:51]
  v_mfma_f32_16x16x32_bf16 v[52:55], v[80:83], v[64:67], v[52:55]
  s_nop 7
  s_barrier
  s_add_u32 s31, s30, 4096
  buffer_load_dwordx4 v[8:11], v2, s[36:39], s31 offen
  s_add_u32 s31, s30, 5120
  buffer_load_dwordx4 v[8:11], v2, s[36:39], s31 offen
  s_add_u32 s31, s30, 6144
  buffer_load_dwordx4 v[8:11], v2, s[36:39], s31 offen
  s_add_u32 s31, s30, 7168
  buffer_load_dwordx4 v[8:11], v2, s[36:39], s31 offen
  s_lshl_b32 s19, s17, 4
  v_add_u32 v6, s19, v4
  v_lshlrev_b32 v6, 2, v6
  v_add_u32 v6, 153344, v6
  ds_read_b32 v24, v6
  ds_read_b32 v26, v6 offset:256
  s_mov_b32 s41, 0x3b000000
  s_mov_b32 s42, 0x3727c5ac
  s_waitcnt lgkmcnt(0)
  v_mul_f32 v24, s41, v24
  v_mul_f32 v26, s41, v26
  v_fma_f32 v26, -v24, v24, v26
  v_max_f32 v26, 0, v26
  v_add_f32 v26, s42, v26
  v_rsq_f32 v26, v26
  s_nop 0
  v_mul_f32 v24, v24, v26
  v_sub_f32 v24, 0, v24
  s_lshl_b32 s19, s14, 8
  s_add_u32 s19, s19, 151552
  v_lshlrev_b32 v23, 4, v3
  v_add_u32 v23, s19, v23
  ds_read_b128 v[64:67], v23 offset:0
  ds_read_b128 v[68:71], v23 offset:448
  ds_read_b128 v[72:75], v23 offset:64
  ds_read_b128 v[76:79], v23 offset:512
  ds_read_b128 v[80:83], v23 offset:128
  ds_read_b128 v[84:87], v23 offset:576
  ds_read_b128 v[88:91], v23 offset:192
  ds_read_b128 v[92:95], v23 offset:640
  s_waitcnt lgkmcnt(6)
  v_fma_f32 v68, v24, v64, v68
  v_fma_f32 v69, v24, v65, v69
  v_fma_f32 v70, v24, v66, v70
  v_fma_f32 v71, v24, v67, v71
  v_fma_f32 v40, v26, v40, v68
  v_fma_f32 v41, v26, v41, v69
  v_fma_f32 v42, v26, v42, v70
  v_fma_f32 v43, v26, v43, v71
  s_waitcnt lgkmcnt(4)
  v_fma_f32 v76, v24, v72, v76
  v_fma_f32 v77, v24, v73, v77
  v_fma_f32 v78, v24, v74, v78
  v_fma_f32 v79, v24, v75, v79
  v_fma_f32 v44, v26, v44, v76
  v_fma_f32 v45, v26, v45, v77
  v_fma_f32 v46, v26, v46, v78
  v_fma_f32 v47, v26, v47, v79
  s_waitcnt lgkmcnt(2)
  v_fma_f32 v84, v24, v80, v84
  v_fma_f32 v85, v24, v81, v85
  v_fma_f32 v86, v24, v82, v86
  v_fma_f32 v87, v24, v83, v87
  v_fma_f32 v48, v26, v48, v84
  v_fma_f32 v49, v26, v49, v85
  v_fma_f32 v50, v26, v50, v86
  v_fma_f32 v51, v26, v51, v87
  s_waitcnt lgkmcnt(0)
  v_fma_f32 v92, v24, v88, v92
  v_fma_f32 v93, v24, v89, v93
  v_fma_f32 v94, v24, v90, v94
  v_fma_f32 v95, v24, v91, v95
  v_fma_f32 v52, v26, v52, v92
  v_fma_f32 v53, v26, v53, v93
  v_fma_f32 v54, v26, v54, v94
  v_fma_f32 v55, v26, v55, v95
  v_mul_f32 v96, v40, v40
  v_mul_f32 v97, v41, v41
  v_mul_f32 v98, v42, v42
  v_mul_f32 v99, v43, v43
  v_mul_f32 v100, v44, v44
  v_mul_f32 v101, v45, v45
  v_mul_f32 v102, v46, v46
  v_mul_f32 v103, v47, v47
  v_fmaak_f32 v96, v22, v96, 0xc0135761
  v_fmaak_f32 v97, v22, v97, 0xc0135761
  v_fmaak_f32 v98, v22, v98, 0xc0135761
  v_fmaak_f32 v99, v22, v99, 0xc0135761
  v_fmaak_f32 v100, v22, v100, 0xc0135761
  v_fmaak_f32 v101, v22, v101, 0xc0135761
  v_fmaak_f32 v102, v22, v102, 0xc0135761
  v_fmaak_f32 v103, v22, v103, 0xc0135761
  v_mul_f32 v96, v40, v96
  v_mul_f32 v97, v41, v97
  v_mul_f32 v98, v42, v98
  v_mul_f32 v99, v43, v99
  v_mul_f32 v100, v44, v100
  v_mul_f32 v101, v45, v101
  v_mul_f32 v102, v46, v102
  v_mul_f32 v103, v47, v103
  v_exp_f32 v96, v96
  v_exp_f32 v97, v97
  v_exp_f32 v98, v98
  v_exp_f32 v99, v99
  v_exp_f32 v100, v100
  v_exp_f32 v101, v101
  v_exp_f32 v102, v102
  v_exp_f32 v103, v103
  v_add_f32 v96, 1.0, v96
  v_add_f32 v97, 1.0, v97
  v_add_f32 v98, 1.0, v98
  v_add_f32 v99, 1.0, v99
  v_add_f32 v100, 1.0, v100
  v_add_f32 v101, 1.0, v101
  v_add_f32 v102, 1.0, v102
  v_add_f32 v103, 1.0, v103
  v_rcp_f32 v96, v96
  v_rcp_f32 v97, v97
  v_rcp_f32 v98, v98
  v_rcp_f32 v99, v99
  v_rcp_f32 v100, v100
  v_rcp_f32 v101, v101
  v_rcp_f32 v102, v102
  v_rcp_f32 v103, v103
  v_mul_f32 v40, v40, v96
  v_mul_f32 v41, v41, v97
  v_mul_f32 v42, v42, v98
  v_mul_f32 v43, v43, v99
  v_mul_f32 v44, v44, v100
  v_mul_f32 v45, v45, v101
  v_mul_f32 v46, v46, v102
  v_mul_f32 v47, v47, v103
  v_mul_f32 v96, v48, v48
  v_mul_f32 v97, v49, v49
  v_mul_f32 v98, v50, v50
  v_mul_f32 v99, v51, v51
  v_mul_f32 v100, v52, v52
  v_mul_f32 v101, v53, v53
  v_mul_f32 v102, v54, v54
  v_mul_f32 v103, v55, v55
  v_fmaak_f32 v96, v22, v96, 0xc0135761
  v_fmaak_f32 v97, v22, v97, 0xc0135761
  v_fmaak_f32 v98, v22, v98, 0xc0135761
  v_fmaak_f32 v99, v22, v99, 0xc0135761
  v_fmaak_f32 v100, v22, v100, 0xc0135761
  v_fmaak_f32 v101, v22, v101, 0xc0135761
  v_fmaak_f32 v102, v22, v102, 0xc0135761
  v_fmaak_f32 v103, v22, v103, 0xc0135761
  v_mul_f32 v96, v48, v96
  v_mul_f32 v97, v49, v97
  v_mul_f32 v98, v50, v98
  v_mul_f32 v99, v51, v99
  v_mul_f32 v100, v52, v100
  v_mul_f32 v101, v53, v101
  v_mul_f32 v102, v54, v102
  v_mul_f32 v103, v55, v103
  v_exp_f32 v96, v96
  v_exp_f32 v97, v97
  v_exp_f32 v98, v98
  v_exp_f32 v99, v99
  v_exp_f32 v100, v100
  v_exp_f32 v101, v101
  v_exp_f32 v102, v102
  v_exp_f32 v103, v103
  v_add_f32 v96, 1.0, v96
  v_add_f32 v97, 1.0, v97
  v_add_f32 v98, 1.0, v98
  v_add_f32 v99, 1.0, v99
  v_add_f32 v100, 1.0, v100
  v_add_f32 v101, 1.0, v101
  v_add_f32 v102, 1.0, v102
  v_add_f32 v103, 1.0, v103
  v_rcp_f32 v96, v96
  v_rcp_f32 v97, v97
  v_rcp_f32 v98, v98
  v_rcp_f32 v99, v99
  v_rcp_f32 v100, v100
  v_rcp_f32 v101, v101
  v_rcp_f32 v102, v102
  v_rcp_f32 v103, v103
  v_mul_f32 v48, v48, v96
  v_mul_f32 v49, v49, v97
  v_mul_f32 v50, v50, v98
  v_mul_f32 v51, v51, v99
  v_mul_f32 v52, v52, v100
  v_mul_f32 v53, v53, v101
  v_mul_f32 v54, v54, v102
  v_mul_f32 v55, v55, v103
  v_mov_b32 v18, v40
  v_mul_f32 v19, v40, v40
  v_add_f32 v18, v18, v41
  v_fmac_f32 v19, v41, v41
  v_add_f32 v18, v18, v42
  v_fmac_f32 v19, v42, v42
  v_add_f32 v18, v18, v43
  v_fmac_f32 v19, v43, v43
  v_add_f32 v18, v18, v44
  v_fmac_f32 v19, v44, v44
  v_add_f32 v18, v18, v45
  v_fmac_f32 v19, v45, v45
  v_add_f32 v18, v18, v46
  v_fmac_f32 v19, v46, v46
  v_add_f32 v18, v18, v47
  v_fmac_f32 v19, v47, v47
  v_add_f32 v18, v18, v48
  v_fmac_f32 v19, v48, v48
  v_add_f32 v18, v18, v49
  v_fmac_f32 v19, v49, v49
  v_add_f32 v18, v18, v50
  v_fmac_f32 v19, v50, v50
  v_add_f32 v18, v18, v51
  v_fmac_f32 v19, v51, v51
  v_add_f32 v18, v18, v52
  v_fmac_f32 v19, v52, v52
  v_add_f32 v18, v18, v53
  v_fmac_f32 v19, v53, v53
  v_add_f32 v18, v18, v54
  v_fmac_f32 v19, v54, v54
  v_add_f32 v18, v18, v55
  v_fmac_f32 v19, v55, v55
  v_mov_b32 v20, v18
  s_nop 1
  v_permlane32_swap_b32 v18, v20
  v_add_f32 v18, v18, v20
  v_mov_b32 v20, v18
  s_nop 1
  v_permlane16_swap_b32 v18, v20
  v_add_f32 v18, v18, v20
  v_mov_b32 v20, v19
  s_nop 1
  v_permlane32_swap_b32 v19, v20
  v_add_f32 v19, v19, v20
  v_mov_b32 v20, v19
  s_nop 1
  v_permlane16_swap_b32 v19, v20
  v_add_f32 v19, v19, v20
  v_add_f32 v19, 1.0, v19
  s_add_u32 s44, s4, 33554432
  s_addc_u32 s45, s5, 0
  s_mov_b32 s46, 262144
  s_mov_b32 s47, 0x20000
  v_lshlrev_b32 v6, 3, v4
  s_lshl_b32 s19, s12, 4
  s_lshl_b32 s32, s13, 1
  s_add_u32 s19, s19, s32
  s_add_u32 s19, s19, s14
  s_lshl_b32 s19, s19, 9
  s_lshl_b32 s32, s17, 7
  s_add_u32 s19, s19, s32
  s_mov_b64 exec, 0xffff
  buffer_store_dwordx2 v[18:19], v6, s[44:47], s19 offen sc1
  s_mov_b64 exec, -1
  v_cvt_pk_bf16_f32 v32, v40, v41
  v_cvt_pk_bf16_f32 v33, v42, v43
  v_cvt_pk_bf16_f32 v34, v44, v45
  v_cvt_pk_bf16_f32 v35, v46, v47
  v_cvt_pk_bf16_f32 v36, v48, v49
  v_cvt_pk_bf16_f32 v37, v50, v51
  v_cvt_pk_bf16_f32 v38, v52, v53
  v_cvt_pk_bf16_f32 v39, v54, v55
  s_barrier
  v_lshlrev_b32 v6, 3, v4
  v_lshl_add_u32 v6, v3, 11, v6
  s_lshl_b32 s19, s12, 13
  s_lshl_b32 s32, s17, 7
  s_add_u32 s19, s19, s32
  v_add_u32 v17, 94208, v16
  ds_read_b64_tr_b16 v[84:85], v14 offset:0
  ds_read_b64_tr_b16 v[86:87], v14 offset:2048
  ds_read_b128 v[88:91], v17 offset:0
  ds_read_b128 v[92:95], v17 offset:2048
  ds_read_b128 v[96:99], v17 offset:4096
  ds_read_b128 v[100:103], v17 offset:6144
  ds_read_b64_tr_b16 v[104:105], v14 offset:4096
  ds_read_b64_tr_b16 v[106:107], v14 offset:6144
  ds_read_b128 v[108:111], v17 offset:1024
  ds_read_b128 v[112:115], v17 offset:3072
  ds_read_b128 v[116:119], v17 offset:5120
  ds_read_b128 v[120:123], v17 offset:7168
  s_barrier
  v_add_u32 v18, 108544, v16
  s_waitcnt lgkmcnt(6)
  v_mfma_f32_16x16x32_bf16 v[40:43], v[88:91], v[84:87], 0
  ds_read_b64_tr_b16 v[64:65], v14 offset:8192
  ds_read_b64_tr_b16 v[66:67], v14 offset:10240
  v_mfma_f32_16x16x32_bf16 v[44:47], v[92:95], v[84:87], 0
  ds_read_b128 v[68:71], v18 offset:0
  ds_read_b128 v[72:75], v18 offset:2048
  v_mfma_f32_16x16x32_bf16 v[48:51], v[96:99], v[84:87], 0
  ds_read_b128 v[76:79], v18 offset:4096
  ds_read_b128 v[80:83], v18 offset:6144
  v_mfma_f32_16x16x32_bf16 v[52:55], v[100:103], v[84:87], 0
  s_waitcnt lgkmcnt(6)
  v_mfma_f32_16x16x32_bf16 v[40:43], v[108:111], v[104:107], v[40:43]
  ds_read_b64_tr_b16 v[84:85], v14 offset:12288
  ds_read_b64_tr_b16 v[86:87], v14 offset:14336
  v_mfma_f32_16x16x32_bf16 v[44:47], v[112:115], v[104:107], v[44:47]
  ds_read_b128 v[88:91], v18 offset:1024
  ds_read_b128 v[92:95], v18 offset:3072
  v_mfma_f32_16x16x32_bf16 v[48:51], v[116:119], v[104:107], v[48:51]
  ds_read_b128 v[96:99], v18 offset:5120
  ds_read_b128 v[100:103], v18 offset:7168
  v_mfma_f32_16x16x32_bf16 v[52:55], v[120:123], v[104:107], v[52:55]
  s_waitcnt lgkmcnt(6)
  s_barrier
  v_add_u32 v17, 122880, v16
  s_waitcnt lgkmcnt(6)
  v_mfma_f32_16x16x32_bf16 v[40:43], v[68:71], v[64:67], v[40:43]
  ds_read_b64_tr_b16 v[104:105], v14 offset:16384
  ds_read_b64_tr_b16 v[106:107], v14 offset:18432
  v_mfma_f32_16x16x32_bf16 v[44:47], v[72:75], v[64:67], v[44:47]
  ds_read_b128 v[108:111], v17 offset:0
  ds_read_b128 v[112:115], v17 offset:2048
  v_mfma_f32_16x16x32_bf16 v[48:51], v[76:79], v[64:67], v[48:51]
  ds_read_b128 v[116:119], v17 offset:4096
  ds_read_b128 v[120:123], v17 offset:6144
  v_mfma_f32_16x16x32_bf16 v[52:55], v[80:83], v[64:67], v[52:55]
  s_waitcnt lgkmcnt(6)
  v_mfma_f32_16x16x32_bf16 v[40:43], v[88:91], v[84:87], v[40:43]
  ds_read_b64_tr_b16 v[64:65], v14 offset:20480
  ds_read_b64_tr_b16 v[66:67], v14 offset:22528
  v_mfma_f32_16x16x32_bf16 v[44:47], v[92:95], v[84:87], v[44:47]
  ds_read_b128 v[68:71], v17 offset:1024
  ds_read_b128 v[72:75], v17 offset:3072
  v_mfma_f32_16x16x32_bf16 v[48:51], v[96:99], v[84:87], v[48:51]
  ds_read_b128 v[76:79], v17 offset:5120
  ds_read_b128 v[80:83], v17 offset:7168
  v_mfma_f32_16x16x32_bf16 v[52:55], v[100:103], v[84:87], v[52:55]
  s_waitcnt lgkmcnt(6)
  s_barrier
  buffer_load_dwordx2 v[56:57], v6, s[44:47], s19 offen offset:0 sc0 sc1
  buffer_load_dwordx2 v[58:59], v6, s[44:47], s19 offen offset:512 sc0 sc1
  buffer_load_dwordx2 v[60:61], v6, s[44:47], s19 offen offset:1024 sc0 sc1
  buffer_load_dwordx2 v[62:63], v6, s[44:47], s19 offen offset:1536 sc0 sc1
  v_add_u32 v18, 137216, v16
  s_waitcnt lgkmcnt(6)
  v_mfma_f32_16x16x32_bf16 v[40:43], v[108:111], v[104:107], v[40:43]
  ds_read_b64_tr_b16 v[84:85], v14 offset:24576
  ds_read_b64_tr_b16 v[86:87], v14 offset:26624
  v_mfma_f32_16x16x32_bf16 v[44:47], v[112:115], v[104:107], v[44:47]
  ds_read_b128 v[88:91], v18 offset:0
  ds_read_b128 v[92:95], v18 offset:2048
  v_mfma_f32_16x16x32_bf16 v[48:51], v[116:119], v[104:107], v[48:51]
  ds_read_b128 v[96:99], v18 offset:4096
  ds_read_b128 v[100:103], v18 offset:6144
  v_mfma_f32_16x16x32_bf16 v[52:55], v[120:123], v[104:107], v[52:55]
  s_waitcnt lgkmcnt(6)
  v_mfma_f32_16x16x32_bf16 v[40:43], v[68:71], v[64:67], v[40:43]
  ds_read_b64_tr_b16 v[104:105], v14 offset:28672
  ds_read_b64_tr_b16 v[106:107], v14 offset:30720
  v_mfma_f32_16x16x32_bf16 v[44:47], v[72:75], v[64:67], v[44:47]
  ds_read_b128 v[108:111], v18 offset:1024
  ds_read_b128 v[112:115], v18 offset:3072
  v_mfma_f32_16x16x32_bf16 v[48:51], v[76:79], v[64:67], v[48:51]
  ds_read_b128 v[116:119], v18 offset:5120
  ds_read_b128 v[120:123], v18 offset:7168
  v_mfma_f32_16x16x32_bf16 v[52:55], v[80:83], v[64:67], v[52:55]
  s_waitcnt lgkmcnt(6)
  s_barrier
  s_waitcnt lgkmcnt(6)
  v_mfma_f32_16x16x32_bf16 v[40:43], v[88:91], v[84:87], v[40:43]
  v_mfma_f32_16x16x32_bf16 v[44:47], v[92:95], v[84:87], v[44:47]
  v_mfma_f32_16x16x32_bf16 v[48:51], v[96:99], v[84:87], v[48:51]
  v_mfma_f32_16x16x32_bf16 v[52:55], v[100:103], v[84:87], v[52:55]
  s_waitcnt lgkmcnt(0)
  v_mfma_f32_16x16x32_bf16 v[40:43], v[108:111], v[104:107], v[40:43]
  v_mfma_f32_16x16x32_bf16 v[44:47], v[112:115], v[104:107], v[44:47]
  v_mfma_f32_16x16x32_bf16 v[48:51], v[116:119], v[104:107], v[48:51]
  v_mfma_f32_16x16x32_bf16 v[52:55], v[120:123], v[104:107], v[52:55]
  s_mov_b32 s33, 0
Q_poll_4:
  s_waitcnt vmcnt(0)
  v_min_u32 v20, v57, v59
  v_min_u32 v21, v61, v63
  v_min_u32 v20, v20, v21
  v_cmp_eq_u32 vcc, 0, v20
  s_cbranch_vccz Q_pollo_5
  s_add_u32 s33, s33, 1
  s_cmp_gt_u32 s33, 0x20000
  s_cbranch_scc1 Q_pollo_5
  buffer_load_dwordx2 v[56:57], v6, s[44:47], s19 offen offset:0 sc0 sc1
  buffer_load_dwordx2 v[58:59], v6, s[44:47], s19 offen offset:512 sc0 sc1
  buffer_load_dwordx2 v[60:61], v6, s[44:47], s19 offen offset:1024 sc0 sc1
  buffer_load_dwordx2 v[62:63], v6, s[44:47], s19 offen offset:1536 sc0 sc1
  s_branch Q_poll_4
Q_pollo_5:
  v_add_f32 v56, v56, v58
  v_add_f32 v57, v57, v59
  v_add_f32 v56, v56, v60
  v_add_f32 v57, v57, v61
  v_add_f32 v56, v56, v62
  v_add_f32 v57, v57, v63
  v_mov_b32 v20, v56
  s_nop 1
  v_permlane32_swap_b32 v56, v20
  v_add_f32 v56, v56, v20
  v_mov_b32 v20, v56
  s_nop 1
  v_permlane16_swap_b32 v56, v20
  v_add_f32 v56, v56, v20
  v_mov_b32 v20, v57
  s_nop 1
  v_permlane32_swap_b32 v57, v20
  v_add_f32 v57, v57, v20
  v_mov_b32 v20, v57
  s_nop 1
  v_permlane16_swap_b32 v57, v20
  v_add_f32 v57, v57, v20
  v_add_f32 v57, 0xc1800000, v57
  s_mov_b32 s41, 0x3a924925
  v_mul_f32 v56, s41, v56
  v_mul_f32 v57, s41, v57
  v_fma_f32 v57, -v56, v56, v57
  v_max_f32 v57, 0, v57
  v_add_f32 v57, s42, v57
  v_rsq_f32 v57, v57
  s_nop 0
  v_mul_f32 v56, v56, v57
  v_sub_f32 v56, 0, v56
  s_lshl_b32 s19, s8, 11
  s_add_u32 s19, s19, 0
  v_lshlrev_b32 v6, 5, v4
  v_lshl_add_u32 v6, v3, 3, v6
  v_add_u32 v6, s19, v6
  v_lshlrev_b32 v96, 16, v32
  v_and_b32 v97, 0xffff0000, v32
  v_lshlrev_b32 v98, 16, v33
  v_and_b32 v99, 0xffff0000, v33
  v_fma_f32 v96, v96, v57, v56
  v_fma_f32 v97, v97, v57, v56
  v_fma_f32 v98, v98, v57, v56
  v_fma_f32 v99, v99, v57, v56
  v_cvt_pk_bf16_f32 v100, v96, v97
  v_cvt_pk_bf16_f32 v101, v98, v99
  ds_write_b64 v6, v[100:101] offset:0
  v_lshlrev_b32 v96, 16, v34
  v_and_b32 v97, 0xffff0000, v34
  v_lshlrev_b32 v98, 16, v35
  v_and_b32 v99, 0xffff0000, v35
  v_fma_f32 v96, v96, v57, v56
  v_fma_f32 v97, v97, v57, v56
  v_fma_f32 v98, v98, v57, v56
  v_fma_f32 v99, v99, v57, v56
  v_cvt_pk_bf16_f32 v102, v96, v97
  v_cvt_pk_bf16_f32 v103, v98, v99
  ds_write_b64 v6, v[102:103] offset:512
  v_lshlrev_b32 v96, 16, v36
  v_and_b32 v97, 0xffff0000, v36
  v_lshlrev_b32 v98, 16, v37
  v_and_b32 v99, 0xffff0000, v37
  v_fma_f32 v96, v96, v57, v56
  v_fma_f32 v97, v97, v57, v56
  v_fma_f32 v98, v98, v57, v56
  v_fma_f32 v99, v99, v57, v56
  v_cvt_pk_bf16_f32 v104, v96, v97
  v_cvt_pk_bf16_f32 v105, v98, v99
  ds_write_b64 v6, v[104:105] offset:1024
  v_lshlrev_b32 v96, 16, v38
  v_and_b32 v97, 0xffff0000, v38
  v_lshlrev_b32 v98, 16, v39
  v_and_b32 v99, 0xffff0000, v39
  v_fma_f32 v96, v96, v57, v56
  v_fma_f32 v97, v97, v57, v56
  v_fma_f32 v98, v98, v57, v56
  v_fma_f32 v99, v99, v57, v56
  v_cvt_pk_bf16_f32 v106, v96, v97
  v_cvt_pk_bf16_f32 v107, v98, v99
  ds_write_b64 v6, v[106:107] offset:1536
  v_lshrrev_b32 v7, 5, v1
  v_lshlrev_b32 v7, 9, v7
  v_and_b32 v10, 1, v3
  v_lshlrev_b32 v10, 3, v10
  v_bfe_u32 v11, v1, 2, 2
  v_add_u32 v10, v10, v11
  v_lshl_add_u32 v7, v10, 5, v7
  v_and_b32 v10, 3, v1
  v_lshl_add_u32 v7, v10, 3, v7
  v_add_u32 v7, s19, v7
  s_add_u32 s48, s4, 20971520
  s_addc_u32 s49, s5, 0
  s_mov_b32 s50, 3670016
  s_mov_b32 s51, 0x20000
  v_lshrrev_b32 v10, 5, v1
  v_lshlrev_b32 v10, 16, v10
  v_and_b32 v11, 1, v3
  v_lshl_add_u32 v10, v11, 8, v10
  v_lshl_add_u32 v10, v4, 4, v10
  s_mul_i32 s19, s13, 7
  s_lshl_b32 s32, s14, 2
  s_add_u32 s19, s19, s32
  s_lshl_b32 s19, s19, 6
  s_lshl_b32 s32, s12, 1
  s_add_u32 s19, s19, s32
  s_lshr_b32 s32, s17, 1
  s_add_u32 s19, s19, s32
  s_lshl_b32 s19, s19, 10
  s_and_b32 s32, s17, 1
  s_lshl_b32 s32, s32, 9
  s_add_u32 s19, s19, s32
  s_waitcnt lgkmcnt(0)
  ds_read_b64_tr_b16 v[120:121], v7 offset:0
  ds_read_b64_tr_b16 v[122:123], v7 offset:128
  ds_read_b64_tr_b16 v[124:125], v7 offset:1024
  ds_read_b64_tr_b16 v[126:127], v7 offset:1152
  s_waitcnt lgkmcnt(2)
  s_add_u32 s32, s19, 0
  buffer_store_dwordx4 v[120:123], v10, s[48:51], s32 offen sc1
  s_waitcnt lgkmcnt(0)
  s_add_u32 s32, s19, 131072
  buffer_store_dwordx4 v[124:127], v10, s[48:51], s32 offen sc1
  s_mov_b64 exec, -1
  v_add_u32 v17, 65536, v16
  ds_read_b64_tr_b16 v[64:65], v14 offset:32768
  ds_read_b64_tr_b16 v[66:67], v14 offset:34816
  ds_read_b128 v[68:71], v17 offset:0
  ds_read_b128 v[72:75], v17 offset:2048
  ds_read_b128 v[76:79], v17 offset:4096
  ds_read_b128 v[80:83], v17 offset:6144
  ds_read_b64_tr_b16 v[84:85], v14 offset:36864
  ds_read_b64_tr_b16 v[86:87], v14 offset:38912
  ds_read_b128 v[88:91], v17 offset:1024
  ds_read_b128 v[92:95], v17 offset:3072
  ds_read_b128 v[96:99], v17 offset:5120
  ds_read_b128 v[100:103], v17 offset:7168
  s_barrier
  v_add_u32 v18, 79872, v16
  s_waitcnt lgkmcnt(6)
  v_mfma_f32_16x16x32_bf16 v[40:43], v[68:71], v[64:67], v[40:43]
  ds_read_b64_tr_b16 v[104:105], v14 offset:40960
  ds_read_b64_tr_b16 v[106:107], v14 offset:43008
  v_mfma_f32_16x16x32_bf16 v[44:47], v[72:75], v[64:67], v[44:47]
  ds_read_b128 v[108:111], v18 offset:0
  ds_read_b128 v[112:115], v18 offset:2048
  v_mfma_f32_16x16x32_bf16 v[48:51], v[76:79], v[64:67], v[48:51]
  ds_read_b128 v[116:119], v18 offset:4096
  ds_read_b128 v[120:123], v18 offset:6144
  v_mfma_f32_16x16x32_bf16 v[52:55], v[80:83], v[64:67], v[52:55]
  s_waitcnt lgkmcnt(6)
  v_mfma_f32_16x16x32_bf16 v[40:43], v[88:91], v[84:87], v[40:43]
  ds_read_b64_tr_b16 v[64:65], v14 offset:45056
  ds_read_b64_tr_b16 v[66:67], v14 offset:47104
  v_mfma_f32_16x16x32_bf16 v[44:47], v[92:95], v[84:87], v[44:47]
  ds_read_b128 v[68:71], v18 offset:1024
  ds_read_b128 v[72:75], v18 offset:3072
  v_mfma_f32_16x16x32_bf16 v[48:51], v[96:99], v[84:87], v[48:51]
  ds_read_b128 v[76:79], v18 offset:5120
  ds_read_b128 v[80:83], v18 offset:7168
  v_mfma_f32_16x16x32_bf16 v[52:55], v[100:103], v[84:87], v[52:55]
  s_waitcnt lgkmcnt(6)
  s_barrier
  v_add_u32 v17, 94208, v16
  s_waitcnt lgkmcnt(6)
  v_mfma_f32_16x16x32_bf16 v[40:43], v[108:111], v[104:107], v[40:43]
  ds_read_b64_tr_b16 v[84:85], v14 offset:49152
  ds_read_b64_tr_b16 v[86:87], v14 offset:51200
  v_mfma_f32_16x16x32_bf16 v[44:47], v[112:115], v[104:107], v[44:47]
  ds_read_b128 v[88:91], v17 offset:0
  ds_read_b128 v[92:95], v17 offset:2048
  v_mfma_f32_16x16x32_bf16 v[48:51], v[116:119], v[104:107], v[48:51]
  ds_read_b128 v[96:99], v17 offset:4096
  ds_read_b128 v[100:103], v17 offset:6144
  v_mfma_f32_16x16x32_bf16 v[52:55], v[120:123], v[104:107], v[52:55]
  s_waitcnt lgkmcnt(6)
  v_mfma_f32_16x16x32_bf16 v[40:43], v[68:71], v[64:67], v[40:43]
  ds_read_b64_tr_b16 v[104:105], v14 offset:53248
  ds_read_b64_tr_b16 v[106:107], v14 offset:55296
  v_mfma_f32_16x16x32_bf16 v[44:47], v[72:75], v[64:67], v[44:47]
  ds_read_b128 v[108:111], v17 offset:1024
  ds_read_b128 v[112:115], v17 offset:3072
  v_mfma_f32_16x16x32_bf16 v[48:51], v[76:79], v[64:67], v[48:51]
  ds_read_b128 v[116:119], v17 offset:5120
  ds_read_b128 v[120:123], v17 offset:7168
  v_mfma_f32_16x16x32_bf16 v[52:55], v[80:83], v[64:67], v[52:55]
  s_waitcnt lgkmcnt(6)
  s_waitcnt vmcnt(0)
  s_barrier
  s_cmp_lg_u32 s8, 0
  s_cbranch_scc1 Q_flag_6
  s_lshl_b32 s58, s13, 5
  s_add_u32 s58, s58, s12
  s_lshl_b32 s58, s58, 7
  s_add_u32 s60, s4, 196608
  s_addc_u32 s61, s5, 0
  v_mov_b32 v5, s58
  v_mov_b32 v19, 1
  s_mov_b64 exec, 1
  global_store_dword v5, v19, s[60:61] sc0 sc1
  s_mov_b64 exec, -1
Q_flag_6:
  v_add_u32 v18, 108544, v16
  s_waitcnt lgkmcnt(6)
  v_mfma_f32_16x16x32_bf16 v[40:43], v[88:91], v[84:87], v[40:43]
  ds_read_b64_tr_b16 v[64:65], v14 offset:57344
  ds_read_b64_tr_b16 v[66:67], v14 offset:59392
  v_mfma_f32_16x16x32_bf16 v[44:47], v[92:95], v[84:87], v[44:47]
  ds_read_b128 v[68:71], v18 offset:0
  ds_read_b128 v[72:75], v18 offset:2048
  v_mfma_f32_16x16x32_bf16 v[48:51], v[96:99], v[84:87], v[48:51]
  ds_read_b128 v[76:79], v18 offset:4096
  ds_read_b128 v[80:83], v18 offset:6144
  v_mfma_f32_16x16x32_bf16 v[52:55], v[100:103], v[84:87], v[52:55]
  s_waitcnt lgkmcnt(6)
  v_mfma_f32_16x16x32_bf16 v[40:43], v[108:111], v[104:107], v[40:43]
  ds_read_b64_tr_b16 v[84:85], v14 offset:61440
  ds_read_b64_tr_b16 v[86:87], v14 offset:63488
  v_mfma_f32_16x16x32_bf16 v[44:47], v[112:115], v[104:107], v[44:47]
  ds_read_b128 v[88:91], v18 offset:1024
  ds_read_b128 v[92:95], v18 offset:3072
  v_mfma_f32_16x16x32_bf16 v[48:51], v[116:119], v[104:107], v[48:51]
  ds_read_b128 v[96:99], v18 offset:5120
  ds_read_b128 v[100:103], v18 offset:7168
  v_mfma_f32_16x16x32_bf16 v[52:55], v[120:123], v[104:107], v[52:55]
  s_waitcnt lgkmcnt(6)
  v_mfma_f32_16x16x32_bf16 v[40:43], v[68:71], v[64:67], v[40:43]
  v_mfma_f32_16x16x32_bf16 v[44:47], v[72:75], v[64:67], v[44:47]
  v_mfma_f32_16x16x32_bf16 v[48:51], v[76:79], v[64:67], v[48:51]
  v_mfma_f32_16x16x32_bf16 v[52:55], v[80:83], v[64:67], v[52:55]
  s_waitcnt lgkmcnt(0)
  v_mfma_f32_16x16x32_bf16 v[40:43], v[88:91], v[84:87], v[40:43]
  v_mfma_f32_16x16x32_bf16 v[44:47], v[92:95], v[84:87], v[44:47]
  v_mfma_f32_16x16x32_bf16 v[48:51], v[96:99], v[84:87], v[48:51]
  v_mfma_f32_16x16x32_bf16 v[52:55], v[100:103], v[84:87], v[52:55]
  s_barrier
  s_nop 3
  s_lshl_b32 s19, s14, 8
  s_add_u32 s19, s19, 152448
  v_lshlrev_b32 v23, 4, v3
  v_add_u32 v23, s19, v23
  ds_read_b128 v[64:67], v23 offset:0
  ds_read_b128 v[68:71], v23 offset:448
  ds_read_b128 v[72:75], v23 offset:64
  ds_read_b128 v[76:79], v23 offset:512
  ds_read_b128 v[80:83], v23 offset:128
  ds_read_b128 v[84:87], v23 offset:576
  ds_read_b128 v[88:91], v23 offset:192
  ds_read_b128 v[92:95], v23 offset:640
  s_waitcnt lgkmcnt(6)
  v_fma_f32 v68, v24, v64, v68
  v_fma_f32 v69, v24, v65, v69
  v_fma_f32 v70, v24, v66, v70
  v_fma_f32 v71, v24, v67, v71
  v_fma_f32 v40, v26, v40, v68
  v_fma_f32 v41, v26, v41, v69
  v_fma_f32 v42, v26, v42, v70
  v_fma_f32 v43, v26, v43, v71
  s_waitcnt lgkmcnt(4)
  v_fma_f32 v76, v24, v72, v76
  v_fma_f32 v77, v24, v73, v77
  v_fma_f32 v78, v24, v74, v78
  v_fma_f32 v79, v24, v75, v79
  v_fma_f32 v44, v26, v44, v76
  v_fma_f32 v45, v26, v45, v77
  v_fma_f32 v46, v26, v46, v78
  v_fma_f32 v47, v26, v47, v79
  s_waitcnt lgkmcnt(2)
  v_fma_f32 v84, v24, v80, v84
  v_fma_f32 v85, v24, v81, v85
  v_fma_f32 v86, v24, v82, v86
  v_fma_f32 v87, v24, v83, v87
  v_fma_f32 v48, v26, v48, v84
  v_fma_f32 v49, v26, v49, v85
  v_fma_f32 v50, v26, v50, v86
  v_fma_f32 v51, v26, v51, v87
  s_waitcnt lgkmcnt(0)
  v_fma_f32 v92, v24, v88, v92
  v_fma_f32 v93, v24, v89, v93
  v_fma_f32 v94, v24, v90, v94
  v_fma_f32 v95, v24, v91, v95
  v_fma_f32 v52, v26, v52, v92
  v_fma_f32 v53, v26, v53, v93
  v_fma_f32 v54, v26, v54, v94
  v_fma_f32 v55, v26, v55, v95
  v_mul_f32 v96, v40, v40
  v_mul_f32 v97, v41, v41
  v_mul_f32 v98, v42, v42
  v_mul_f32 v99, v43, v43
  v_mul_f32 v100, v44, v44
  v_mul_f32 v101, v45, v45
  v_mul_f32 v102, v46, v46
  v_mul_f32 v103, v47, v47
  v_fmaak_f32 v96, v22, v96, 0xc0135761
  v_fmaak_f32 v97, v22, v97, 0xc0135761
  v_fmaak_f32 v98, v22, v98, 0xc0135761
  v_fmaak_f32 v99, v22, v99, 0xc0135761
  v_fmaak_f32 v100, v22, v100, 0xc0135761
  v_fmaak_f32 v101, v22, v101, 0xc0135761
  v_fmaak_f32 v102, v22, v102, 0xc0135761
  v_fmaak_f32 v103, v22, v103, 0xc0135761
  v_mul_f32 v96, v40, v96
  v_mul_f32 v97, v41, v97
  v_mul_f32 v98, v42, v98
  v_mul_f32 v99, v43, v99
  v_mul_f32 v100, v44, v100
  v_mul_f32 v101, v45, v101
  v_mul_f32 v102, v46, v102
  v_mul_f32 v103, v47, v103
  v_exp_f32 v96, v96
  v_exp_f32 v97, v97
  v_exp_f32 v98, v98
  v_exp_f32 v99, v99
  v_exp_f32 v100, v100
  v_exp_f32 v101, v101
  v_exp_f32 v102, v102
  v_exp_f32 v103, v103
  v_add_f32 v96, 1.0, v96
  v_add_f32 v97, 1.0, v97
  v_add_f32 v98, 1.0, v98
  v_add_f32 v99, 1.0, v99
  v_add_f32 v100, 1.0, v100
  v_add_f32 v101, 1.0, v101
  v_add_f32 v102, 1.0, v102
  v_add_f32 v103, 1.0, v103
  v_rcp_f32 v96, v96
  v_rcp_f32 v97, v97
  v_rcp_f32 v98, v98
  v_rcp_f32 v99, v99
  v_rcp_f32 v100, v100
  v_rcp_f32 v101, v101
  v_rcp_f32 v102, v102
  v_rcp_f32 v103, v103
  v_mul_f32 v40, v40, v96
  v_mul_f32 v41, v41, v97
  v_mul_f32 v42, v42, v98
  v_mul_f32 v43, v43, v99
  v_mul_f32 v44, v44, v100
  v_mul_f32 v45, v45, v101
  v_mul_f32 v46, v46, v102
  v_mul_f32 v47, v47, v103
  v_mul_f32 v96, v48, v48
  v_mul_f32 v97, v49, v49
  v_mul_f32 v98, v50, v50
  v_mul_f32 v99, v51, v51
  v_mul_f32 v100, v52, v52
  v_mul_f32 v101, v53, v53
  v_mul_f32 v102, v54, v54
  v_mul_f32 v103, v55, v55
  v_fmaak_f32 v96, v22, v96, 0xc0135761
  v_fmaak_f32 v97, v22, v97, 0xc0135761
  v_fmaak_f32 v98, v22, v98, 0xc0135761
  v_fmaak_f32 v99, v22, v99, 0xc0135761
  v_fmaak_f32 v100, v22, v100, 0xc0135761
  v_fmaak_f32 v101, v22, v101, 0xc0135761
  v_fmaak_f32 v102, v22, v102, 0xc0135761
  v_fmaak_f32 v103, v22, v103, 0xc0135761
  v_mul_f32 v96, v48, v96
  v_mul_f32 v97, v49, v97
  v_mul_f32 v98, v50, v98
  v_mul_f32 v99, v51, v99
  v_mul_f32 v100, v52, v100
  v_mul_f32 v101, v53, v101
  v_mul_f32 v102, v54, v102
  v_mul_f32 v103, v55, v103
  v_exp_f32 v96, v96
  v_exp_f32 v97, v97
  v_exp_f32 v98, v98
  v_exp_f32 v99, v99
  v_exp_f32 v100, v100
  v_exp_f32 v101, v101
  v_exp_f32 v102, v102
  v_exp_f32 v103, v103
  v_add_f32 v96, 1.0, v96
  v_add_f32 v97, 1.0, v97
  v_add_f32 v98, 1.0, v98
  v_add_f32 v99, 1.0, v99
  v_add_f32 v100, 1.0, v100
  v_add_f32 v101, 1.0, v101
  v_add_f32 v102, 1.0, v102
  v_add_f32 v103, 1.0, v103
  v_rcp_f32 v96, v96
  v_rcp_f32 v97, v97
  v_rcp_f32 v98, v98
  v_rcp_f32 v99, v99
  v_rcp_f32 v100, v100
  v_rcp_f32 v101, v101
  v_rcp_f32 v102, v102
  v_rcp_f32 v103, v103
  v_mul_f32 v48, v48, v96
  v_mul_f32 v49, v49, v97
  v_mul_f32 v50, v50, v98
  v_mul_f32 v51, v51, v99
  v_mul_f32 v52, v52, v100
  v_mul_f32 v53, v53, v101
  v_mul_f32 v54, v54, v102
  v_mul_f32 v55, v55, v103
  v_cvt_pk_bf16_f32 v32, v40, v41
  v_cvt_pk_bf16_f32 v33, v42, v43
  v_cvt_pk_bf16_f32 v34, v44, v45
  v_cvt_pk_bf16_f32 v35, v46, v47
  v_cvt_pk_bf16_f32 v36, v48, v49
  v_cvt_pk_bf16_f32 v37, v50, v51
  v_cvt_pk_bf16_f32 v38, v52, v53
  v_cvt_pk_bf16_f32 v39, v54, v55
  s_branch Q_end
Q_f1_3:
  s_waitcnt lgkmcnt(0)
  s_barrier
  v_add_u32 v17, 65536, v16
  ds_read_b64_tr_b16 v[64:65], v14 offset:0
  ds_read_b64_tr_b16 v[66:67], v14 offset:2048
  ds_read_b128 v[68:71], v17 offset:0
  ds_read_b128 v[72:75], v17 offset:2048
  ds_read_b128 v[76:79], v17 offset:4096
  ds_read_b64_tr_b16 v[84:85], v14 offset:4096
  ds_read_b64_tr_b16 v[86:87], v14 offset:6144
  ds_read_b128 v[88:91], v17 offset:1024
  ds_read_b128 v[92:95], v17 offset:3072
  ds_read_b128 v[96:99], v17 offset:5120
  s_barrier
  v_add_u32 v18, 79872, v16
  s_waitcnt lgkmcnt(5)
  v_mfma_f32_16x16x32_bf16 v[40:43], v[68:71], v[64:67], 0
  ds_read_b64_tr_b16 v[104:105], v14 offset:8192
  ds_read_b64_tr_b16 v[106:107], v14 offset:10240
  v_mfma_f32_16x16x32_bf16 v[56:59], v[64:67], v[64:67], 0
  ds_read_b128 v[108:111], v18 offset:0
  ds_read_b128 v[112:115], v18 offset:2048
  v_mfma_f32_16x16x32_bf16 v[44:47], v[72:75], v[64:67], 0
  ds_read_b128 v[116:119], v18 offset:4096
  v_mfma_f32_16x16x32_bf16 v[60:63], v[28:31], v[64:67], 0
  v_mfma_f32_16x16x32_bf16 v[48:51], v[76:79], v[64:67], 0
  s_waitcnt lgkmcnt(5)
  v_mfma_f32_16x16x32_bf16 v[40:43], v[88:91], v[84:87], v[40:43]
  ds_read_b64_tr_b16 v[64:65], v14 offset:12288
  ds_read_b64_tr_b16 v[66:67], v14 offset:14336
  v_mfma_f32_16x16x32_bf16 v[56:59], v[84:87], v[84:87], v[56:59]
  ds_read_b128 v[68:71], v18 offset:1024
  ds_read_b128 v[72:75], v18 offset:3072
  v_mfma_f32_16x16x32_bf16 v[44:47], v[92:95], v[84:87], v[44:47]
  ds_read_b128 v[76:79], v18 offset:5120
  v_mfma_f32_16x16x32_bf16 v[60:63], v[28:31], v[84:87], v[60:63]
  v_mfma_f32_16x16x32_bf16 v[48:51], v[96:99], v[84:87], v[48:51]
  s_waitcnt lgkmcnt(5)
  s_barrier
  v_add_u32 v17, 94208, v16
  s_waitcnt lgkmcnt(5)
  v_mfma_f32_16x16x32_bf16 v[40:43], v[108:111], v[104:107], v[40:43]
  ds_read_b64_tr_b16 v[84:85], v14 offset:16384
  ds_read_b64_tr_b16 v[86:87], v14 offset:18432
  v_mfma_f32_16x16x32_bf16 v[56:59], v[104:107], v[104:107], v[56:59]
  ds_read_b128 v[88:91], v17 offset:0
  ds_read_b128 v[92:95], v17 offset:2048
  v_mfma_f32_16x16x32_bf16 v[44:47], v[112:115], v[104:107], v[44:47]
  ds_read_b128 v[96:99], v17 offset:4096
  v_mfma_f32_16x16x32_bf16 v[60:63], v[28:31], v[104:107], v[60:63]
  v_mfma_f32_16x16x32_bf16 v[48:51], v[116:119], v[104:107], v[48:51]
  s_waitcnt lgkmcnt(5)
  v_mfma_f32_16x16x32_bf16 v[40:43], v[68:71], v[64:67], v[40:43]
  ds_read_b64_tr_b16 v[104:105], v14 offset:20480
  ds_read_b64_tr_b16 v[106:107], v14 offset:22528
  v_mfma_f32_16x16x32_bf16 v[56:59], v[64:67], v[64:67], v[56:59]
  ds_read_b128 v[108:111], v17 offset:1024
  ds_read_b128 v[112:115], v17 offset:3072
  v_mfma_f32_16x16x32_bf16 v[44:47], v[72:75], v[64:67], v[44:47]
  ds_read_b128 v[116:119], v17 offset:5120
  v_mfma_f32_16x16x32_bf16 v[60:63], v[28:31], v[64:67], v[60:63]
  v_mfma_f32_16x16x32_bf16 v[48:51], v[76:79], v[64:67], v[48:51]
  s_waitcnt lgkmcnt(5)
  s_barrier
  v_add_u32 v18, 108544, v16
  s_waitcnt lgkmcnt(5)
  v_mfma_f32_16x16x32_bf16 v[40:43], v[88:91], v[84:87], v[40:43]
  ds_read_b64_tr_b16 v[64:65], v14 offset:24576
  ds_read_b64_tr_b16 v[66:67], v14 offset:26624
  v_mfma_f32_16x16x32_bf16 v[56:59], v[84:87], v[84:87], v[56:59]
  ds_read_b128 v[68:71], v18 offset:0
  ds_read_b128 v[72:75], v18 offset:2048
  v_mfma_f32_16x16x32_bf16 v[44:47], v[92:95], v[84:87], v[44:47]
  ds_read_b128 v[76:79], v18 offset:4096
  v_mfma_f32_16x16x32_bf16 v[60:63], v[28:31], v[84:87], v[60:63]
  v_mfma_f32_16x16x32_bf16 v[48:51], v[96:99], v[84:87], v[48:51]
  s_waitcnt lgkmcnt(5)
  v_mfma_f32_16x16x32_bf16 v[40:43], v[108:111], v[104:107], v[40:43]
  ds_read_b64_tr_b16 v[84:85], v14 offset:28672
  ds_read_b64_tr_b16 v[86:87], v14 offset:30720
  v_mfma_f32_16x16x32_bf16 v[56:59], v[104:107], v[104:107], v[56:59]
  ds_read_b128 v[88:91], v18 offset:1024
  ds_read_b128 v[92:95], v18 offset:3072
  v_mfma_f32_16x16x32_bf16 v[44:47], v[112:115], v[104:107], v[44:47]
  ds_read_b128 v[96:99], v18 offset:5120
  v_mfma_f32_16x16x32_bf16 v[60:63], v[28:31], v[104:107], v[60:63]
  v_mfma_f32_16x16x32_bf16 v[48:51], v[116:119], v[104:107], v[48:51]
  s_waitcnt lgkmcnt(5)
  s_barrier
  v_add_u32 v17, 122880, v16
  s_waitcnt lgkmcnt(5)
  v_mfma_f32_16x16x32_bf16 v[40:43], v[68:71], v[64:67], v[40:43]
  ds_read_b64_tr_b16 v[104:105], v14 offset:32768
  ds_read_b64_tr_b16 v[106:107], v14 offset:34816
  v_mfma_f32_16x16x32_bf16 v[56:59], v[64:67], v[64:67], v[56:59]
  ds_read_b128 v[108:111], v17 offset:0
  ds_read_b128 v[112:115], v17 offset:2048
  v_mfma_f32_16x16x32_bf16 v[44:47], v[72:75], v[64:67], v[44:47]
  ds_read_b128 v[116:119], v17 offset:4096
  v_mfma_f32_16x16x32_bf16 v[60:63], v[28:31], v[64:67], v[60:63]
  v_mfma_f32_16x16x32_bf16 v[48:51], v[76:79], v[64:67], v[48:51]
  s_waitcnt lgkmcnt(5)
  v_mfma_f32_16x16x32_bf16 v[40:43], v[88:91], v[84:87], v[40:43]
  ds_read_b64_tr_b16 v[64:65], v14 offset:36864
  ds_read_b64_tr_b16 v[66:67], v14 offset:38912
  v_mfma_f32_16x16x32_bf16 v[56:59], v[84:87], v[84:87], v[56:59]
  ds_read_b128 v[68:71], v17 offset:1024
  ds_read_b128 v[72:75], v17 offset:3072
  v_mfma_f32_16x16x32_bf16 v[44:47], v[92:95], v[84:87], v[44:47]
  ds_read_b128 v[76:79], v17 offset:5120
  v_mfma_f32_16x16x32_bf16 v[60:63], v[28:31], v[84:87], v[60:63]
  v_mfma_f32_16x16x32_bf16 v[48:51], v[96:99], v[84:87], v[48:51]
  s_waitcnt lgkmcnt(5)
  s_barrier
  v_add_u32 v18, 137216, v16
  s_waitcnt lgkmcnt(5)
  v_mfma_f32_16x16x32_bf16 v[40:43], v[108:111], v[104:107], v[40:43]
  ds_read_b64_tr_b16 v[84:85], v14 offset:40960
  ds_read_b64_tr_b16 v[86:87], v14 offset:43008
  v_mfma_f32_16x16x32_bf16 v[56:59], v[104:107], v[104:107], v[56:59]
  ds_read_b128 v[88:91], v18 offset:0
  ds_read_b128 v[92:95], v18 offset:2048
  v_mfma_f32_16x16x32_bf16 v[44:47], v[112:115], v[104:107], v[44:47]
  ds_read_b128 v[96:99], v18 offset:4096
  v_mfma_f32_16x16x32_bf16 v[60:63], v[28:31], v[104:107], v[60:63]
  v_mfma_f32_16x16x32_bf16 v[48:51], v[116:119], v[104:107], v[48:51]
  s_waitcnt lgkmcnt(5)
  v_mfma_f32_16x16x32_bf16 v[40:43], v[68:71], v[64:67], v[40:43]
  ds_read_b64_tr_b16 v[104:105], v14 offset:45056
  ds_read_b64_tr_b16 v[106:107], v14 offset:47104
  v_mfma_f32_16x16x32_bf16 v[56:59], v[64:67], v[64:67], v[56:59]
  ds_read_b128 v[108:111], v18 offset:1024
  ds_read_b128 v[112:115], v18 offset:3072
  v_mfma_f32_16x16x32_bf16 v[44:47], v[72:75], v[64:67], v[44:47]
  ds_read_b128 v[116:119], v18 offset:5120
  v_mfma_f32_16x16x32_bf16 v[60:63], v[28:31], v[64:67], v[60:63]
  v_mfma_f32_16x16x32_bf16 v[48:51], v[76:79], v[64:67], v[48:51]
  s_waitcnt lgkmcnt(5)
  s_barrier
  v_add_u32 v17, 65536, v16
  s_waitcnt lgkmcnt(5)
  v_mfma_f32_16x16x32_bf16 v[40:43], v[88:91], v[84:87], v[40:43]
  ds_read_b64_tr_b16 v[64:65], v14 offset:49152
  ds_read_b64_tr_b16 v[66:67], v14 offset:51200
  v_mfma_f32_16x16x32_bf16 v[56:59], v[84:87], v[84:87], v[56:59]
  ds_read_b128 v[68:71], v17 offset:0
  ds_read_b128 v[72:75], v17 offset:2048
  v_mfma_f32_16x16x32_bf16 v[44:47], v[92:95], v[84:87], v[44:47]
  ds_read_b128 v[76:79], v17 offset:4096
  v_mfma_f32_16x16x32_bf16 v[60:63], v[28:31], v[84:87], v[60:63]
  v_mfma_f32_16x16x32_bf16 v[48:51], v[96:99], v[84:87], v[48:51]
  s_waitcnt lgkmcnt(5)
  v_mfma_f32_16x16x32_bf16 v[40:43], v[108:111], v[104:107], v[40:43]
  ds_read_b64_tr_b16 v[84:85], v14 offset:53248
  ds_read_b64_tr_b16 v[86:87], v14 offset:55296
  v_mfma_f32_16x16x32_bf16 v[56:59], v[104:107], v[104:107], v[56:59]
  ds_read_b128 v[88:91], v17 offset:1024
  ds_read_b128 v[92:95], v17 offset:3072
  v_mfma_f32_16x16x32_bf16 v[44:47], v[112:115], v[104:107], v[44:47]
  ds_read_b128 v[96:99], v17 offset:5120
  v_mfma_f32_16x16x32_bf16 v[60:63], v[28:31], v[104:107], v[60:63]
  v_mfma_f32_16x16x32_bf16 v[48:51], v[116:119], v[104:107], v[48:51]
  s_waitcnt lgkmcnt(5)
  s_barrier
  v_add_u32 v18, 79872, v16
  s_waitcnt lgkmcnt(5)
  v_mfma_f32_16x16x32_bf16 v[40:43], v[68:71], v[64:67], v[40:43]
  ds_read_b64_tr_b16 v[104:105], v14 offset:57344
  ds_read_b64_tr_b16 v[106:107], v14 offset:59392
  v_mfma_f32_16x16x32_bf16 v[56:59], v[64:67], v[64:67], v[56:59]
  ds_read_b128 v[108:111], v18 offset:0
  ds_read_b128 v[112:115], v18 offset:2048
  v_mfma_f32_16x16x32_bf16 v[44:47], v[72:75], v[64:67], v[44:47]
  ds_read_b128 v[116:119], v18 offset:4096
  v_mfma_f32_16x16x32_bf16 v[60:63], v[28:31], v[64:67], v[60:63]
  v_mfma_f32_16x16x32_bf16 v[48:51], v[76:79], v[64:67], v[48:51]
  s_waitcnt lgkmcnt(5)
  v_mfma_f32_16x16x32_bf16 v[40:43], v[88:91], v[84:87], v[40:43]
  ds_read_b64_tr_b16 v[64:65], v14 offset:61440
  ds_read_b64_tr_b16 v[66:67], v14 offset:63488
  v_mfma_f32_16x16x32_bf16 v[56:59], v[84:87], v[84:87], v[56:59]
  ds_read_b128 v[68:71], v18 offset:1024
  ds_read_b128 v[72:75], v18 offset:3072
  v_mfma_f32_16x16x32_bf16 v[44:47], v[92:95], v[84:87], v[44:47]
  ds_read_b128 v[76:79], v18 offset:5120
  v_mfma_f32_16x16x32_bf16 v[60:63], v[28:31], v[84:87], v[60:63]
  v_mfma_f32_16x16x32_bf16 v[48:51], v[96:99], v[84:87], v[48:51]
  s_waitcnt lgkmcnt(5)
  v_mfma_f32_16x16x32_bf16 v[40:43], v[108:111], v[104:107], v[40:43]
  v_mfma_f32_16x16x32_bf16 v[56:59], v[104:107], v[104:107], v[56:59]
  v_mfma_f32_16x16x32_bf16 v[44:47], v[112:115], v[104:107], v[44:47]
  v_mfma_f32_16x16x32_bf16 v[60:63], v[28:31], v[104:107], v[60:63]
  v_mfma_f32_16x16x32_bf16 v[48:51], v[116:119], v[104:107], v[48:51]
  s_waitcnt lgkmcnt(0)
  v_mfma_f32_16x16x32_bf16 v[40:43], v[68:71], v[64:67], v[40:43]
  v_mfma_f32_16x16x32_bf16 v[56:59], v[64:67], v[64:67], v[56:59]
  v_mfma_f32_16x16x32_bf16 v[44:47], v[72:75], v[64:67], v[44:47]
  v_mfma_f32_16x16x32_bf16 v[60:63], v[28:31], v[64:67], v[60:63]
  v_mfma_f32_16x16x32_bf16 v[48:51], v[76:79], v[64:67], v[48:51]
  s_nop 7
  v_and_b32 v6, 1, v1
  v_cmp_eq_u32 vcc, 1, v6
  s_nop 1
  v_cndmask_b32 v20, v56, v57, vcc
  v_cndmask_b32 v21, v58, v59, vcc
  v_and_b32 v6, 2, v1
  v_cmp_eq_u32 vcc, 2, v6
  s_nop 1
  v_cndmask_b32 v20, v20, v21, vcc
  s_lshl_b32 s19, s17, 4
  v_add_u32 v6, s19, v4
  v_lshlrev_b32 v6, 2, v6
  v_add_u32 v6, 153344, v6
  v_lshrrev_b32 v7, 2, v4
  v_cmp_eq_u32 vcc, v7, v3
  s_and_saveexec_b64 s[34:35], vcc
  ds_write_b32 v6, v20 offset:256
  s_mov_b64 exec, 0xffff
  ds_write_b32 v6, v60
  s_mov_b64 exec, -1
  s_waitcnt lgkmcnt(0)
  s_barrier
  s_add_u32 s31, s30, 4096
  buffer_load_dwordx4 v[8:11], v2, s[36:39], s31 offen
  s_add_u32 s31, s30, 5120
  buffer_load_dwordx4 v[8:11], v2, s[36:39], s31 offen
  s_add_u32 s31, s30, 6144
  buffer_load_dwordx4 v[8:11], v2, s[36:39], s31 offen
  s_add_u32 s31, s30, 7168
  buffer_load_dwordx4 v[8:11], v2, s[36:39], s31 offen
  s_lshl_b32 s19, s17, 4
  v_add_u32 v6, s19, v4
  v_lshlrev_b32 v6, 2, v6
  v_add_u32 v6, 153344, v6
  ds_read_b32 v24, v6
  ds_read_b32 v26, v6 offset:256
  s_mov_b32 s41, 0x3b000000
  s_mov_b32 s42, 0x3727c5ac
  s_waitcnt lgkmcnt(0)
  v_mul_f32 v24, s41, v24
  v_mul_f32 v26, s41, v26
  v_fma_f32 v26, -v24, v24, v26
  v_max_f32 v26, 0, v26
  v_add_f32 v26, s42, v26
  v_rsq_f32 v26, v26
  s_nop 0
  v_mul_f32 v24, v24, v26
  v_sub_f32 v24, 0, v24
  s_lshl_b32 s19, s14, 8
  s_add_u32 s19, s19, 151552
  v_lshlrev_b32 v23, 4, v3
  v_add_u32 v23, s19, v23
  ds_read_b128 v[64:67], v23 offset:0
  ds_read_b128 v[68:71], v23 offset:448
  ds_read_b128 v[72:75], v23 offset:64
  ds_read_b128 v[76:79], v23 offset:512
  ds_read_b128 v[80:83], v23 offset:128
  ds_read_b128 v[84:87], v23 offset:576
  s_waitcnt lgkmcnt(4)
  v_fma_f32 v68, v24, v64, v68
  v_fma_f32 v69, v24, v65, v69
  v_fma_f32 v70, v24, v66, v70
  v_fma_f32 v71, v24, v67, v71
  v_fma_f32 v40, v26, v40, v68
  v_fma_f32 v41, v26, v41, v69
  v_fma_f32 v42, v26, v42, v70
  v_fma_f32 v43, v26, v43, v71
  s_waitcnt lgkmcnt(2)
  v_fma_f32 v76, v24, v72, v76
  v_fma_f32 v77, v24, v73, v77
  v_fma_f32 v78, v24, v74, v78
  v_fma_f32 v79, v24, v75, v79
  v_fma_f32 v44, v26, v44, v76
  v_fma_f32 v45, v26, v45, v77
  v_fma_f32 v46, v26, v46, v78
  v_fma_f32 v47, v26, v47, v79
  s_waitcnt lgkmcnt(0)
  v_fma_f32 v84, v24, v80, v84
  v_fma_f32 v85, v24, v81, v85
  v_fma_f32 v86, v24, v82, v86
  v_fma_f32 v87, v24, v83, v87
  v_fma_f32 v48, v26, v48, v84
  v_fma_f32 v49, v26, v49, v85
  v_fma_f32 v50, v26, v50, v86
  v_fma_f32 v51, v26, v51, v87
  v_mul_f32 v96, v40, v40
  v_mul_f32 v97, v41, v41
  v_mul_f32 v98, v42, v42
  v_mul_f32 v99, v43, v43
  v_mul_f32 v100, v44, v44
  v_mul_f32 v101, v45, v45
  v_mul_f32 v102, v46, v46
  v_mul_f32 v103, v47, v47
  v_fmaak_f32 v96, v22, v96, 0xc0135761
  v_fmaak_f32 v97, v22, v97, 0xc0135761
  v_fmaak_f32 v98, v22, v98, 0xc0135761
  v_fmaak_f32 v99, v22, v99, 0xc0135761
  v_fmaak_f32 v100, v22, v100, 0xc0135761
  v_fmaak_f32 v101, v22, v101, 0xc0135761
  v_fmaak_f32 v102, v22, v102, 0xc0135761
  v_fmaak_f32 v103, v22, v103, 0xc0135761
  v_mul_f32 v96, v40, v96
  v_mul_f32 v97, v41, v97
  v_mul_f32 v98, v42, v98
  v_mul_f32 v99, v43, v99
  v_mul_f32 v100, v44, v100
  v_mul_f32 v101, v45, v101
  v_mul_f32 v102, v46, v102
  v_mul_f32 v103, v47, v103
  v_exp_f32 v96, v96
  v_exp_f32 v97, v97
  v_exp_f32 v98, v98
  v_exp_f32 v99, v99
  v_exp_f32 v100, v100
  v_exp_f32 v101, v101
  v_exp_f32 v102, v102
  v_exp_f32 v103, v103
  v_add_f32 v96, 1.0, v96
  v_add_f32 v97, 1.0, v97
  v_add_f32 v98, 1.0, v98
  v_add_f32 v99, 1.0, v99
  v_add_f32 v100, 1.0, v100
  v_add_f32 v101, 1.0, v101
  v_add_f32 v102, 1.0, v102
  v_add_f32 v103, 1.0, v103
  v_rcp_f32 v96, v96
  v_rcp_f32 v97, v97
  v_rcp_f32 v98, v98
  v_rcp_f32 v99, v99
  v_rcp_f32 v100, v100
  v_rcp_f32 v101, v101
  v_rcp_f32 v102, v102
  v_rcp_f32 v103, v103
  v_mul_f32 v40, v40, v96
  v_mul_f32 v41, v41, v97
  v_mul_f32 v42, v42, v98
  v_mul_f32 v43, v43, v99
  v_mul_f32 v44, v44, v100
  v_mul_f32 v45, v45, v101
  v_mul_f32 v46, v46, v102
  v_mul_f32 v47, v47, v103
  v_mul_f32 v96, v48, v48
  v_mul_f32 v97, v49, v49
  v_mul_f32 v98, v50, v50
  v_mul_f32 v99, v51, v51
  v_fmaak_f32 v96, v22, v96, 0xc0135761
  v_fmaak_f32 v97, v22, v97, 0xc0135761
  v_fmaak_f32 v98, v22, v98, 0xc0135761
  v_fmaak_f32 v99, v22, v99, 0xc0135761
  v_mul_f32 v96, v48, v96
  v_mul_f32 v97, v49, v97
  v_mul_f32 v98, v50, v98
  v_mul_f32 v99, v51, v99
  v_exp_f32 v96, v96
  v_exp_f32 v97, v97
  v_exp_f32 v98, v98
  v_exp_f32 v99, v99
  v_add_f32 v96, 1.0, v96
  v_add_f32 v97, 1.0, v97
  v_add_f32 v98, 1.0, v98
  v_add_f32 v99, 1.0, v99
  v_rcp_f32 v96, v96
  v_rcp_f32 v97, v97
  v_rcp_f32 v98, v98
  v_rcp_f32 v99, v99
  v_mul_f32 v48, v48, v96
  v_mul_f32 v49, v49, v97
  v_mul_f32 v50, v50, v98
  v_mul_f32 v51, v51, v99
  v_mov_b32 v18, v40
  v_mul_f32 v19, v40, v40
  v_add_f32 v18, v18, v41
  v_fmac_f32 v19, v41, v41
  v_add_f32 v18, v18, v42
  v_fmac_f32 v19, v42, v42
  v_add_f32 v18, v18, v43
  v_fmac_f32 v19, v43, v43
  v_add_f32 v18, v18, v44
  v_fmac_f32 v19, v44, v44
  v_add_f32 v18, v18, v45
  v_fmac_f32 v19, v45, v45
  v_add_f32 v18, v18, v46
  v_fmac_f32 v19, v46, v46
  v_add_f32 v18, v18, v47
  v_fmac_f32 v19, v47, v47
  v_add_f32 v18, v18, v48
  v_fmac_f32 v19, v48, v48
  v_add_f32 v18, v18, v49
  v_fmac_f32 v19, v49, v49
  v_add_f32 v18, v18, v50
  v_fmac_f32 v19, v50, v50
  v_add_f32 v18, v18, v51
  v_fmac_f32 v19, v51, v51
  v_mov_b32 v20, v18
  s_nop 1
  v_permlane32_swap_b32 v18, v20
  v_add_f32 v18, v18, v20
  v_mov_b32 v20, v18
  s_nop 1
  v_permlane16_swap_b32 v18, v20
  v_add_f32 v18, v18, v20
  v_mov_b32 v20, v19
  s_nop 1
  v_permlane32_swap_b32 v19, v20
  v_add_f32 v19, v19, v20
  v_mov_b32 v20, v19
  s_nop 1
  v_permlane16_swap_b32 v19, v20
  v_add_f32 v19, v19, v20
  v_add_f32 v19, 1.0, v19
  s_add_u32 s44, s4, 33554432
  s_addc_u32 s45, s5, 0
  s_mov_b32 s46, 262144
  s_mov_b32 s47, 0x20000
  v_lshlrev_b32 v6, 3, v4
  s_lshl_b32 s19, s12, 4
  s_lshl_b32 s32, s13, 1
  s_add_u32 s19, s19, s32
  s_add_u32 s19, s19, s14
  s_lshl_b32 s19, s19, 9
  s_lshl_b32 s32, s17, 7
  s_add_u32 s19, s19, s32
  s_mov_b64 exec, 0xffff
  buffer_store_dwordx2 v[18:19], v6, s[44:47], s19 offen sc1
  s_mov_b64 exec, -1
  v_cvt_pk_bf16_f32 v32, v40, v41
  v_cvt_pk_bf16_f32 v33, v42, v43
  v_cvt_pk_bf16_f32 v34, v44, v45
  v_cvt_pk_bf16_f32 v35, v46, v47
  v_cvt_pk_bf16_f32 v36, v48, v49
  v_cvt_pk_bf16_f32 v37, v50, v51
  s_barrier
  v_lshlrev_b32 v6, 3, v4
  v_lshl_add_u32 v6, v3, 11, v6
  s_lshl_b32 s19, s12, 13
  s_lshl_b32 s32, s17, 7
  s_add_u32 s19, s19, s32
  v_add_u32 v17, 94208, v16
  ds_read_b64_tr_b16 v[84:85], v14 offset:0
  ds_read_b64_tr_b16 v[86:87], v14 offset:2048
  ds_read_b128 v[88:91], v17 offset:0
  ds_read_b128 v[92:95], v17 offset:2048
  ds_read_b128 v[96:99], v17 offset:4096
  ds_read_b64_tr_b16 v[104:105], v14 offset:4096
  ds_read_b64_tr_b16 v[106:107], v14 offset:6144
  ds_read_b128 v[108:111], v17 offset:1024
  ds_read_b128 v[112:115], v17 offset:3072
  ds_read_b128 v[116:119], v17 offset:5120
  s_barrier
  v_add_u32 v18, 108544, v16
  s_waitcnt lgkmcnt(5)
  v_mfma_f32_16x16x32_bf16 v[40:43], v[88:91], v[84:87], 0
  ds_read_b64_tr_b16 v[64:65], v14 offset:8192
  ds_read_b64_tr_b16 v[66:67], v14 offset:10240
  v_mfma_f32_16x16x32_bf16 v[44:47], v[92:95], v[84:87], 0
  ds_read_b128 v[68:71], v18 offset:0
  ds_read_b128 v[72:75], v18 offset:2048
  v_mfma_f32_16x16x32_bf16 v[48:51], v[96:99], v[84:87], 0
  ds_read_b128 v[76:79], v18 offset:4096
  s_waitcnt lgkmcnt(5)
  v_mfma_f32_16x16x32_bf16 v[40:43], v[108:111], v[104:107], v[40:43]
  ds_read_b64_tr_b16 v[84:85], v14 offset:12288
  ds_read_b64_tr_b16 v[86:87], v14 offset:14336
  v_mfma_f32_16x16x32_bf16 v[44:47], v[112:115], v[104:107], v[44:47]
  ds_read_b128 v[88:91], v18 offset:1024
  ds_read_b128 v[92:95], v18 offset:3072
  v_mfma_f32_16x16x32_bf16 v[48:51], v[116:119], v[104:107], v[48:51]
  ds_read_b128 v[96:99], v18 offset:5120
  s_waitcnt lgkmcnt(5)
  s_barrier
  v_add_u32 v17, 122880, v16
  s_waitcnt lgkmcnt(5)
  v_mfma_f32_16x16x32_bf16 v[40:43], v[68:71], v[64:67], v[40:43]
  ds_read_b64_tr_b16 v[104:105], v14 offset:16384
  ds_read_b64_tr_b16 v[106:107], v14 offset:18432
  v_mfma_f32_16x16x32_bf16 v[44:47], v[72:75], v[64:67], v[44:47]
  ds_read_b128 v[108:111], v17 offset:0
  ds_read_b128 v[112:115], v17 offset:2048
  v_mfma_f32_16x16x32_bf16 v[48:51], v[76:79], v[64:67], v[48:51]
  ds_read_b128 v[116:119], v17 offset:4096
  s_waitcnt lgkmcnt(5)
  v_mfma_f32_16x16x32_bf16 v[40:43], v[88:91], v[84:87], v[40:43]
  ds_read_b64_tr_b16 v[64:65], v14 offset:20480
  ds_read_b64_tr_b16 v[66:67], v14 offset:22528
  v_mfma_f32_16x16x32_bf16 v[44:47], v[92:95], v[84:87], v[44:47]
  ds_read_b128 v[68:71], v17 offset:1024
  ds_read_b128 v[72:75], v17 offset:3072
  v_mfma_f32_16x16x32_bf16 v[48:51], v[96:99], v[84:87], v[48:51]
  ds_read_b128 v[76:79], v17 offset:5120
  s_waitcnt lgkmcnt(5)
  s_barrier
  buffer_load_dwordx2 v[56:57], v6, s[44:47], s19 offen offset:0 sc0 sc1
  buffer_load_dwordx2 v[58:59], v6, s[44:47], s19 offen offset:512 sc0 sc1
  buffer_load_dwordx2 v[60:61], v6, s[44:47], s19 offen offset:1024 sc0 sc1
  buffer_load_dwordx2 v[62:63], v6, s[44:47], s19 offen offset:1536 sc0 sc1
  v_add_u32 v18, 137216, v16
  s_waitcnt lgkmcnt(5)
  v_mfma_f32_16x16x32_bf16 v[40:43], v[108:111], v[104:107], v[40:43]
  ds_read_b64_tr_b16 v[84:85], v14 offset:24576
  ds_read_b64_tr_b16 v[86:87], v14 offset:26624
  v_mfma_f32_16x16x32_bf16 v[44:47], v[112:115], v[104:107], v[44:47]
  ds_read_b128 v[88:91], v18 offset:0
  ds_read_b128 v[92:95], v18 offset:2048
  v_mfma_f32_16x16x32_bf16 v[48:51], v[116:119], v[104:107], v[48:51]
  ds_read_b128 v[96:99], v18 offset:4096
  s_waitcnt lgkmcnt(5)
  v_mfma_f32_16x16x32_bf16 v[40:43], v[68:71], v[64:67], v[40:43]
  ds_read_b64_tr_b16 v[104:105], v14 offset:28672
  ds_read_b64_tr_b16 v[106:107], v14 offset:30720
  v_mfma_f32_16x16x32_bf16 v[44:47], v[72:75], v[64:67], v[44:47]
  ds_read_b128 v[108:111], v18 offset:1024
  ds_read_b128 v[112:115], v18 offset:3072
  v_mfma_f32_16x16x32_bf16 v[48:51], v[76:79], v[64:67], v[48:51]
  ds_read_b128 v[116:119], v18 offset:5120
  s_waitcnt lgkmcnt(5)
  s_barrier
  s_waitcnt lgkmcnt(5)
  v_mfma_f32_16x16x32_bf16 v[40:43], v[88:91], v[84:87], v[40:43]
  v_mfma_f32_16x16x32_bf16 v[44:47], v[92:95], v[84:87], v[44:47]
  v_mfma_f32_16x16x32_bf16 v[48:51], v[96:99], v[84:87], v[48:51]
  s_waitcnt lgkmcnt(0)
  v_mfma_f32_16x16x32_bf16 v[40:43], v[108:111], v[104:107], v[40:43]
  v_mfma_f32_16x16x32_bf16 v[44:47], v[112:115], v[104:107], v[44:47]
  v_mfma_f32_16x16x32_bf16 v[48:51], v[116:119], v[104:107], v[48:51]
  s_mov_b32 s33, 0
Q_poll_7:
  s_waitcnt vmcnt(0)
  v_min_u32 v20, v57, v59
  v_min_u32 v21, v61, v63
  v_min_u32 v20, v20, v21
  v_cmp_eq_u32 vcc, 0, v20
  s_cbranch_vccz Q_pollo_8
  s_add_u32 s33, s33, 1
  s_cmp_gt_u32 s33, 0x20000
  s_cbranch_scc1 Q_pollo_8
  buffer_load_dwordx2 v[56:57], v6, s[44:47], s19 offen offset:0 sc0 sc1
  buffer_load_dwordx2 v[58:59], v6, s[44:47], s19 offen offset:512 sc0 sc1
  buffer_load_dwordx2 v[60:61], v6, s[44:47], s19 offen offset:1024 sc0 sc1
  buffer_load_dwordx2 v[62:63], v6, s[44:47], s19 offen offset:1536 sc0 sc1
  s_branch Q_poll_7
Q_pollo_8:
  v_add_f32 v56, v56, v58
  v_add_f32 v57, v57, v59
  v_add_f32 v56, v56, v60
  v_add_f32 v57, v57, v61
  v_add_f32 v56, v56, v62
  v_add_f32 v57, v57, v63
  v_mov_b32 v20, v56
  s_nop 1
  v_permlane32_swap_b32 v56, v20
  v_add_f32 v56, v56, v20
  v_mov_b32 v20, v56
  s_nop 1
  v_permlane16_swap_b32 v56, v20
  v_add_f32 v56, v56, v20
  v_mov_b32 v20, v57
  s_nop 1
  v_permlane32_swap_b32 v57, v20
  v_add_f32 v57, v57, v20
  v_mov_b32 v20, v57
  s_nop 1
  v_permlane16_swap_b32 v57, v20
  v_add_f32 v57, v57, v20
  v_add_f32 v57, 0xc1800000, v57
  s_mov_b32 s41, 0x3a924925
  v_mul_f32 v56, s41, v56
  v_mul_f32 v57, s41, v57
  v_fma_f32 v57, -v56, v56, v57
  v_max_f32 v57, 0, v57
  v_add_f32 v57, s42, v57
  v_rsq_f32 v57, v57
  s_nop 0
  v_mul_f32 v56, v56, v57
  v_sub_f32 v56, 0, v56
  s_lshl_b32 s19, s8, 11
  s_add_u32 s19, s19, 0
  v_lshlrev_b32 v6, 5, v4
  v_lshl_add_u32 v6, v3, 3, v6
  v_add_u32 v6, s19, v6
  v_lshlrev_b32 v96, 16, v32
  v_and_b32 v97, 0xffff0000, v32
  v_lshlrev_b32 v98, 16, v33
  v_and_b32 v99, 0xffff0000, v33
  v_fma_f32 v96, v96, v57, v56
  v_fma_f32 v97, v97, v57, v56
  v_fma_f32 v98, v98, v57, v56
  v_fma_f32 v99, v99, v57, v56
  v_cvt_pk_bf16_f32 v100, v96, v97
  v_cvt_pk_bf16_f32 v101, v98, v99
  ds_write_b64 v6, v[100:101] offset:0
  v_lshlrev_b32 v96, 16, v34
  v_and_b32 v97, 0xffff0000, v34
  v_lshlrev_b32 v98, 16, v35
  v_and_b32 v99, 0xffff0000, v35
  v_fma_f32 v96, v96, v57, v56
  v_fma_f32 v97, v97, v57, v56
  v_fma_f32 v98, v98, v57, v56
  v_fma_f32 v99, v99, v57, v56
  v_cvt_pk_bf16_f32 v102, v96, v97
  v_cvt_pk_bf16_f32 v103, v98, v99
  ds_write_b64 v6, v[102:103] offset:512
  v_lshlrev_b32 v96, 16, v36
  v_and_b32 v97, 0xffff0000, v36
  v_lshlrev_b32 v98, 16, v37
  v_and_b32 v99, 0xffff0000, v37
  v_fma_f32 v96, v96, v57, v56
  v_fma_f32 v97, v97, v57, v56
  v_fma_f32 v98, v98, v57, v56
  v_fma_f32 v99, v99, v57, v56
  v_cvt_pk_bf16_f32 v104, v96, v97
  v_cvt_pk_bf16_f32 v105, v98, v99
  ds_write_b64 v6, v[104:105] offset:1024
  v_lshrrev_b32 v7, 5, v1
  v_lshlrev_b32 v7, 9, v7
  v_and_b32 v10, 1, v3
  v_lshlrev_b32 v10, 3, v10
  v_bfe_u32 v11, v1, 2, 2
  v_add_u32 v10, v10, v11
  v_lshl_add_u32 v7, v10, 5, v7
  v_and_b32 v10, 3, v1
  v_lshl_add_u32 v7, v10, 3, v7
  v_add_u32 v7, s19, v7
  s_add_u32 s48, s4, 20971520
  s_addc_u32 s49, s5, 0
  s_mov_b32 s50, 3670016
  s_mov_b32 s51, 0x20000
  v_lshrrev_b32 v10, 5, v1
  v_lshlrev_b32 v10, 16, v10
  v_and_b32 v11, 1, v3
  v_lshl_add_u32 v10, v11, 8, v10
  v_lshl_add_u32 v10, v4, 4, v10
  s_mul_i32 s19, s13, 7
  s_lshl_b32 s32, s14, 2
  s_add_u32 s19, s19, s32
  s_lshl_b32 s19, s19, 6
  s_lshl_b32 s32, s12, 1
  s_add_u32 s19, s19, s32
  s_lshr_b32 s32, s17, 1
  s_add_u32 s19, s19, s32
  s_lshl_b32 s19, s19, 10
  s_and_b32 s32, s17, 1
  s_lshl_b32 s32, s32, 9
  s_add_u32 s19, s19, s32
  s_waitcnt lgkmcnt(0)
  ds_read_b64_tr_b16 v[120:121], v7 offset:0
  ds_read_b64_tr_b16 v[122:123], v7 offset:128
  ds_read_b64_tr_b16 v[124:125], v7 offset:1024
  ds_read_b64_tr_b16 v[126:127], v7 offset:1152
  s_waitcnt lgkmcnt(2)
  s_add_u32 s32, s19, 0
  buffer_store_dwordx4 v[120:123], v10, s[48:51], s32 offen sc1
  s_waitcnt lgkmcnt(0)
  s_add_u32 s32, s19, 131072
  s_mov_b32 exec_hi, 0
  buffer_store_dwordx4 v[124:127], v10, s[48:51], s32 offen sc1
  s_mov_b64 exec, -1
  v_add_u32 v17, 65536, v16
  ds_read_b64_tr_b16 v[64:65], v14 offset:32768
  ds_read_b64_tr_b16 v[66:67], v14 offset:34816
  ds_read_b128 v[68:71], v17 offset:0
  ds_read_b128 v[72:75], v17 offset:2048
  ds_read_b128 v[76:79], v17 offset:4096
  ds_read_b64_tr_b16 v[84:85], v14 offset:36864
  ds_read_b64_tr_b16 v[86:87], v14 offset:38912
  ds_read_b128 v[88:91], v17 offset:1024
  ds_read_b128 v[92:95], v17 offset:3072
  ds_read_b128 v[96:99], v17 offset:5120
  s_barrier
  v_add_u32 v18, 79872, v16
  s_waitcnt lgkmcnt(5)
  v_mfma_f32_16x16x32_bf16 v[40:43], v[68:71], v[64:67], v[40:43]
  ds_read_b64_tr_b16 v[104:105], v14 offset:40960
  ds_read_b64_tr_b16 v[106:107], v14 offset:43008
  v_mfma_f32_16x16x32_bf16 v[44:47], v[72:75], v[64:67], v[44:47]
  ds_read_b128 v[108:111], v18 offset:0
  ds_read_b128 v[112:115], v18 offset:2048
  v_mfma_f32_16x16x32_bf16 v[48:51], v[76:79], v[64:67], v[48:51]
  ds_read_b128 v[116:119], v18 offset:4096
  s_waitcnt lgkmcnt(5)
  v_mfma_f32_16x16x32_bf16 v[40:43], v[88:91], v[84:87], v[40:43]
  ds_read_b64_tr_b16 v[64:65], v14 offset:45056
  ds_read_b64_tr_b16 v[66:67], v14 offset:47104
  v_mfma_f32_16x16x32_bf16 v[44:47], v[92:95], v[84:87], v[44:47]
  ds_read_b128 v[68:71], v18 offset:1024
  ds_read_b128 v[72:75], v18 offset:3072
  v_mfma_f32_16x16x32_bf16 v[48:51], v[96:99], v[84:87], v[48:51]
  ds_read_b128 v[76:79], v18 offset:5120
  s_waitcnt lgkmcnt(5)
  s_barrier
  v_add_u32 v17, 94208, v16
  s_waitcnt lgkmcnt(5)
  v_mfma_f32_16x16x32_bf16 v[40:43], v[108:111], v[104:107], v[40:43]
  ds_read_b64_tr_b16 v[84:85], v14 offset:49152
  ds_read_b64_tr_b16 v[86:87], v14 offset:51200
  v_mfma_f32_16x16x32_bf16 v[44:47], v[112:115], v[104:107], v[44:47]
  ds_read_b128 v[88:91], v17 offset:0
  ds_read_b128 v[92:95], v17 offset:2048
  v_mfma_f32_16x16x32_bf16 v[48:51], v[116:119], v[104:107], v[48:51]
  ds_read_b128 v[96:99], v17 offset:4096
  s_waitcnt lgkmcnt(5)
  v_mfma_f32_16x16x32_bf16 v[40:43], v[68:71], v[64:67], v[40:43]
  ds_read_b64_tr_b16 v[104:105], v14 offset:53248
  ds_read_b64_tr_b16 v[106:107], v14 offset:55296
  v_mfma_f32_16x16x32_bf16 v[44:47], v[72:75], v[64:67], v[44:47]
  ds_read_b128 v[108:111], v17 offset:1024
  ds_read_b128 v[112:115], v17 offset:3072
  v_mfma_f32_16x16x32_bf16 v[48:51], v[76:79], v[64:67], v[48:51]
  ds_read_b128 v[116:119], v17 offset:5120
  s_waitcnt lgkmcnt(5)
  s_waitcnt vmcnt(0)
  s_barrier
  s_cmp_lg_u32 s8, 0
  s_cbranch_scc1 Q_flag_9
  s_lshl_b32 s58, s13, 5
  s_add_u32 s58, s58, s12
  s_lshl_b32 s58, s58, 7
  s_add_u32 s60, s4, 196608
  s_addc_u32 s61, s5, 0
  v_mov_b32 v5, s58
  v_mov_b32 v19, 1
  s_mov_b64 exec, 1
  global_store_dword v5, v19, s[60:61] sc0 sc1
  s_mov_b64 exec, -1
Q_flag_9:
  v_add_u32 v18, 108544, v16
  s_waitcnt lgkmcnt(5)
  v_mfma_f32_16x16x32_bf16 v[40:43], v[88:91], v[84:87], v[40:43]
  ds_read_b64_tr_b16 v[64:65], v14 offset:57344
  ds_read_b64_tr_b16 v[66:67], v14 offset:59392
  v_mfma_f32_16x16x32_bf16 v[44:47], v[92:95], v[84:87], v[44:47]
  ds_read_b128 v[68:71], v18 offset:0
  ds_read_b128 v[72:75], v18 offset:2048
  v_mfma_f32_16x16x32_bf16 v[48:51], v[96:99], v[84:87], v[48:51]
  ds_read_b128 v[76:79], v18 offset:4096
  s_waitcnt lgkmcnt(5)
  v_mfma_f32_16x16x32_bf16 v[40:43], v[108:111], v[104:107], v[40:43]
  ds_read_b64_tr_b16 v[84:85], v14 offset:61440
  ds_read_b64_tr_b16 v[86:87], v14 offset:63488
  v_mfma_f32_16x16x32_bf16 v[44:47], v[112:115], v[104:107], v[44:47]
  ds_read_b128 v[88:91], v18 offset:1024
  ds_read_b128 v[92:95], v18 offset:3072
  v_mfma_f32_16x16x32_bf16 v[48:51], v[116:119], v[104:107], v[48:51]
  ds_read_b128 v[96:99], v18 offset:5120
  s_waitcnt lgkmcnt(5)
  v_mfma_f32_16x16x32_bf16 v[40:43], v[68:71], v[64:67], v[40:43]
  v_mfma_f32_16x16x32_bf16 v[44:47], v[72:75], v[64:67], v[44:47]
  v_mfma_f32_16x16x32_bf16 v[48:51], v[76:79], v[64:67], v[48:51]
  s_waitcnt lgkmcnt(0)
  v_mfma_f32_16x16x32_bf16 v[40:43], v[88:91], v[84:87], v[40:43]
  v_mfma_f32_16x16x32_bf16 v[44:47], v[92:95], v[84:87], v[44:47]
  v_mfma_f32_16x16x32_bf16 v[48:51], v[96:99], v[84:87], v[48:51]
  s_barrier
  s_nop 3
  s_lshl_b32 s19, s14, 8
  s_add_u32 s19, s19, 152448
  v_lshlrev_b32 v23, 4, v3
  v_add_u32 v23, s19, v23
  ds_read_b128 v[64:67], v23 offset:0
  ds_read_b128 v[68:71], v23 offset:448
  ds_read_b128 v[72:75], v23 offset:64
  ds_read_b128 v[76:79], v23 offset:512
  ds_read_b128 v[80:83], v23 offset:128
  ds_read_b128 v[84:87], v23 offset:576
  s_waitcnt lgkmcnt(4)
  v_fma_f32 v68, v24, v64, v68
  v_fma_f32 v69, v24, v65, v69
  v_fma_f32 v70, v24, v66, v70
  v_fma_f32 v71, v24, v67, v71
  v_fma_f32 v40, v26, v40, v68
  v_fma_f32 v41, v26, v41, v69
  v_fma_f32 v42, v26, v42, v70
  v_fma_f32 v43, v26, v43, v71
  s_waitcnt lgkmcnt(2)
  v_fma_f32 v76, v24, v72, v76
  v_fma_f32 v77, v24, v73, v77
  v_fma_f32 v78, v24, v74, v78
  v_fma_f32 v79, v24, v75, v79
  v_fma_f32 v44, v26, v44, v76
  v_fma_f32 v45, v26, v45, v77
  v_fma_f32 v46, v26, v46, v78
  v_fma_f32 v47, v26, v47, v79
  s_waitcnt lgkmcnt(0)
  v_fma_f32 v84, v24, v80, v84
  v_fma_f32 v85, v24, v81, v85
  v_fma_f32 v86, v24, v82, v86
  v_fma_f32 v87, v24, v83, v87
  v_fma_f32 v48, v26, v48, v84
  v_fma_f32 v49, v26, v49, v85
  v_fma_f32 v50, v26, v50, v86
  v_fma_f32 v51, v26, v51, v87
  v_mul_f32 v96, v40, v40
  v_mul_f32 v97, v41, v41
  v_mul_f32 v98, v42, v42
  v_mul_f32 v99, v43, v43
  v_mul_f32 v100, v44, v44
  v_mul_f32 v101, v45, v45
  v_mul_f32 v102, v46, v46
  v_mul_f32 v103, v47, v47
  v_fmaak_f32 v96, v22, v96, 0xc0135761
  v_fmaak_f32 v97, v22, v97, 0xc0135761
  v_fmaak_f32 v98, v22, v98, 0xc0135761
  v_fmaak_f32 v99, v22, v99, 0xc0135761
  v_fmaak_f32 v100, v22, v100, 0xc0135761
  v_fmaak_f32 v101, v22, v101, 0xc0135761
  v_fmaak_f32 v102, v22, v102, 0xc0135761
  v_fmaak_f32 v103, v22, v103, 0xc0135761
  v_mul_f32 v96, v40, v96
  v_mul_f32 v97, v41, v97
  v_mul_f32 v98, v42, v98
  v_mul_f32 v99, v43, v99
  v_mul_f32 v100, v44, v100
  v_mul_f32 v101, v45, v101
  v_mul_f32 v102, v46, v102
  v_mul_f32 v103, v47, v103
  v_exp_f32 v96, v96
  v_exp_f32 v97, v97
  v_exp_f32 v98, v98
  v_exp_f32 v99, v99
  v_exp_f32 v100, v100
  v_exp_f32 v101, v101
  v_exp_f32 v102, v102
  v_exp_f32 v103, v103
  v_add_f32 v96, 1.0, v96
  v_add_f32 v97, 1.0, v97
  v_add_f32 v98, 1.0, v98
  v_add_f32 v99, 1.0, v99
  v_add_f32 v100, 1.0, v100
  v_add_f32 v101, 1.0, v101
  v_add_f32 v102, 1.0, v102
  v_add_f32 v103, 1.0, v103
  v_rcp_f32 v96, v96
  v_rcp_f32 v97, v97
  v_rcp_f32 v98, v98
  v_rcp_f32 v99, v99
  v_rcp_f32 v100, v100
  v_rcp_f32 v101, v101
  v_rcp_f32 v102, v102
  v_rcp_f32 v103, v103
  v_mul_f32 v40, v40, v96
  v_mul_f32 v41, v41, v97
  v_mul_f32 v42, v42, v98
  v_mul_f32 v43, v43, v99
  v_mul_f32 v44, v44, v100
  v_mul_f32 v45, v45, v101
  v_mul_f32 v46, v46, v102
  v_mul_f32 v47, v47, v103
  v_mul_f32 v96, v48, v48
  v_mul_f32 v97, v49, v49
  v_mul_f32 v98, v50, v50
  v_mul_f32 v99, v51, v51
  v_fmaak_f32 v96, v22, v96, 0xc0135761
  v_fmaak_f32 v97, v22, v97, 0xc0135761
  v_fmaak_f32 v98, v22, v98, 0xc0135761
  v_fmaak_f32 v99, v22, v99, 0xc0135761
  v_mul_f32 v96, v48, v96
  v_mul_f32 v97, v49, v97
  v_mul_f32 v98, v50, v98
  v_mul_f32 v99, v51, v99
  v_exp_f32 v96, v96
  v_exp_f32 v97, v97
  v_exp_f32 v98, v98
  v_exp_f32 v99, v99
  v_add_f32 v96, 1.0, v96
  v_add_f32 v97, 1.0, v97
  v_add_f32 v98, 1.0, v98
  v_add_f32 v99, 1.0, v99
  v_rcp_f32 v96, v96
  v_rcp_f32 v97, v97
  v_rcp_f32 v98, v98
  v_rcp_f32 v99, v99
  v_mul_f32 v48, v48, v96
  v_mul_f32 v49, v49, v97
  v_mul_f32 v50, v50, v98
  v_mul_f32 v51, v51, v99
  v_cvt_pk_bf16_f32 v32, v40, v41
  v_cvt_pk_bf16_f32 v33, v42, v43
  v_cvt_pk_bf16_f32 v34, v44, v45
  v_cvt_pk_bf16_f32 v35, v46, v47
  v_cvt_pk_bf16_f32 v36, v48, v49
  v_cvt_pk_bf16_f32 v37, v50, v51
  s_branch Q_end
Q_end:
Q_pdone:
  s_cmp_ge_u32 s8, 8
  s_cbranch_scc1 P4_prod
  s_and_b32 s9, s2, 3
  s_bfe_u32 s10, s2, 0x10002
  s_lshr_b32 s11, s2, 3
  s_and_b32 s12, s11, 7
  s_lshl_b32 s9, s9, 3
  s_add_u32 s12, s12, s9
  s_lshr_b32 s13, s11, 3
  s_lshl_b32 s10, s10, 2
  s_add_u32 s13, s13, s10
  s_lshr_b32 s14, s8, 2
  s_bfe_u32 s15, s8, 0x10001
  s_and_b32 s16, s8, 1
  s_lshl_b32 s18, s15, 1
  s_add_u32 s18, s18, s16
  s_lshl_b32 s19, s12, 2
  s_add_u32 s36, s18, s19
  s_lshl_b32 s18, s36, 5
  v_lshlrev_b32 v6, 1, v4
  v_add_u32 v6, s18, v6
  global_load_ushort v30, v6, s[52:53]
  s_lshl_b32 s18, s14, 13
  s_lshl_b32 s19, s16, 10
  s_add_u32 s18, s18, s19
  v_add_u32 v22, s18, v2
  s_lshl_b32 s18, s16, 2
  v_add_u32 v5, s18, v3
  v_bfe_u32 v6, v4, 1, 3
  v_xor_b32 v5, v5, v6
  v_lshlrev_b32 v5, 4, v5
  v_lshl_add_u32 v5, v4, 7, v5
  s_lshl_b32 s18, s15, 12
  v_add_u32 v23, s18, v5
  s_cmp_eq_u32 s14, 1
  s_cbranch_scc1 P4_f1_10
  v_add_u32 v24, 0, v22
  v_add_u32 v25, 14336, v23
  v_add_u32 v26, 22528, v22
  v_add_u32 v27, 36864, v23
  s_barrier
  ds_read_b128 v[72:75], v24 offset:0
  ds_read_b128 v[88:91], v25 offset:0
  ds_read_b128 v[92:95], v25 offset:2048
  ds_read_b128 v[76:79], v24 offset:2048
  ds_read_b128 v[80:83], v24 offset:4096
  ds_read_b128 v[84:87], v24 offset:6144
  s_waitcnt lgkmcnt(0)
  s_barrier
  v_mfma_f32_16x16x32_bf16 v[40:43], v[72:75], v[88:91], 0
  ds_read_b128 v[96:99], v26 offset:0
  ds_read_b128 v[112:115], v27 offset:0
  v_mfma_f32_16x16x32_bf16 v[56:59], v[72:75], v[92:95], 0
  ds_read_b128 v[116:119], v27 offset:2048
  v_mfma_f32_16x16x32_bf16 v[44:47], v[76:79], v[88:91], 0
  ds_read_b128 v[100:103], v26 offset:2048
  ds_read_b128 v[104:107], v26 offset:4096
  v_mfma_f32_16x16x32_bf16 v[60:63], v[76:79], v[92:95], 0
  v_mfma_f32_16x16x32_bf16 v[48:51], v[80:83], v[88:91], 0
  ds_read_b128 v[108:111], v26 offset:6144
  v_mfma_f32_16x16x32_bf16 v[64:67], v[80:83], v[92:95], 0
  v_mfma_f32_16x16x32_bf16 v[52:55], v[84:87], v[88:91], 0
  v_mfma_f32_16x16x32_bf16 v[68:71], v[84:87], v[92:95], 0
  v_add_u32 v24, 45056, v22
  v_add_u32 v25, 59392, v23
  s_waitcnt lgkmcnt(3)
  v_mfma_f32_16x16x32_bf16 v[40:43], v[96:99], v[112:115], v[40:43]
  ds_read_b128 v[72:75], v24 offset:0
  ds_read_b128 v[88:91], v25 offset:0
  v_mfma_f32_16x16x32_bf16 v[56:59], v[96:99], v[116:119], v[56:59]
  ds_read_b128 v[92:95], v25 offset:2048
  s_waitcnt lgkmcnt(5)
  v_mfma_f32_16x16x32_bf16 v[44:47], v[100:103], v[112:115], v[44:47]
  ds_read_b128 v[76:79], v24 offset:2048
  ds_read_b128 v[80:83], v24 offset:4096
  v_mfma_f32_16x16x32_bf16 v[60:63], v[100:103], v[116:119], v[60:63]
  s_waitcnt lgkmcnt(6)
  v_mfma_f32_16x16x32_bf16 v[48:51], v[104:107], v[112:115], v[48:51]
  ds_read_b128 v[84:87], v24 offset:6144
  v_mfma_f32_16x16x32_bf16 v[64:67], v[104:107], v[116:119], v[64:67]
  s_waitcnt lgkmcnt(6)
  v_mfma_f32_16x16x32_bf16 v[52:55], v[108:111], v[112:115], v[52:55]
  v_mfma_f32_16x16x32_bf16 v[68:71], v[108:111], v[116:119], v[68:71]
  v_add_u32 v26, 67584, v22
  v_add_u32 v27, 81920, v23
  s_waitcnt lgkmcnt(0)
  s_barrier
  v_mfma_f32_16x16x32_bf16 v[40:43], v[72:75], v[88:91], v[40:43]
  ds_read_b128 v[96:99], v26 offset:0
  ds_read_b128 v[112:115], v27 offset:0
  v_mfma_f32_16x16x32_bf16 v[56:59], v[72:75], v[92:95], v[56:59]
  ds_read_b128 v[116:119], v27 offset:2048
  v_mfma_f32_16x16x32_bf16 v[44:47], v[76:79], v[88:91], v[44:47]
  ds_read_b128 v[100:103], v26 offset:2048
  ds_read_b128 v[104:107], v26 offset:4096
  v_mfma_f32_16x16x32_bf16 v[60:63], v[76:79], v[92:95], v[60:63]
  v_mfma_f32_16x16x32_bf16 v[48:51], v[80:83], v[88:91], v[48:51]
  ds_read_b128 v[108:111], v26 offset:6144
  v_mfma_f32_16x16x32_bf16 v[64:67], v[80:83], v[92:95], v[64:67]
  v_mfma_f32_16x16x32_bf16 v[52:55], v[84:87], v[88:91], v[52:55]
  v_mfma_f32_16x16x32_bf16 v[68:71], v[84:87], v[92:95], v[68:71]
  v_add_u32 v24, 90112, v22
  v_add_u32 v25, 104448, v23
  s_waitcnt lgkmcnt(3)
  v_mfma_f32_16x16x32_bf16 v[40:43], v[96:99], v[112:115], v[40:43]
  ds_read_b128 v[72:75], v24 offset:0
  ds_read_b128 v[88:91], v25 offset:0
  v_mfma_f32_16x16x32_bf16 v[56:59], v[96:99], v[116:119], v[56:59]
  ds_read_b128 v[92:95], v25 offset:2048
  s_waitcnt lgkmcnt(5)
  v_mfma_f32_16x16x32_bf16 v[44:47], v[100:103], v[112:115], v[44:47]
  ds_read_b128 v[76:79], v24 offset:2048
  ds_read_b128 v[80:83], v24 offset:4096
  v_mfma_f32_16x16x32_bf16 v[60:63], v[100:103], v[116:119], v[60:63]
  s_waitcnt lgkmcnt(6)
  v_mfma_f32_16x16x32_bf16 v[48:51], v[104:107], v[112:115], v[48:51]
  ds_read_b128 v[84:87], v24 offset:6144
  v_mfma_f32_16x16x32_bf16 v[64:67], v[104:107], v[116:119], v[64:67]
  s_waitcnt lgkmcnt(6)
  v_mfma_f32_16x16x32_bf16 v[52:55], v[108:111], v[112:115], v[52:55]
  v_mfma_f32_16x16x32_bf16 v[68:71], v[108:111], v[116:119], v[68:71]
  v_add_u32 v26, 112640, v22
  v_add_u32 v27, 126976, v23
  s_waitcnt lgkmcnt(0)
  s_barrier
  v_mfma_f32_16x16x32_bf16 v[40:43], v[72:75], v[88:91], v[40:43]
  ds_read_b128 v[96:99], v26 offset:0
  ds_read_b128 v[112:115], v27 offset:0
  v_mfma_f32_16x16x32_bf16 v[56:59], v[72:75], v[92:95], v[56:59]
  ds_read_b128 v[116:119], v27 offset:2048
  v_mfma_f32_16x16x32_bf16 v[44:47], v[76:79], v[88:91], v[44:47]
  ds_read_b128 v[100:103], v26 offset:2048
  ds_read_b128 v[104:107], v26 offset:4096
  v_mfma_f32_16x16x32_bf16 v[60:63], v[76:79], v[92:95], v[60:63]
  v_mfma_f32_16x16x32_bf16 v[48:51], v[80:83], v[88:91], v[48:51]
  ds_read_b128 v[108:111], v26 offset:6144
  v_mfma_f32_16x16x32_bf16 v[64:67], v[80:83], v[92:95], v[64:67]
  v_mfma_f32_16x16x32_bf16 v[52:55], v[84:87], v[88:91], v[52:55]
  v_mfma_f32_16x16x32_bf16 v[68:71], v[84:87], v[92:95], v[68:71]
  v_add_u32 v24, 135168, v22
  v_add_u32 v25, 149504, v23
  s_waitcnt lgkmcnt(3)
  v_mfma_f32_16x16x32_bf16 v[40:43], v[96:99], v[112:115], v[40:43]
  ds_read_b128 v[72:75], v24 offset:0
  ds_read_b128 v[88:91], v25 offset:0
  v_mfma_f32_16x16x32_bf16 v[56:59], v[96:99], v[116:119], v[56:59]
  ds_read_b128 v[92:95], v25 offset:2048
  s_waitcnt lgkmcnt(5)
  v_mfma_f32_16x16x32_bf16 v[44:47], v[100:103], v[112:115], v[44:47]
  ds_read_b128 v[76:79], v24 offset:2048
  ds_read_b128 v[80:83], v24 offset:4096
  v_mfma_f32_16x16x32_bf16 v[60:63], v[100:103], v[116:119], v[60:63]
  s_waitcnt lgkmcnt(6)
  v_mfma_f32_16x16x32_bf16 v[48:51], v[104:107], v[112:115], v[48:51]
  ds_read_b128 v[84:87], v24 offset:6144
  v_mfma_f32_16x16x32_bf16 v[64:67], v[104:107], v[116:119], v[64:67]
  s_waitcnt lgkmcnt(6)
  v_mfma_f32_16x16x32_bf16 v[52:55], v[108:111], v[112:115], v[52:55]
  v_mfma_f32_16x16x32_bf16 v[68:71], v[108:111], v[116:119], v[68:71]
  v_add_u32 v26, 0, v22
  v_add_u32 v27, 14336, v23
  s_waitcnt lgkmcnt(0)
  s_barrier
  v_mfma_f32_16x16x32_bf16 v[40:43], v[72:75], v[88:91], v[40:43]
  ds_read_b128 v[96:99], v26 offset:0
  ds_read_b128 v[112:115], v27 offset:0
  v_mfma_f32_16x16x32_bf16 v[56:59], v[72:75], v[92:95], v[56:59]
  ds_read_b128 v[116:119], v27 offset:2048
  v_mfma_f32_16x16x32_bf16 v[44:47], v[76:79], v[88:91], v[44:47]
  ds_read_b128 v[100:103], v26 offset:2048
  ds_read_b128 v[104:107], v26 offset:4096
  v_mfma_f32_16x16x32_bf16 v[60:63], v[76:79], v[92:95], v[60:63]
  v_mfma_f32_16x16x32_bf16 v[48:51], v[80:83], v[88:91], v[48:51]
  ds_read_b128 v[108:111], v26 offset:6144
  v_mfma_f32_16x16x32_bf16 v[64:67], v[80:83], v[92:95], v[64:67]
  v_mfma_f32_16x16x32_bf16 v[52:55], v[84:87], v[88:91], v[52:55]
  v_mfma_f32_16x16x32_bf16 v[68:71], v[84:87], v[92:95], v[68:71]
  v_add_u32 v24, 22528, v22
  v_add_u32 v25, 36864, v23
  s_waitcnt lgkmcnt(3)
  v_mfma_f32_16x16x32_bf16 v[40:43], v[96:99], v[112:115], v[40:43]
  ds_read_b128 v[72:75], v24 offset:0
  ds_read_b128 v[88:91], v25 offset:0
  v_mfma_f32_16x16x32_bf16 v[56:59], v[96:99], v[116:119], v[56:59]
  ds_read_b128 v[92:95], v25 offset:2048
  s_waitcnt lgkmcnt(5)
  v_mfma_f32_16x16x32_bf16 v[44:47], v[100:103], v[112:115], v[44:47]
  ds_read_b128 v[76:79], v24 offset:2048
  ds_read_b128 v[80:83], v24 offset:4096
  v_mfma_f32_16x16x32_bf16 v[60:63], v[100:103], v[116:119], v[60:63]
  s_waitcnt lgkmcnt(6)
  v_mfma_f32_16x16x32_bf16 v[48:51], v[104:107], v[112:115], v[48:51]
  ds_read_b128 v[84:87], v24 offset:6144
  v_mfma_f32_16x16x32_bf16 v[64:67], v[104:107], v[116:119], v[64:67]
  s_waitcnt lgkmcnt(6)
  v_mfma_f32_16x16x32_bf16 v[52:55], v[108:111], v[112:115], v[52:55]
  v_mfma_f32_16x16x32_bf16 v[68:71], v[108:111], v[116:119], v[68:71]
  v_add_u32 v26, 45056, v22
  v_add_u32 v27, 59392, v23
  s_waitcnt lgkmcnt(0)
  s_barrier
  v_mfma_f32_16x16x32_bf16 v[40:43], v[72:75], v[88:91], v[40:43]
  ds_read_b128 v[96:99], v26 offset:0
  ds_read_b128 v[112:115], v27 offset:0
  v_mfma_f32_16x16x32_bf16 v[56:59], v[72:75], v[92:95], v[56:59]
  ds_read_b128 v[116:119], v27 offset:2048
  v_mfma_f32_16x16x32_bf16 v[44:47], v[76:79], v[88:91], v[44:47]
  ds_read_b128 v[100:103], v26 offset:2048
  ds_read_b128 v[104:107], v26 offset:4096
  v_mfma_f32_16x16x32_bf16 v[60:63], v[76:79], v[92:95], v[60:63]
  v_mfma_f32_16x16x32_bf16 v[48:51], v[80:83], v[88:91], v[48:51]
  ds_read_b128 v[108:111], v26 offset:6144
  v_mfma_f32_16x16x32_bf16 v[64:67], v[80:83], v[92:95], v[64:67]
  v_mfma_f32_16x16x32_bf16 v[52:55], v[84:87], v[88:91], v[52:55]
  v_mfma_f32_16x16x32_bf16 v[68:71], v[84:87], v[92:95], v[68:71]
  v_add_u32 v24, 67584, v22
  v_add_u32 v25, 81920, v23
  s_waitcnt lgkmcnt(3)
  v_mfma_f32_16x16x32_bf16 v[40:43], v[96:99], v[112:115], v[40:43]
  ds_read_b128 v[72:75], v24 offset:0
  ds_read_b128 v[88:91], v25 offset:0
  v_mfma_f32_16x16x32_bf16 v[56:59], v[96:99], v[116:119], v[56:59]
  ds_read_b128 v[92:95], v25 offset:2048
  s_waitcnt lgkmcnt(5)
  v_mfma_f32_16x16x32_bf16 v[44:47], v[100:103], v[112:115], v[44:47]
  ds_read_b128 v[76:79], v24 offset:2048
  ds_read_b128 v[80:83], v24 offset:4096
  v_mfma_f32_16x16x32_bf16 v[60:63], v[100:103], v[116:119], v[60:63]
  s_waitcnt lgkmcnt(6)
  v_mfma_f32_16x16x32_bf16 v[48:51], v[104:107], v[112:115], v[48:51]
  ds_read_b128 v[84:87], v24 offset:6144
  v_mfma_f32_16x16x32_bf16 v[64:67], v[104:107], v[116:119], v[64:67]
  s_waitcnt lgkmcnt(6)
  v_mfma_f32_16x16x32_bf16 v[52:55], v[108:111], v[112:115], v[52:55]
  v_mfma_f32_16x16x32_bf16 v[68:71], v[108:111], v[116:119], v[68:71]
  v_add_u32 v26, 90112, v22
  v_add_u32 v27, 104448, v23
  s_waitcnt lgkmcnt(0)
  s_barrier
  v_mfma_f32_16x16x32_bf16 v[40:43], v[72:75], v[88:91], v[40:43]
  ds_read_b128 v[96:99], v26 offset:0
  ds_read_b128 v[112:115], v27 offset:0
  v_mfma_f32_16x16x32_bf16 v[56:59], v[72:75], v[92:95], v[56:59]
  ds_read_b128 v[116:119], v27 offset:2048
  v_mfma_f32_16x16x32_bf16 v[44:47], v[76:79], v[88:91], v[44:47]
  ds_read_b128 v[100:103], v26 offset:2048
  ds_read_b128 v[104:107], v26 offset:4096
  v_mfma_f32_16x16x32_bf16 v[60:63], v[76:79], v[92:95], v[60:63]
  v_mfma_f32_16x16x32_bf16 v[48:51], v[80:83], v[88:91], v[48:51]
  ds_read_b128 v[108:111], v26 offset:6144
  v_mfma_f32_16x16x32_bf16 v[64:67], v[80:83], v[92:95], v[64:67]
  v_mfma_f32_16x16x32_bf16 v[52:55], v[84:87], v[88:91], v[52:55]
  v_mfma_f32_16x16x32_bf16 v[68:71], v[84:87], v[92:95], v[68:71]
  v_add_u32 v24, 112640, v22
  v_add_u32 v25, 126976, v23
  s_waitcnt lgkmcnt(3)
  v_mfma_f32_16x16x32_bf16 v[40:43], v[96:99], v[112:115], v[40:43]
  ds_read_b128 v[72:75], v24 offset:0
  ds_read_b128 v[88:91], v25 offset:0
  v_mfma_f32_16x16x32_bf16 v[56:59], v[96:99], v[116:119], v[56:59]
  ds_read_b128 v[92:95], v25 offset:2048
  s_waitcnt lgkmcnt(5)
  v_mfma_f32_16x16x32_bf16 v[44:47], v[100:103], v[112:115], v[44:47]
  ds_read_b128 v[76:79], v24 offset:2048
  ds_read_b128 v[80:83], v24 offset:4096
  v_mfma_f32_16x16x32_bf16 v[60:63], v[100:103], v[116:119], v[60:63]
  s_waitcnt lgkmcnt(6)
  v_mfma_f32_16x16x32_bf16 v[48:51], v[104:107], v[112:115], v[48:51]
  ds_read_b128 v[84:87], v24 offset:6144
  v_mfma_f32_16x16x32_bf16 v[64:67], v[104:107], v[116:119], v[64:67]
  s_waitcnt lgkmcnt(6)
  v_mfma_f32_16x16x32_bf16 v[52:55], v[108:111], v[112:115], v[52:55]
  v_mfma_f32_16x16x32_bf16 v[68:71], v[108:111], v[116:119], v[68:71]
  v_add_u32 v26, 135168, v22
  v_add_u32 v27, 149504, v23
  s_waitcnt lgkmcnt(0)
  s_barrier
  v_mfma_f32_16x16x32_bf16 v[40:43], v[72:75], v[88:91], v[40:43]
  ds_read_b128 v[96:99], v26 offset:0
  ds_read_b128 v[112:115], v27 offset:0
  v_mfma_f32_16x16x32_bf16 v[56:59], v[72:75], v[92:95], v[56:59]
  ds_read_b128 v[116:119], v27 offset:2048
  v_mfma_f32_16x16x32_bf16 v[44:47], v[76:79], v[88:91], v[44:47]
  ds_read_b128 v[100:103], v26 offset:2048
  ds_read_b128 v[104:107], v26 offset:4096
  v_mfma_f32_16x16x32_bf16 v[60:63], v[76:79], v[92:95], v[60:63]
  v_mfma_f32_16x16x32_bf16 v[48:51], v[80:83], v[88:91], v[48:51]
  ds_read_b128 v[108:111], v26 offset:6144
  v_mfma_f32_16x16x32_bf16 v[64:67], v[80:83], v[92:95], v[64:67]
  v_mfma_f32_16x16x32_bf16 v[52:55], v[84:87], v[88:91], v[52:55]
  v_mfma_f32_16x16x32_bf16 v[68:71], v[84:87], v[92:95], v[68:71]
  v_add_u32 v24, 0, v22
  v_add_u32 v25, 14336, v23
  s_waitcnt lgkmcnt(3)
  v_mfma_f32_16x16x32_bf16 v[40:43], v[96:99], v[112:115], v[40:43]
  ds_read_b128 v[72:75], v24 offset:0
  ds_read_b128 v[88:91], v25 offset:0
  v_mfma_f32_16x16x32_bf16 v[56:59], v[96:99], v[116:119], v[56:59]
  ds_read_b128 v[92:95], v25 offset:2048
  s_waitcnt lgkmcnt(5)
  v_mfma_f32_16x16x32_bf16 v[44:47], v[100:103], v[112:115], v[44:47]
  ds_read_b128 v[76:79], v24 offset:2048
  ds_read_b128 v[80:83], v24 offset:4096
  v_mfma_f32_16x16x32_bf16 v[60:63], v[100:103], v[116:119], v[60:63]
  s_waitcnt lgkmcnt(6)
  v_mfma_f32_16x16x32_bf16 v[48:51], v[104:107], v[112:115], v[48:51]
  ds_read_b128 v[84:87], v24 offset:6144
  v_mfma_f32_16x16x32_bf16 v[64:67], v[104:107], v[116:119], v[64:67]
  s_waitcnt lgkmcnt(6)
  v_mfma_f32_16x16x32_bf16 v[52:55], v[108:111], v[112:115], v[52:55]
  v_mfma_f32_16x16x32_bf16 v[68:71], v[108:111], v[116:119], v[68:71]
  v_add_u32 v26, 22528, v22
  v_add_u32 v27, 36864, v23
  s_waitcnt lgkmcnt(0)
  s_barrier
  v_mfma_f32_16x16x32_bf16 v[40:43], v[72:75], v[88:91], v[40:43]
  ds_read_b128 v[96:99], v26 offset:0
  ds_read_b128 v[112:115], v27 offset:0
  v_mfma_f32_16x16x32_bf16 v[56:59], v[72:75], v[92:95], v[56:59]
  ds_read_b128 v[116:119], v27 offset:2048
  v_mfma_f32_16x16x32_bf16 v[44:47], v[76:79], v[88:91], v[44:47]
  ds_read_b128 v[100:103], v26 offset:2048
  ds_read_b128 v[104:107], v26 offset:4096
  v_mfma_f32_16x16x32_bf16 v[60:63], v[76:79], v[92:95], v[60:63]
  v_mfma_f32_16x16x32_bf16 v[48:51], v[80:83], v[88:91], v[48:51]
  ds_read_b128 v[108:111], v26 offset:6144
  v_mfma_f32_16x16x32_bf16 v[64:67], v[80:83], v[92:95], v[64:67]
  v_mfma_f32_16x16x32_bf16 v[52:55], v[84:87], v[88:91], v[52:55]
  v_mfma_f32_16x16x32_bf16 v[68:71], v[84:87], v[92:95], v[68:71]
  v_add_u32 v24, 45056, v22
  v_add_u32 v25, 59392, v23
  s_waitcnt lgkmcnt(3)
  v_mfma_f32_16x16x32_bf16 v[40:43], v[96:99], v[112:115], v[40:43]
  ds_read_b128 v[72:75], v24 offset:0
  ds_read_b128 v[88:91], v25 offset:0
  v_mfma_f32_16x16x32_bf16 v[56:59], v[96:99], v[116:119], v[56:59]
  ds_read_b128 v[92:95], v25 offset:2048
  s_waitcnt lgkmcnt(5)
  v_mfma_f32_16x16x32_bf16 v[44:47], v[100:103], v[112:115], v[44:47]
  ds_read_b128 v[76:79], v24 offset:2048
  ds_read_b128 v[80:83], v24 offset:4096
  v_mfma_f32_16x16x32_bf16 v[60:63], v[100:103], v[116:119], v[60:63]
  s_waitcnt lgkmcnt(6)
  v_mfma_f32_16x16x32_bf16 v[48:51], v[104:107], v[112:115], v[48:51]
  ds_read_b128 v[84:87], v24 offset:6144
  v_mfma_f32_16x16x32_bf16 v[64:67], v[104:107], v[116:119], v[64:67]
  s_waitcnt lgkmcnt(6)
  v_mfma_f32_16x16x32_bf16 v[52:55], v[108:111], v[112:115], v[52:55]
  v_mfma_f32_16x16x32_bf16 v[68:71], v[108:111], v[116:119], v[68:71]
  v_add_u32 v26, 67584, v22
  v_add_u32 v27, 81920, v23
  s_waitcnt lgkmcnt(0)
  s_barrier
  v_mfma_f32_16x16x32_bf16 v[40:43], v[72:75], v[88:91], v[40:43]
  ds_read_b128 v[96:99], v26 offset:0
  ds_read_b128 v[112:115], v27 offset:0
  v_mfma_f32_16x16x32_bf16 v[56:59], v[72:75], v[92:95], v[56:59]
  ds_read_b128 v[116:119], v27 offset:2048
  v_mfma_f32_16x16x32_bf16 v[44:47], v[76:79], v[88:91], v[44:47]
  ds_read_b128 v[100:103], v26 offset:2048
  ds_read_b128 v[104:107], v26 offset:4096
  v_mfma_f32_16x16x32_bf16 v[60:63], v[76:79], v[92:95], v[60:63]
  v_mfma_f32_16x16x32_bf16 v[48:51], v[80:83], v[88:91], v[48:51]
  ds_read_b128 v[108:111], v26 offset:6144
  v_mfma_f32_16x16x32_bf16 v[64:67], v[80:83], v[92:95], v[64:67]
  v_mfma_f32_16x16x32_bf16 v[52:55], v[84:87], v[88:91], v[52:55]
  v_mfma_f32_16x16x32_bf16 v[68:71], v[84:87], v[92:95], v[68:71]
  v_add_u32 v24, 90112, v22
  v_add_u32 v25, 104448, v23
  s_waitcnt lgkmcnt(3)
  v_mfma_f32_16x16x32_bf16 v[40:43], v[96:99], v[112:115], v[40:43]
  ds_read_b128 v[72:75], v24 offset:0
  ds_read_b128 v[88:91], v25 offset:0
  v_mfma_f32_16x16x32_bf16 v[56:59], v[96:99], v[116:119], v[56:59]
  ds_read_b128 v[92:95], v25 offset:2048
  s_waitcnt lgkmcnt(5)
  v_mfma_f32_16x16x32_bf16 v[44:47], v[100:103], v[112:115], v[44:47]
  ds_read_b128 v[76:79], v24 offset:2048
  ds_read_b128 v[80:83], v24 offset:4096
  v_mfma_f32_16x16x32_bf16 v[60:63], v[100:103], v[116:119], v[60:63]
  s_waitcnt lgkmcnt(6)
  v_mfma_f32_16x16x32_bf16 v[48:51], v[104:107], v[112:115], v[48:51]
  ds_read_b128 v[84:87], v24 offset:6144
  v_mfma_f32_16x16x32_bf16 v[64:67], v[104:107], v[116:119], v[64:67]
  s_waitcnt lgkmcnt(6)
  v_mfma_f32_16x16x32_bf16 v[52:55], v[108:111], v[112:115], v[52:55]
  v_mfma_f32_16x16x32_bf16 v[68:71], v[108:111], v[116:119], v[68:71]
  v_add_u32 v26, 112640, v22
  v_add_u32 v27, 126976, v23
  s_waitcnt lgkmcnt(0)
  s_barrier
  v_mfma_f32_16x16x32_bf16 v[40:43], v[72:75], v[88:91], v[40:43]
  ds_read_b128 v[96:99], v26 offset:0
  ds_read_b128 v[112:115], v27 offset:0
  v_mfma_f32_16x16x32_bf16 v[56:59], v[72:75], v[92:95], v[56:59]
  ds_read_b128 v[116:119], v27 offset:2048
  v_mfma_f32_16x16x32_bf16 v[44:47], v[76:79], v[88:91], v[44:47]
  ds_read_b128 v[100:103], v26 offset:2048
  ds_read_b128 v[104:107], v26 offset:4096
  v_mfma_f32_16x16x32_bf16 v[60:63], v[76:79], v[92:95], v[60:63]
  v_mfma_f32_16x16x32_bf16 v[48:51], v[80:83], v[88:91], v[48:51]
  ds_read_b128 v[108:111], v26 offset:6144
  v_mfma_f32_16x16x32_bf16 v[64:67], v[80:83], v[92:95], v[64:67]
  v_mfma_f32_16x16x32_bf16 v[52:55], v[84:87], v[88:91], v[52:55]
  v_mfma_f32_16x16x32_bf16 v[68:71], v[84:87], v[92:95], v[68:71]
  v_add_u32 v24, 135168, v22
  v_add_u32 v25, 149504, v23
  s_waitcnt lgkmcnt(3)
  v_mfma_f32_16x16x32_bf16 v[40:43], v[96:99], v[112:115], v[40:43]
  ds_read_b128 v[72:75], v24 offset:0
  ds_read_b128 v[88:91], v25 offset:0
  v_mfma_f32_16x16x32_bf16 v[56:59], v[96:99], v[116:119], v[56:59]
  ds_read_b128 v[92:95], v25 offset:2048
  s_waitcnt lgkmcnt(5)
  v_mfma_f32_16x16x32_bf16 v[44:47], v[100:103], v[112:115], v[44:47]
  ds_read_b128 v[76:79], v24 offset:2048
  ds_read_b128 v[80:83], v24 offset:4096
  v_mfma_f32_16x16x32_bf16 v[60:63], v[100:103], v[116:119], v[60:63]
  s_waitcnt lgkmcnt(6)
  v_mfma_f32_16x16x32_bf16 v[48:51], v[104:107], v[112:115], v[48:51]
  ds_read_b128 v[84:87], v24 offset:6144
  v_mfma_f32_16x16x32_bf16 v[64:67], v[104:107], v[116:119], v[64:67]
  s_waitcnt lgkmcnt(6)
  v_mfma_f32_16x16x32_bf16 v[52:55], v[108:111], v[112:115], v[52:55]
  v_mfma_f32_16x16x32_bf16 v[68:71], v[108:111], v[116:119], v[68:71]
  v_add_u32 v26, 0, v22
  v_add_u32 v27, 14336, v23
  s_waitcnt lgkmcnt(0)
  s_barrier
  v_mfma_f32_16x16x32_bf16 v[40:43], v[72:75], v[88:91], v[40:43]
  ds_read_b128 v[96:99], v26 offset:0
  ds_read_b128 v[112:115], v27 offset:0
  v_mfma_f32_16x16x32_bf16 v[56:59], v[72:75], v[92:95], v[56:59]
  ds_read_b128 v[116:119], v27 offset:2048
  v_mfma_f32_16x16x32_bf16 v[44:47], v[76:79], v[88:91], v[44:47]
  ds_read_b128 v[100:103], v26 offset:2048
  ds_read_b128 v[104:107], v26 offset:4096
  v_mfma_f32_16x16x32_bf16 v[60:63], v[76:79], v[92:95], v[60:63]
  v_mfma_f32_16x16x32_bf16 v[48:51], v[80:83], v[88:91], v[48:51]
  ds_read_b128 v[108:111], v26 offset:6144
  v_mfma_f32_16x16x32_bf16 v[64:67], v[80:83], v[92:95], v[64:67]
  v_mfma_f32_16x16x32_bf16 v[52:55], v[84:87], v[88:91], v[52:55]
  v_mfma_f32_16x16x32_bf16 v[68:71], v[84:87], v[92:95], v[68:71]
  v_add_u32 v24, 22528, v22
  v_add_u32 v25, 36864, v23
  s_waitcnt lgkmcnt(3)
  v_mfma_f32_16x16x32_bf16 v[40:43], v[96:99], v[112:115], v[40:43]
  ds_read_b128 v[72:75], v24 offset:0
  ds_read_b128 v[88:91], v25 offset:0
  v_mfma_f32_16x16x32_bf16 v[56:59], v[96:99], v[116:119], v[56:59]
  ds_read_b128 v[92:95], v25 offset:2048
  s_waitcnt lgkmcnt(5)
  v_mfma_f32_16x16x32_bf16 v[44:47], v[100:103], v[112:115], v[44:47]
  ds_read_b128 v[76:79], v24 offset:2048
  ds_read_b128 v[80:83], v24 offset:4096
  v_mfma_f32_16x16x32_bf16 v[60:63], v[100:103], v[116:119], v[60:63]
  s_waitcnt lgkmcnt(6)
  v_mfma_f32_16x16x32_bf16 v[48:51], v[104:107], v[112:115], v[48:51]
  ds_read_b128 v[84:87], v24 offset:6144
  v_mfma_f32_16x16x32_bf16 v[64:67], v[104:107], v[116:119], v[64:67]
  s_waitcnt lgkmcnt(6)
  v_mfma_f32_16x16x32_bf16 v[52:55], v[108:111], v[112:115], v[52:55]
  v_mfma_f32_16x16x32_bf16 v[68:71], v[108:111], v[116:119], v[68:71]
  v_add_u32 v26, 45056, v22
  v_add_u32 v27, 59392, v23
  s_waitcnt lgkmcnt(0)
  s_barrier
  v_mfma_f32_16x16x32_bf16 v[40:43], v[72:75], v[88:91], v[40:43]
  ds_read_b128 v[96:99], v26 offset:0
  ds_read_b128 v[112:115], v27 offset:0
  v_mfma_f32_16x16x32_bf16 v[56:59], v[72:75], v[92:95], v[56:59]
  ds_read_b128 v[116:119], v27 offset:2048
  v_mfma_f32_16x16x32_bf16 v[44:47], v[76:79], v[88:91], v[44:47]
  ds_read_b128 v[100:103], v26 offset:2048
  ds_read_b128 v[104:107], v26 offset:4096
  v_mfma_f32_16x16x32_bf16 v[60:63], v[76:79], v[92:95], v[60:63]
  v_mfma_f32_16x16x32_bf16 v[48:51], v[80:83], v[88:91], v[48:51]
  ds_read_b128 v[108:111], v26 offset:6144
  v_mfma_f32_16x16x32_bf16 v[64:67], v[80:83], v[92:95], v[64:67]
  v_mfma_f32_16x16x32_bf16 v[52:55], v[84:87], v[88:91], v[52:55]
  v_mfma_f32_16x16x32_bf16 v[68:71], v[84:87], v[92:95], v[68:71]
  v_add_u32 v24, 67584, v22
  v_add_u32 v25, 81920, v23
  s_waitcnt lgkmcnt(3)
  v_mfma_f32_16x16x32_bf16 v[40:43], v[96:99], v[112:115], v[40:43]
  ds_read_b128 v[72:75], v24 offset:0
  ds_read_b128 v[88:91], v25 offset:0
  v_mfma_f32_16x16x32_bf16 v[56:59], v[96:99], v[116:119], v[56:59]
  ds_read_b128 v[92:95], v25 offset:2048
  s_waitcnt lgkmcnt(5)
  v_mfma_f32_16x16x32_bf16 v[44:47], v[100:103], v[112:115], v[44:47]
  ds_read_b128 v[76:79], v24 offset:2048
  ds_read_b128 v[80:83], v24 offset:4096
  v_mfma_f32_16x16x32_bf16 v[60:63], v[100:103], v[116:119], v[60:63]
  s_waitcnt lgkmcnt(6)
  v_mfma_f32_16x16x32_bf16 v[48:51], v[104:107], v[112:115], v[48:51]
  ds_read_b128 v[84:87], v24 offset:6144
  v_mfma_f32_16x16x32_bf16 v[64:67], v[104:107], v[116:119], v[64:67]
  s_waitcnt lgkmcnt(6)
  v_mfma_f32_16x16x32_bf16 v[52:55], v[108:111], v[112:115], v[52:55]
  v_mfma_f32_16x16x32_bf16 v[68:71], v[108:111], v[116:119], v[68:71]
  v_add_u32 v26, 90112, v22
  v_add_u32 v27, 104448, v23
  s_waitcnt lgkmcnt(0)
  s_barrier
  v_mfma_f32_16x16x32_bf16 v[40:43], v[72:75], v[88:91], v[40:43]
  ds_read_b128 v[96:99], v26 offset:0
  ds_read_b128 v[112:115], v27 offset:0
  v_mfma_f32_16x16x32_bf16 v[56:59], v[72:75], v[92:95], v[56:59]
  ds_read_b128 v[116:119], v27 offset:2048
  v_mfma_f32_16x16x32_bf16 v[44:47], v[76:79], v[88:91], v[44:47]
  ds_read_b128 v[100:103], v26 offset:2048
  ds_read_b128 v[104:107], v26 offset:4096
  v_mfma_f32_16x16x32_bf16 v[60:63], v[76:79], v[92:95], v[60:63]
  v_mfma_f32_16x16x32_bf16 v[48:51], v[80:83], v[88:91], v[48:51]
  ds_read_b128 v[108:111], v26 offset:6144
  v_mfma_f32_16x16x32_bf16 v[64:67], v[80:83], v[92:95], v[64:67]
  v_mfma_f32_16x16x32_bf16 v[52:55], v[84:87], v[88:91], v[52:55]
  v_mfma_f32_16x16x32_bf16 v[68:71], v[84:87], v[92:95], v[68:71]
  v_add_u32 v24, 112640, v22
  v_add_u32 v25, 126976, v23
  s_waitcnt lgkmcnt(3)
  v_mfma_f32_16x16x32_bf16 v[40:43], v[96:99], v[112:115], v[40:43]
  ds_read_b128 v[72:75], v24 offset:0
  ds_read_b128 v[88:91], v25 offset:0
  v_mfma_f32_16x16x32_bf16 v[56:59], v[96:99], v[116:119], v[56:59]
  ds_read_b128 v[92:95], v25 offset:2048
  s_waitcnt lgkmcnt(5)
  v_mfma_f32_16x16x32_bf16 v[44:47], v[100:103], v[112:115], v[44:47]
  ds_read_b128 v[76:79], v24 offset:2048
  ds_read_b128 v[80:83], v24 offset:4096
  v_mfma_f32_16x16x32_bf16 v[60:63], v[100:103], v[116:119], v[60:63]
  s_waitcnt lgkmcnt(6)
  v_mfma_f32_16x16x32_bf16 v[48:51], v[104:107], v[112:115], v[48:51]
  ds_read_b128 v[84:87], v24 offset:6144
  v_mfma_f32_16x16x32_bf16 v[64:67], v[104:107], v[116:119], v[64:67]
  s_waitcnt lgkmcnt(6)
  v_mfma_f32_16x16x32_bf16 v[52:55], v[108:111], v[112:115], v[52:55]
  v_mfma_f32_16x16x32_bf16 v[68:71], v[108:111], v[116:119], v[68:71]
  v_add_u32 v26, 135168, v22
  v_add_u32 v27, 149504, v23
  s_waitcnt lgkmcnt(0)
  s_barrier
  v_mfma_f32_16x16x32_bf16 v[40:43], v[72:75], v[88:91], v[40:43]
  ds_read_b128 v[96:99], v26 offset:0
  ds_read_b128 v[112:115], v27 offset:0
  v_mfma_f32_16x16x32_bf16 v[56:59], v[72:75], v[92:95], v[56:59]
  ds_read_b128 v[116:119], v27 offset:2048
  v_mfma_f32_16x16x32_bf16 v[44:47], v[76:79], v[88:91], v[44:47]
  ds_read_b128 v[100:103], v26 offset:2048
  ds_read_b128 v[104:107], v26 offset:4096
  v_mfma_f32_16x16x32_bf16 v[60:63], v[76:79], v[92:95], v[60:63]
  v_mfma_f32_16x16x32_bf16 v[48:51], v[80:83], v[88:91], v[48:51]
  ds_read_b128 v[108:111], v26 offset:6144
  v_mfma_f32_16x16x32_bf16 v[64:67], v[80:83], v[92:95], v[64:67]
  v_mfma_f32_16x16x32_bf16 v[52:55], v[84:87], v[88:91], v[52:55]
  v_mfma_f32_16x16x32_bf16 v[68:71], v[84:87], v[92:95], v[68:71]
  v_add_u32 v24, 0, v22
  v_add_u32 v25, 14336, v23
  s_waitcnt lgkmcnt(3)
  v_mfma_f32_16x16x32_bf16 v[40:43], v[96:99], v[112:115], v[40:43]
  ds_read_b128 v[72:75], v24 offset:0
  ds_read_b128 v[88:91], v25 offset:0
  v_mfma_f32_16x16x32_bf16 v[56:59], v[96:99], v[116:119], v[56:59]
  ds_read_b128 v[92:95], v25 offset:2048
  s_waitcnt lgkmcnt(5)
  v_mfma_f32_16x16x32_bf16 v[44:47], v[100:103], v[112:115], v[44:47]
  ds_read_b128 v[76:79], v24 offset:2048
  ds_read_b128 v[80:83], v24 offset:4096
  v_mfma_f32_16x16x32_bf16 v[60:63], v[100:103], v[116:119], v[60:63]
  s_waitcnt lgkmcnt(6)
  v_mfma_f32_16x16x32_bf16 v[48:51], v[104:107], v[112:115], v[48:51]
  ds_read_b128 v[84:87], v24 offset:6144
  v_mfma_f32_16x16x32_bf16 v[64:67], v[104:107], v[116:119], v[64:67]
  s_waitcnt lgkmcnt(6)
  v_mfma_f32_16x16x32_bf16 v[52:55], v[108:111], v[112:115], v[52:55]
  v_mfma_f32_16x16x32_bf16 v[68:71], v[108:111], v[116:119], v[68:71]
  v_add_u32 v26, 22528, v22
  v_add_u32 v27, 36864, v23
  s_waitcnt lgkmcnt(0)
  s_barrier
  v_mfma_f32_16x16x32_bf16 v[40:43], v[72:75], v[88:91], v[40:43]
  ds_read_b128 v[96:99], v26 offset:0
  ds_read_b128 v[112:115], v27 offset:0
  v_mfma_f32_16x16x32_bf16 v[56:59], v[72:75], v[92:95], v[56:59]
  ds_read_b128 v[116:119], v27 offset:2048
  v_mfma_f32_16x16x32_bf16 v[44:47], v[76:79], v[88:91], v[44:47]
  ds_read_b128 v[100:103], v26 offset:2048
  ds_read_b128 v[104:107], v26 offset:4096
  v_mfma_f32_16x16x32_bf16 v[60:63], v[76:79], v[92:95], v[60:63]
  v_mfma_f32_16x16x32_bf16 v[48:51], v[80:83], v[88:91], v[48:51]
  ds_read_b128 v[108:111], v26 offset:6144
  v_mfma_f32_16x16x32_bf16 v[64:67], v[80:83], v[92:95], v[64:67]
  v_mfma_f32_16x16x32_bf16 v[52:55], v[84:87], v[88:91], v[52:55]
  v_mfma_f32_16x16x32_bf16 v[68:71], v[84:87], v[92:95], v[68:71]
  v_add_u32 v24, 45056, v22
  v_add_u32 v25, 59392, v23
  s_waitcnt lgkmcnt(3)
  v_mfma_f32_16x16x32_bf16 v[40:43], v[96:99], v[112:115], v[40:43]
  ds_read_b128 v[72:75], v24 offset:0
  ds_read_b128 v[88:91], v25 offset:0
  v_mfma_f32_16x16x32_bf16 v[56:59], v[96:99], v[116:119], v[56:59]
  ds_read_b128 v[92:95], v25 offset:2048
  s_waitcnt lgkmcnt(5)
  v_mfma_f32_16x16x32_bf16 v[44:47], v[100:103], v[112:115], v[44:47]
  ds_read_b128 v[76:79], v24 offset:2048
  ds_read_b128 v[80:83], v24 offset:4096
  v_mfma_f32_16x16x32_bf16 v[60:63], v[100:103], v[116:119], v[60:63]
  s_waitcnt lgkmcnt(6)
  v_mfma_f32_16x16x32_bf16 v[48:51], v[104:107], v[112:115], v[48:51]
  ds_read_b128 v[84:87], v24 offset:6144
  v_mfma_f32_16x16x32_bf16 v[64:67], v[104:107], v[116:119], v[64:67]
  s_waitcnt lgkmcnt(6)
  v_mfma_f32_16x16x32_bf16 v[52:55], v[108:111], v[112:115], v[52:55]
  v_mfma_f32_16x16x32_bf16 v[68:71], v[108:111], v[116:119], v[68:71]
  v_add_u32 v26, 67584, v22
  v_add_u32 v27, 81920, v23
  s_waitcnt lgkmcnt(0)
  s_barrier
  v_mfma_f32_16x16x32_bf16 v[40:43], v[72:75], v[88:91], v[40:43]
  ds_read_b128 v[96:99], v26 offset:0
  ds_read_b128 v[112:115], v27 offset:0
  v_mfma_f32_16x16x32_bf16 v[56:59], v[72:75], v[92:95], v[56:59]
  ds_read_b128 v[116:119], v27 offset:2048
  v_mfma_f32_16x16x32_bf16 v[44:47], v[76:79], v[88:91], v[44:47]
  ds_read_b128 v[100:103], v26 offset:2048
  ds_read_b128 v[104:107], v26 offset:4096
  v_mfma_f32_16x16x32_bf16 v[60:63], v[76:79], v[92:95], v[60:63]
  v_mfma_f32_16x16x32_bf16 v[48:51], v[80:83], v[88:91], v[48:51]
  ds_read_b128 v[108:111], v26 offset:6144
  v_mfma_f32_16x16x32_bf16 v[64:67], v[80:83], v[92:95], v[64:67]
  v_mfma_f32_16x16x32_bf16 v[52:55], v[84:87], v[88:91], v[52:55]
  v_mfma_f32_16x16x32_bf16 v[68:71], v[84:87], v[92:95], v[68:71]
  s_waitcnt lgkmcnt(3)
  v_mfma_f32_16x16x32_bf16 v[40:43], v[96:99], v[112:115], v[40:43]
  v_mfma_f32_16x16x32_bf16 v[56:59], v[96:99], v[116:119], v[56:59]
  s_waitcnt lgkmcnt(2)
  v_mfma_f32_16x16x32_bf16 v[44:47], v[100:103], v[112:115], v[44:47]
  v_mfma_f32_16x16x32_bf16 v[60:63], v[100:103], v[116:119], v[60:63]
  s_waitcnt lgkmcnt(1)
  v_mfma_f32_16x16x32_bf16 v[48:51], v[104:107], v[112:115], v[48:51]
  v_mfma_f32_16x16x32_bf16 v[64:67], v[104:107], v[116:119], v[64:67]
  s_waitcnt lgkmcnt(0)
  v_mfma_f32_16x16x32_bf16 v[52:55], v[108:111], v[112:115], v[52:55]
  v_mfma_f32_16x16x32_bf16 v[68:71], v[108:111], v[116:119], v[68:71]
  s_nop 7
  s_lshl_b32 s18, s8, 12
  s_add_u32 s18, s18, 90112
  v_add_u32 v5, s18, v2
  s_xor_b32 s18, s8, 1
  s_lshl_b32 s18, s18, 12
  s_add_u32 s18, s18, 90112
  v_add_u32 v6, s18, v2
  s_cmp_eq_u32 s16, 1
  s_cbranch_scc1 P4_k1_11
  ds_write_b128 v5, v[56:59] offset:0
  ds_write_b128 v5, v[60:63] offset:1024
  ds_write_b128 v5, v[64:67] offset:2048
  ds_write_b128 v5, v[68:71] offset:3072
  s_branch P4_k2_12
P4_k1_11:
  ds_write_b128 v5, v[40:43] offset:0
  ds_write_b128 v5, v[44:47] offset:1024
  ds_write_b128 v5, v[48:51] offset:2048
  ds_write_b128 v5, v[52:55] offset:3072
  v_mov_b32 v40, v56
  v_mov_b32 v41, v57
  v_mov_b32 v42, v58
  v_mov_b32 v43, v59
  v_mov_b32 v44, v60
  v_mov_b32 v45, v61
  v_mov_b32 v46, v62
  v_mov_b32 v47, v63
  v_mov_b32 v48, v64
  v_mov_b32 v49, v65
  v_mov_b32 v50, v66
  v_mov_b32 v51, v67
  v_mov_b32 v52, v68
  v_mov_b32 v53, v69
  v_mov_b32 v54, v70
  v_mov_b32 v55, v71
P4_k2_12:
  s_waitcnt vmcnt(0) lgkmcnt(0)
  s_barrier
  ds_read_b128 v[72:75], v6 offset:0
  ds_read_b128 v[76:79], v6 offset:1024
  ds_read_b128 v[80:83], v6 offset:2048
  ds_read_b128 v[84:87], v6 offset:3072
  v_lshlrev_b32 v30, 16, v30
  s_waitcnt lgkmcnt(0)
  v_add_f32 v40, v40, v72
  v_add_f32 v41, v41, v73
  v_add_f32 v42, v42, v74
  v_add_f32 v43, v43, v75
  v_add_f32 v40, v40, v30
  v_add_f32 v41, v41, v30
  v_add_f32 v42, v42, v30
  v_add_f32 v43, v43, v30
  v_lshlrev_b32 v88, 16, v32
  v_and_b32 v89, 0xffff0000, v32
  v_lshlrev_b32 v90, 16, v33
  v_and_b32 v91, 0xffff0000, v33
  v_mul_f32 v40, v40, v88
  v_mul_f32 v41, v41, v89
  v_mul_f32 v42, v42, v90
  v_mul_f32 v43, v43, v91
  v_cvt_pk_bf16_f32 v96, v40, v41
  v_cvt_pk_bf16_f32 v97, v42, v43
  v_add_f32 v44, v44, v76
  v_add_f32 v45, v45, v77
  v_add_f32 v46, v46, v78
  v_add_f32 v47, v47, v79
  v_add_f32 v44, v44, v30
  v_add_f32 v45, v45, v30
  v_add_f32 v46, v46, v30
  v_add_f32 v47, v47, v30
  v_lshlrev_b32 v88, 16, v34
  v_and_b32 v89, 0xffff0000, v34
  v_lshlrev_b32 v90, 16, v35
  v_and_b32 v91, 0xffff0000, v35
  v_mul_f32 v44, v44, v88
  v_mul_f32 v45, v45, v89
  v_mul_f32 v46, v46, v90
  v_mul_f32 v47, v47, v91
  v_cvt_pk_bf16_f32 v98, v44, v45
  v_cvt_pk_bf16_f32 v99, v46, v47
  v_add_f32 v48, v48, v80
  v_add_f32 v49, v49, v81
  v_add_f32 v50, v50, v82
  v_add_f32 v51, v51, v83
  v_add_f32 v48, v48, v30
  v_add_f32 v49, v49, v30
  v_add_f32 v50, v50, v30
  v_add_f32 v51, v51, v30
  v_lshlrev_b32 v88, 16, v36
  v_and_b32 v89, 0xffff0000, v36
  v_lshlrev_b32 v90, 16, v37
  v_and_b32 v91, 0xffff0000, v37
  v_mul_f32 v48, v48, v88
  v_mul_f32 v49, v49, v89
  v_mul_f32 v50, v50, v90
  v_mul_f32 v51, v51, v91
  v_cvt_pk_bf16_f32 v100, v48, v49
  v_cvt_pk_bf16_f32 v101, v50, v51
  v_add_f32 v52, v52, v84
  v_add_f32 v53, v53, v85
  v_add_f32 v54, v54, v86
  v_add_f32 v55, v55, v87
  v_add_f32 v52, v52, v30
  v_add_f32 v53, v53, v30
  v_add_f32 v54, v54, v30
  v_add_f32 v55, v55, v30
  v_lshlrev_b32 v88, 16, v38
  v_and_b32 v89, 0xffff0000, v38
  v_lshlrev_b32 v90, 16, v39
  v_and_b32 v91, 0xffff0000, v39
  v_mul_f32 v52, v52, v88
  v_mul_f32 v53, v53, v89
  v_mul_f32 v54, v54, v90
  v_mul_f32 v55, v55, v91
  v_cvt_pk_bf16_f32 v102, v52, v53
  v_cvt_pk_bf16_f32 v103, v54, v55
  s_add_u32 s40, s4, 25165824
  s_addc_u32 s41, s5, 0
  s_mov_b32 s42, 3670016
  s_mov_b32 s43, 0x20000
  v_and_b32 v5, 1, v3
  v_lshlrev_b32 v5, 1, v5
  v_lshrrev_b32 v6, 1, v3
  v_or_b32 v5, v5, v6
  v_lshlrev_b32 v5, 8, v5
  v_lshl_add_u32 v5, v4, 4, v5
  s_mul_i32 s18, s36, 28
  s_mul_i32 s19, s13, 3
  s_add_u32 s19, s19, s18
  s_lshl_b32 s37, s14, 1
  s_add_u32 s19, s19, s37
  s_lshl_b32 s19, s19, 10
  v_permlane16_swap_b32 v96, v98
  v_permlane16_swap_b32 v97, v99
  buffer_store_dwordx4 v[96:99], v5, s[40:43], s19 offen offset:0 sc1
  v_permlane16_swap_b32 v100, v102
  v_permlane16_swap_b32 v101, v103
  buffer_store_dwordx4 v[100:103], v5, s[40:43], s19 offen offset:1024 sc1
  s_waitcnt vmcnt(0)
  s_branch P4_end
P4_f1_10:
  v_add_u32 v24, 0, v22
  v_add_u32 v25, 14336, v23
  v_add_u32 v26, 22528, v22
  v_add_u32 v27, 36864, v23
  s_barrier
  ds_read_b128 v[72:75], v24 offset:0
  ds_read_b128 v[88:91], v25 offset:0
  ds_read_b128 v[92:95], v25 offset:2048
  ds_read_b128 v[76:79], v24 offset:2048
  ds_read_b128 v[80:83], v24 offset:4096
  s_waitcnt lgkmcnt(0)
  s_barrier
  v_mfma_f32_16x16x32_bf16 v[40:43], v[72:75], v[88:91], 0
  ds_read_b128 v[96:99], v26 offset:0
  ds_read_b128 v[112:115], v27 offset:0
  v_mfma_f32_16x16x32_bf16 v[56:59], v[72:75], v[92:95], 0
  ds_read_b128 v[116:119], v27 offset:2048
  v_mfma_f32_16x16x32_bf16 v[44:47], v[76:79], v[88:91], 0
  ds_read_b128 v[100:103], v26 offset:2048
  ds_read_b128 v[104:107], v26 offset:4096
  v_mfma_f32_16x16x32_bf16 v[60:63], v[76:79], v[92:95], 0
  v_mfma_f32_16x16x32_bf16 v[48:51], v[80:83], v[88:91], 0
  v_mfma_f32_16x16x32_bf16 v[64:67], v[80:83], v[92:95], 0
  v_add_u32 v24, 45056, v22
  v_add_u32 v25, 59392, v23
  s_waitcnt lgkmcnt(2)
  v_mfma_f32_16x16x32_bf16 v[40:43], v[96:99], v[112:115], v[40:43]
  ds_read_b128 v[72:75], v24 offset:0
  ds_read_b128 v[88:91], v25 offset:0
  v_mfma_f32_16x16x32_bf16 v[56:59], v[96:99], v[116:119], v[56:59]
  ds_read_b128 v[92:95], v25 offset:2048
  s_waitcnt lgkmcnt(4)
  v_mfma_f32_16x16x32_bf16 v[44:47], v[100:103], v[112:115], v[44:47]
  ds_read_b128 v[76:79], v24 offset:2048
  ds_read_b128 v[80:83], v24 offset:4096
  v_mfma_f32_16x16x32_bf16 v[60:63], v[100:103], v[116:119], v[60:63]
  s_waitcnt lgkmcnt(5)
  v_mfma_f32_16x16x32_bf16 v[48:51], v[104:107], v[112:115], v[48:51]
  v_mfma_f32_16x16x32_bf16 v[64:67], v[104:107], v[116:119], v[64:67]
  v_add_u32 v26, 67584, v22
  v_add_u32 v27, 81920, v23
  s_waitcnt lgkmcnt(0)
  s_barrier
  v_mfma_f32_16x16x32_bf16 v[40:43], v[72:75], v[88:91], v[40:43]
  ds_read_b128 v[96:99], v26 offset:0
  ds_read_b128 v[112:115], v27 offset:0
  v_mfma_f32_16x16x32_bf16 v[56:59], v[72:75], v[92:95], v[56:59]
  ds_read_b128 v[116:119], v27 offset:2048
  v_mfma_f32_16x16x32_bf16 v[44:47], v[76:79], v[88:91], v[44:47]
  ds_read_b128 v[100:103], v26 offset:2048
  ds_read_b128 v[104:107], v26 offset:4096
  v_mfma_f32_16x16x32_bf16 v[60:63], v[76:79], v[92:95], v[60:63]
  v_mfma_f32_16x16x32_bf16 v[48:51], v[80:83], v[88:91], v[48:51]
  v_mfma_f32_16x16x32_bf16 v[64:67], v[80:83], v[92:95], v[64:67]
  v_add_u32 v24, 90112, v22
  v_add_u32 v25, 104448, v23
  s_waitcnt lgkmcnt(2)
  v_mfma_f32_16x16x32_bf16 v[40:43], v[96:99], v[112:115], v[40:43]
  ds_read_b128 v[72:75], v24 offset:0
  ds_read_b128 v[88:91], v25 offset:0
  v_mfma_f32_16x16x32_bf16 v[56:59], v[96:99], v[116:119], v[56:59]
  ds_read_b128 v[92:95], v25 offset:2048
  s_waitcnt lgkmcnt(4)
  v_mfma_f32_16x16x32_bf16 v[44:47], v[100:103], v[112:115], v[44:47]
  ds_read_b128 v[76:79], v24 offset:2048
  ds_read_b128 v[80:83], v24 offset:4096
  v_mfma_f32_16x16x32_bf16 v[60:63], v[100:103], v[116:119], v[60:63]
  s_waitcnt lgkmcnt(5)
  v_mfma_f32_16x16x32_bf16 v[48:51], v[104:107], v[112:115], v[48:51]
  v_mfma_f32_16x16x32_bf16 v[64:67], v[104:107], v[116:119], v[64:67]
  v_add_u32 v26, 112640, v22
  v_add_u32 v27, 126976, v23
  s_waitcnt lgkmcnt(0)
  s_barrier
  v_mfma_f32_16x16x32_bf16 v[40:43], v[72:75], v[88:91], v[40:43]
  ds_read_b128 v[96:99], v26 offset:0
  ds_read_b128 v[112:115], v27 offset:0
  v_mfma_f32_16x16x32_bf16 v[56:59], v[72:75], v[92:95], v[56:59]
  ds_read_b128 v[116:119], v27 offset:2048
  v_mfma_f32_16x16x32_bf16 v[44:47], v[76:79], v[88:91], v[44:47]
  ds_read_b128 v[100:103], v26 offset:2048
  ds_read_b128 v[104:107], v26 offset:4096
  v_mfma_f32_16x16x32_bf16 v[60:63], v[76:79], v[92:95], v[60:63]
  v_mfma_f32_16x16x32_bf16 v[48:51], v[80:83], v[88:91], v[48:51]
  v_mfma_f32_16x16x32_bf16 v[64:67], v[80:83], v[92:95], v[64:67]
  v_add_u32 v24, 135168, v22
  v_add_u32 v25, 149504, v23
  s_waitcnt lgkmcnt(2)
  v_mfma_f32_16x16x32_bf16 v[40:43], v[96:99], v[112:115], v[40:43]
  ds_read_b128 v[72:75], v24 offset:0
  ds_read_b128 v[88:91], v25 offset:0
  v_mfma_f32_16x16x32_bf16 v[56:59], v[96:99], v[116:119], v[56:59]
  ds_read_b128 v[92:95], v25 offset:2048
  s_waitcnt lgkmcnt(4)
  v_mfma_f32_16x16x32_bf16 v[44:47], v[100:103], v[112:115], v[44:47]
  ds_read_b128 v[76:79], v24 offset:2048
  ds_read_b128 v[80:83], v24 offset:4096
  v_mfma_f32_16x16x32_bf16 v[60:63], v[100:103], v[116:119], v[60:63]
  s_waitcnt lgkmcnt(5)
  v_mfma_f32_16x16x32_bf16 v[48:51], v[104:107], v[112:115], v[48:51]
  v_mfma_f32_16x16x32_bf16 v[64:67], v[104:107], v[116:119], v[64:67]
  v_add_u32 v26, 0, v22
  v_add_u32 v27, 14336, v23
  s_waitcnt lgkmcnt(0)
  s_barrier
  v_mfma_f32_16x16x32_bf16 v[40:43], v[72:75], v[88:91], v[40:43]
  ds_read_b128 v[96:99], v26 offset:0
  ds_read_b128 v[112:115], v27 offset:0
  v_mfma_f32_16x16x32_bf16 v[56:59], v[72:75], v[92:95], v[56:59]
  ds_read_b128 v[116:119], v27 offset:2048
  v_mfma_f32_16x16x32_bf16 v[44:47], v[76:79], v[88:91], v[44:47]
  ds_read_b128 v[100:103], v26 offset:2048
  ds_read_b128 v[104:107], v26 offset:4096
  v_mfma_f32_16x16x32_bf16 v[60:63], v[76:79], v[92:95], v[60:63]
  v_mfma_f32_16x16x32_bf16 v[48:51], v[80:83], v[88:91], v[48:51]
  v_mfma_f32_16x16x32_bf16 v[64:67], v[80:83], v[92:95], v[64:67]
  v_add_u32 v24, 22528, v22
  v_add_u32 v25, 36864, v23
  s_waitcnt lgkmcnt(2)
  v_mfma_f32_16x16x32_bf16 v[40:43], v[96:99], v[112:115], v[40:43]
  ds_read_b128 v[72:75], v24 offset:0
  ds_read_b128 v[88:91], v25 offset:0
  v_mfma_f32_16x16x32_bf16 v[56:59], v[96:99], v[116:119], v[56:59]
  ds_read_b128 v[92:95], v25 offset:2048
  s_waitcnt lgkmcnt(4)
  v_mfma_f32_16x16x32_bf16 v[44:47], v[100:103], v[112:115], v[44:47]
  ds_read_b128 v[76:79], v24 offset:2048
  ds_read_b128 v[80:83], v24 offset:4096
  v_mfma_f32_16x16x32_bf16 v[60:63], v[100:103], v[116:119], v[60:63]
  s_waitcnt lgkmcnt(5)
  v_mfma_f32_16x16x32_bf16 v[48:51], v[104:107], v[112:115], v[48:51]
  v_mfma_f32_16x16x32_bf16 v[64:67], v[104:107], v[116:119], v[64:67]
  v_add_u32 v26, 45056, v22
  v_add_u32 v27, 59392, v23
  s_waitcnt lgkmcnt(0)
  s_barrier
  v_mfma_f32_16x16x32_bf16 v[40:43], v[72:75], v[88:91], v[40:43]
  ds_read_b128 v[96:99], v26 offset:0
  ds_read_b128 v[112:115], v27 offset:0
  v_mfma_f32_16x16x32_bf16 v[56:59], v[72:75], v[92:95], v[56:59]
  ds_read_b128 v[116:119], v27 offset:2048
  v_mfma_f32_16x16x32_bf16 v[44:47], v[76:79], v[88:91], v[44:47]
  ds_read_b128 v[100:103], v26 offset:2048
  ds_read_b128 v[104:107], v26 offset:4096
  v_mfma_f32_16x16x32_bf16 v[60:63], v[76:79], v[92:95], v[60:63]
  v_mfma_f32_16x16x32_bf16 v[48:51], v[80:83], v[88:91], v[48:51]
  v_mfma_f32_16x16x32_bf16 v[64:67], v[80:83], v[92:95], v[64:67]
  v_add_u32 v24, 67584, v22
  v_add_u32 v25, 81920, v23
  s_waitcnt lgkmcnt(2)
  v_mfma_f32_16x16x32_bf16 v[40:43], v[96:99], v[112:115], v[40:43]
  ds_read_b128 v[72:75], v24 offset:0
  ds_read_b128 v[88:91], v25 offset:0
  v_mfma_f32_16x16x32_bf16 v[56:59], v[96:99], v[116:119], v[56:59]
  ds_read_b128 v[92:95], v25 offset:2048
  s_waitcnt lgkmcnt(4)
  v_mfma_f32_16x16x32_bf16 v[44:47], v[100:103], v[112:115], v[44:47]
  ds_read_b128 v[76:79], v24 offset:2048
  ds_read_b128 v[80:83], v24 offset:4096
  v_mfma_f32_16x16x32_bf16 v[60:63], v[100:103], v[116:119], v[60:63]
  s_waitcnt lgkmcnt(5)
  v_mfma_f32_16x16x32_bf16 v[48:51], v[104:107], v[112:115], v[48:51]
  v_mfma_f32_16x16x32_bf16 v[64:67], v[104:107], v[116:119], v[64:67]
  v_add_u32 v26, 90112, v22
  v_add_u32 v27, 104448, v23
  s_waitcnt lgkmcnt(0)
  s_barrier
  v_mfma_f32_16x16x32_bf16 v[40:43], v[72:75], v[88:91], v[40:43]
  ds_read_b128 v[96:99], v26 offset:0
  ds_read_b128 v[112:115], v27 offset:0
  v_mfma_f32_16x16x32_bf16 v[56:59], v[72:75], v[92:95], v[56:59]
  ds_read_b128 v[116:119], v27 offset:2048
  v_mfma_f32_16x16x32_bf16 v[44:47], v[76:79], v[88:91], v[44:47]
  ds_read_b128 v[100:103], v26 offset:2048
  ds_read_b128 v[104:107], v26 offset:4096
  v_mfma_f32_16x16x32_bf16 v[60:63], v[76:79], v[92:95], v[60:63]
  v_mfma_f32_16x16x32_bf16 v[48:51], v[80:83], v[88:91], v[48:51]
  v_mfma_f32_16x16x32_bf16 v[64:67], v[80:83], v[92:95], v[64:67]
  v_add_u32 v24, 112640, v22
  v_add_u32 v25, 126976, v23
  s_waitcnt lgkmcnt(2)
  v_mfma_f32_16x16x32_bf16 v[40:43], v[96:99], v[112:115], v[40:43]
  ds_read_b128 v[72:75], v24 offset:0
  ds_read_b128 v[88:91], v25 offset:0
  v_mfma_f32_16x16x32_bf16 v[56:59], v[96:99], v[116:119], v[56:59]
  ds_read_b128 v[92:95], v25 offset:2048
  s_waitcnt lgkmcnt(4)
  v_mfma_f32_16x16x32_bf16 v[44:47], v[100:103], v[112:115], v[44:47]
  ds_read_b128 v[76:79], v24 offset:2048
  ds_read_b128 v[80:83], v24 offset:4096
  v_mfma_f32_16x16x32_bf16 v[60:63], v[100:103], v[116:119], v[60:63]
  s_waitcnt lgkmcnt(5)
  v_mfma_f32_16x16x32_bf16 v[48:51], v[104:107], v[112:115], v[48:51]
  v_mfma_f32_16x16x32_bf16 v[64:67], v[104:107], v[116:119], v[64:67]
  v_add_u32 v26, 135168, v22
  v_add_u32 v27, 149504, v23
  s_waitcnt lgkmcnt(0)
  s_barrier
  v_mfma_f32_16x16x32_bf16 v[40:43], v[72:75], v[88:91], v[40:43]
  ds_read_b128 v[96:99], v26 offset:0
  ds_read_b128 v[112:115], v27 offset:0
  v_mfma_f32_16x16x32_bf16 v[56:59], v[72:75], v[92:95], v[56:59]
  ds_read_b128 v[116:119], v27 offset:2048
  v_mfma_f32_16x16x32_bf16 v[44:47], v[76:79], v[88:91], v[44:47]
  ds_read_b128 v[100:103], v26 offset:2048
  ds_read_b128 v[104:107], v26 offset:4096
  v_mfma_f32_16x16x32_bf16 v[60:63], v[76:79], v[92:95], v[60:63]
  v_mfma_f32_16x16x32_bf16 v[48:51], v[80:83], v[88:91], v[48:51]
  v_mfma_f32_16x16x32_bf16 v[64:67], v[80:83], v[92:95], v[64:67]
  v_add_u32 v24, 0, v22
  v_add_u32 v25, 14336, v23
  s_waitcnt lgkmcnt(2)
  v_mfma_f32_16x16x32_bf16 v[40:43], v[96:99], v[112:115], v[40:43]
  ds_read_b128 v[72:75], v24 offset:0
  ds_read_b128 v[88:91], v25 offset:0
  v_mfma_f32_16x16x32_bf16 v[56:59], v[96:99], v[116:119], v[56:59]
  ds_read_b128 v[92:95], v25 offset:2048
  s_waitcnt lgkmcnt(4)
  v_mfma_f32_16x16x32_bf16 v[44:47], v[100:103], v[112:115], v[44:47]
  ds_read_b128 v[76:79], v24 offset:2048
  ds_read_b128 v[80:83], v24 offset:4096
  v_mfma_f32_16x16x32_bf16 v[60:63], v[100:103], v[116:119], v[60:63]
  s_waitcnt lgkmcnt(5)
  v_mfma_f32_16x16x32_bf16 v[48:51], v[104:107], v[112:115], v[48:51]
  v_mfma_f32_16x16x32_bf16 v[64:67], v[104:107], v[116:119], v[64:67]
  v_add_u32 v26, 22528, v22
  v_add_u32 v27, 36864, v23
  s_waitcnt lgkmcnt(0)
  s_barrier
  v_mfma_f32_16x16x32_bf16 v[40:43], v[72:75], v[88:91], v[40:43]
  ds_read_b128 v[96:99], v26 offset:0
  ds_read_b128 v[112:115], v27 offset:0
  v_mfma_f32_16x16x32_bf16 v[56:59], v[72:75], v[92:95], v[56:59]
  ds_read_b128 v[116:119], v27 offset:2048
  v_mfma_f32_16x16x32_bf16 v[44:47], v[76:79], v[88:91], v[44:47]
  ds_read_b128 v[100:103], v26 offset:2048
  ds_read_b128 v[104:107], v26 offset:4096
  v_mfma_f32_16x16x32_bf16 v[60:63], v[76:79], v[92:95], v[60:63]
  v_mfma_f32_16x16x32_bf16 v[48:51], v[80:83], v[88:91], v[48:51]
  v_mfma_f32_16x16x32_bf16 v[64:67], v[80:83], v[92:95], v[64:67]
  v_add_u32 v24, 45056, v22
  v_add_u32 v25, 59392, v23
  s_waitcnt lgkmcnt(2)
  v_mfma_f32_16x16x32_bf16 v[40:43], v[96:99], v[112:115], v[40:43]
  ds_read_b128 v[72:75], v24 offset:0
  ds_read_b128 v[88:91], v25 offset:0
  v_mfma_f32_16x16x32_bf16 v[56:59], v[96:99], v[116:119], v[56:59]
  ds_read_b128 v[92:95], v25 offset:2048
  s_waitcnt lgkmcnt(4)
  v_mfma_f32_16x16x32_bf16 v[44:47], v[100:103], v[112:115], v[44:47]
  ds_read_b128 v[76:79], v24 offset:2048
  ds_read_b128 v[80:83], v24 offset:4096
  v_mfma_f32_16x16x32_bf16 v[60:63], v[100:103], v[116:119], v[60:63]
  s_waitcnt lgkmcnt(5)
  v_mfma_f32_16x16x32_bf16 v[48:51], v[104:107], v[112:115], v[48:51]
  v_mfma_f32_16x16x32_bf16 v[64:67], v[104:107], v[116:119], v[64:67]
  v_add_u32 v26, 67584, v22
  v_add_u32 v27, 81920, v23
  s_waitcnt lgkmcnt(0)
  s_barrier
  v_mfma_f32_16x16x32_bf16 v[40:43], v[72:75], v[88:91], v[40:43]
  ds_read_b128 v[96:99], v26 offset:0
  ds_read_b128 v[112:115], v27 offset:0
  v_mfma_f32_16x16x32_bf16 v[56:59], v[72:75], v[92:95], v[56:59]
  ds_read_b128 v[116:119], v27 offset:2048
  v_mfma_f32_16x16x32_bf16 v[44:47], v[76:79], v[88:91], v[44:47]
  ds_read_b128 v[100:103], v26 offset:2048
  ds_read_b128 v[104:107], v26 offset:4096
  v_mfma_f32_16x16x32_bf16 v[60:63], v[76:79], v[92:95], v[60:63]
  v_mfma_f32_16x16x32_bf16 v[48:51], v[80:83], v[88:91], v[48:51]
  v_mfma_f32_16x16x32_bf16 v[64:67], v[80:83], v[92:95], v[64:67]
  v_add_u32 v24, 90112, v22
  v_add_u32 v25, 104448, v23
  s_waitcnt lgkmcnt(2)
  v_mfma_f32_16x16x32_bf16 v[40:43], v[96:99], v[112:115], v[40:43]
  ds_read_b128 v[72:75], v24 offset:0
  ds_read_b128 v[88:91], v25 offset:0
  v_mfma_f32_16x16x32_bf16 v[56:59], v[96:99], v[116:119], v[56:59]
  ds_read_b128 v[92:95], v25 offset:2048
  s_waitcnt lgkmcnt(4)
  v_mfma_f32_16x16x32_bf16 v[44:47], v[100:103], v[112:115], v[44:47]
  ds_read_b128 v[76:79], v24 offset:2048
  ds_read_b128 v[80:83], v24 offset:4096
  v_mfma_f32_16x16x32_bf16 v[60:63], v[100:103], v[116:119], v[60:63]
  s_waitcnt lgkmcnt(5)
  v_mfma_f32_16x16x32_bf16 v[48:51], v[104:107], v[112:115], v[48:51]
  v_mfma_f32_16x16x32_bf16 v[64:67], v[104:107], v[116:119], v[64:67]
  v_add_u32 v26, 112640, v22
  v_add_u32 v27, 126976, v23
  s_waitcnt lgkmcnt(0)
  s_barrier
  v_mfma_f32_16x16x32_bf16 v[40:43], v[72:75], v[88:91], v[40:43]
  ds_read_b128 v[96:99], v26 offset:0
  ds_read_b128 v[112:115], v27 offset:0
  v_mfma_f32_16x16x32_bf16 v[56:59], v[72:75], v[92:95], v[56:59]
  ds_read_b128 v[116:119], v27 offset:2048
  v_mfma_f32_16x16x32_bf16 v[44:47], v[76:79], v[88:91], v[44:47]
  ds_read_b128 v[100:103], v26 offset:2048
  ds_read_b128 v[104:107], v26 offset:4096
  v_mfma_f32_16x16x32_bf16 v[60:63], v[76:79], v[92:95], v[60:63]
  v_mfma_f32_16x16x32_bf16 v[48:51], v[80:83], v[88:91], v[48:51]
  v_mfma_f32_16x16x32_bf16 v[64:67], v[80:83], v[92:95], v[64:67]
  v_add_u32 v24, 135168, v22
  v_add_u32 v25, 149504, v23
  s_waitcnt lgkmcnt(2)
  v_mfma_f32_16x16x32_bf16 v[40:43], v[96:99], v[112:115], v[40:43]
  ds_read_b128 v[72:75], v24 offset:0
  ds_read_b128 v[88:91], v25 offset:0
  v_mfma_f32_16x16x32_bf16 v[56:59], v[96:99], v[116:119], v[56:59]
  ds_read_b128 v[92:95], v25 offset:2048
  s_waitcnt lgkmcnt(4)
  v_mfma_f32_16x16x32_bf16 v[44:47], v[100:103], v[112:115], v[44:47]
  ds_read_b128 v[76:79], v24 offset:2048
  ds_read_b128 v[80:83], v24 offset:4096
  v_mfma_f32_16x16x32_bf16 v[60:63], v[100:103], v[116:119], v[60:63]
  s_waitcnt lgkmcnt(5)
  v_mfma_f32_16x16x32_bf16 v[48:51], v[104:107], v[112:115], v[48:51]
  v_mfma_f32_16x16x32_bf16 v[64:67], v[104:107], v[116:119], v[64:67]
  v_add_u32 v26, 0, v22
  v_add_u32 v27, 14336, v23
  s_waitcnt lgkmcnt(0)
  s_barrier
  v_mfma_f32_16x16x32_bf16 v[40:43], v[72:75], v[88:91], v[40:43]
  ds_read_b128 v[96:99], v26 offset:0
  ds_read_b128 v[112:115], v27 offset:0
  v_mfma_f32_16x16x32_bf16 v[56:59], v[72:75], v[92:95], v[56:59]
  ds_read_b128 v[116:119], v27 offset:2048
  v_mfma_f32_16x16x32_bf16 v[44:47], v[76:79], v[88:91], v[44:47]
  ds_read_b128 v[100:103], v26 offset:2048
  ds_read_b128 v[104:107], v26 offset:4096
  v_mfma_f32_16x16x32_bf16 v[60:63], v[76:79], v[92:95], v[60:63]
  v_mfma_f32_16x16x32_bf16 v[48:51], v[80:83], v[88:91], v[48:51]
  v_mfma_f32_16x16x32_bf16 v[64:67], v[80:83], v[92:95], v[64:67]
  v_add_u32 v24, 22528, v22
  v_add_u32 v25, 36864, v23
  s_waitcnt lgkmcnt(2)
  v_mfma_f32_16x16x32_bf16 v[40:43], v[96:99], v[112:115], v[40:43]
  ds_read_b128 v[72:75], v24 offset:0
  ds_read_b128 v[88:91], v25 offset:0
  v_mfma_f32_16x16x32_bf16 v[56:59], v[96:99], v[116:119], v[56:59]
  ds_read_b128 v[92:95], v25 offset:2048
  s_waitcnt lgkmcnt(4)
  v_mfma_f32_16x16x32_bf16 v[44:47], v[100:103], v[112:115], v[44:47]
  ds_read_b128 v[76:79], v24 offset:2048
  ds_read_b128 v[80:83], v24 offset:4096
  v_mfma_f32_16x16x32_bf16 v[60:63], v[100:103], v[116:119], v[60:63]
  s_waitcnt lgkmcnt(5)
  v_mfma_f32_16x16x32_bf16 v[48:51], v[104:107], v[112:115], v[48:51]
  v_mfma_f32_16x16x32_bf16 v[64:67], v[104:107], v[116:119], v[64:67]
  v_add_u32 v26, 45056, v22
  v_add_u32 v27, 59392, v23
  s_waitcnt lgkmcnt(0)
  s_barrier
  v_mfma_f32_16x16x32_bf16 v[40:43], v[72:75], v[88:91], v[40:43]
  ds_read_b128 v[96:99], v26 offset:0
  ds_read_b128 v[112:115], v27 offset:0
  v_mfma_f32_16x16x32_bf16 v[56:59], v[72:75], v[92:95], v[56:59]
  ds_read_b128 v[116:119], v27 offset:2048
  v_mfma_f32_16x16x32_bf16 v[44:47], v[76:79], v[88:91], v[44:47]
  ds_read_b128 v[100:103], v26 offset:2048
  ds_read_b128 v[104:107], v26 offset:4096
  v_mfma_f32_16x16x32_bf16 v[60:63], v[76:79], v[92:95], v[60:63]
  v_mfma_f32_16x16x32_bf16 v[48:51], v[80:83], v[88:91], v[48:51]
  v_mfma_f32_16x16x32_bf16 v[64:67], v[80:83], v[92:95], v[64:67]
  v_add_u32 v24, 67584, v22
  v_add_u32 v25, 81920, v23
  s_waitcnt lgkmcnt(2)
  v_mfma_f32_16x16x32_bf16 v[40:43], v[96:99], v[112:115], v[40:43]
  ds_read_b128 v[72:75], v24 offset:0
  ds_read_b128 v[88:91], v25 offset:0
  v_mfma_f32_16x16x32_bf16 v[56:59], v[96:99], v[116:119], v[56:59]
  ds_read_b128 v[92:95], v25 offset:2048
  s_waitcnt lgkmcnt(4)
  v_mfma_f32_16x16x32_bf16 v[44:47], v[100:103], v[112:115], v[44:47]
  ds_read_b128 v[76:79], v24 offset:2048
  ds_read_b128 v[80:83], v24 offset:4096
  v_mfma_f32_16x16x32_bf16 v[60:63], v[100:103], v[116:119], v[60:63]
  s_waitcnt lgkmcnt(5)
  v_mfma_f32_16x16x32_bf16 v[48:51], v[104:107], v[112:115], v[48:51]
  v_mfma_f32_16x16x32_bf16 v[64:67], v[104:107], v[116:119], v[64:67]
  v_add_u32 v26, 90112, v22
  v_add_u32 v27, 104448, v23
  s_waitcnt lgkmcnt(0)
  s_barrier
  v_mfma_f32_16x16x32_bf16 v[40:43], v[72:75], v[88:91], v[40:43]
  ds_read_b128 v[96:99], v26 offset:0
  ds_read_b128 v[112:115], v27 offset:0
  v_mfma_f32_16x16x32_bf16 v[56:59], v[72:75], v[92:95], v[56:59]
  ds_read_b128 v[116:119], v27 offset:2048
  v_mfma_f32_16x16x32_bf16 v[44:47], v[76:79], v[88:91], v[44:47]
  ds_read_b128 v[100:103], v26 offset:2048
  ds_read_b128 v[104:107], v26 offset:4096
  v_mfma_f32_16x16x32_bf16 v[60:63], v[76:79], v[92:95], v[60:63]
  v_mfma_f32_16x16x32_bf16 v[48:51], v[80:83], v[88:91], v[48:51]
  v_mfma_f32_16x16x32_bf16 v[64:67], v[80:83], v[92:95], v[64:67]
  v_add_u32 v24, 112640, v22
  v_add_u32 v25, 126976, v23
  s_waitcnt lgkmcnt(2)
  v_mfma_f32_16x16x32_bf16 v[40:43], v[96:99], v[112:115], v[40:43]
  ds_read_b128 v[72:75], v24 offset:0
  ds_read_b128 v[88:91], v25 offset:0
  v_mfma_f32_16x16x32_bf16 v[56:59], v[96:99], v[116:119], v[56:59]
  ds_read_b128 v[92:95], v25 offset:2048
  s_waitcnt lgkmcnt(4)
  v_mfma_f32_16x16x32_bf16 v[44:47], v[100:103], v[112:115], v[44:47]
  ds_read_b128 v[76:79], v24 offset:2048
  ds_read_b128 v[80:83], v24 offset:4096
  v_mfma_f32_16x16x32_bf16 v[60:63], v[100:103], v[116:119], v[60:63]
  s_waitcnt lgkmcnt(5)
  v_mfma_f32_16x16x32_bf16 v[48:51], v[104:107], v[112:115], v[48:51]
  v_mfma_f32_16x16x32_bf16 v[64:67], v[104:107], v[116:119], v[64:67]
  v_add_u32 v26, 135168, v22
  v_add_u32 v27, 149504, v23
  s_waitcnt lgkmcnt(0)
  s_barrier
  v_mfma_f32_16x16x32_bf16 v[40:43], v[72:75], v[88:91], v[40:43]
  ds_read_b128 v[96:99], v26 offset:0
  ds_read_b128 v[112:115], v27 offset:0
  v_mfma_f32_16x16x32_bf16 v[56:59], v[72:75], v[92:95], v[56:59]
  ds_read_b128 v[116:119], v27 offset:2048
  v_mfma_f32_16x16x32_bf16 v[44:47], v[76:79], v[88:91], v[44:47]
  ds_read_b128 v[100:103], v26 offset:2048
  ds_read_b128 v[104:107], v26 offset:4096
  v_mfma_f32_16x16x32_bf16 v[60:63], v[76:79], v[92:95], v[60:63]
  v_mfma_f32_16x16x32_bf16 v[48:51], v[80:83], v[88:91], v[48:51]
  v_mfma_f32_16x16x32_bf16 v[64:67], v[80:83], v[92:95], v[64:67]
  v_add_u32 v24, 0, v22
  v_add_u32 v25, 14336, v23
  s_waitcnt lgkmcnt(2)
  v_mfma_f32_16x16x32_bf16 v[40:43], v[96:99], v[112:115], v[40:43]
  ds_read_b128 v[72:75], v24 offset:0
  ds_read_b128 v[88:91], v25 offset:0
  v_mfma_f32_16x16x32_bf16 v[56:59], v[96:99], v[116:119], v[56:59]
  ds_read_b128 v[92:95], v25 offset:2048
  s_waitcnt lgkmcnt(4)
  v_mfma_f32_16x16x32_bf16 v[44:47], v[100:103], v[112:115], v[44:47]
  ds_read_b128 v[76:79], v24 offset:2048
  ds_read_b128 v[80:83], v24 offset:4096
  v_mfma_f32_16x16x32_bf16 v[60:63], v[100:103], v[116:119], v[60:63]
  s_waitcnt lgkmcnt(5)
  v_mfma_f32_16x16x32_bf16 v[48:51], v[104:107], v[112:115], v[48:51]
  v_mfma_f32_16x16x32_bf16 v[64:67], v[104:107], v[116:119], v[64:67]
  v_add_u32 v26, 22528, v22
  v_add_u32 v27, 36864, v23
  s_waitcnt lgkmcnt(0)
  s_barrier
  v_mfma_f32_16x16x32_bf16 v[40:43], v[72:75], v[88:91], v[40:43]
  ds_read_b128 v[96:99], v26 offset:0
  ds_read_b128 v[112:115], v27 offset:0
  v_mfma_f32_16x16x32_bf16 v[56:59], v[72:75], v[92:95], v[56:59]
  ds_read_b128 v[116:119], v27 offset:2048
  v_mfma_f32_16x16x32_bf16 v[44:47], v[76:79], v[88:91], v[44:47]
  ds_read_b128 v[100:103], v26 offset:2048
  ds_read_b128 v[104:107], v26 offset:4096
  v_mfma_f32_16x16x32_bf16 v[60:63], v[76:79], v[92:95], v[60:63]
  v_mfma_f32_16x16x32_bf16 v[48:51], v[80:83], v[88:91], v[48:51]
  v_mfma_f32_16x16x32_bf16 v[64:67], v[80:83], v[92:95], v[64:67]
  v_add_u32 v24, 45056, v22
  v_add_u32 v25, 59392, v23
  s_waitcnt lgkmcnt(2)
  v_mfma_f32_16x16x32_bf16 v[40:43], v[96:99], v[112:115], v[40:43]
  ds_read_b128 v[72:75], v24 offset:0
  ds_read_b128 v[88:91], v25 offset:0
  v_mfma_f32_16x16x32_bf16 v[56:59], v[96:99], v[116:119], v[56:59]
  ds_read_b128 v[92:95], v25 offset:2048
  s_waitcnt lgkmcnt(4)
  v_mfma_f32_16x16x32_bf16 v[44:47], v[100:103], v[112:115], v[44:47]
  ds_read_b128 v[76:79], v24 offset:2048
  ds_read_b128 v[80:83], v24 offset:4096
  v_mfma_f32_16x16x32_bf16 v[60:63], v[100:103], v[116:119], v[60:63]
  s_waitcnt lgkmcnt(5)
  v_mfma_f32_16x16x32_bf16 v[48:51], v[104:107], v[112:115], v[48:51]
  v_mfma_f32_16x16x32_bf16 v[64:67], v[104:107], v[116:119], v[64:67]
  v_add_u32 v26, 67584, v22
  v_add_u32 v27, 81920, v23
  s_waitcnt lgkmcnt(0)
  s_barrier
  v_mfma_f32_16x16x32_bf16 v[40:43], v[72:75], v[88:91], v[40:43]
  ds_read_b128 v[96:99], v26 offset:0
  ds_read_b128 v[112:115], v27 offset:0
  v_mfma_f32_16x16x32_bf16 v[56:59], v[72:75], v[92:95], v[56:59]
  ds_read_b128 v[116:119], v27 offset:2048
  v_mfma_f32_16x16x32_bf16 v[44:47], v[76:79], v[88:91], v[44:47]
  ds_read_b128 v[100:103], v26 offset:2048
  ds_read_b128 v[104:107], v26 offset:4096
  v_mfma_f32_16x16x32_bf16 v[60:63], v[76:79], v[92:95], v[60:63]
  v_mfma_f32_16x16x32_bf16 v[48:51], v[80:83], v[88:91], v[48:51]
  v_mfma_f32_16x16x32_bf16 v[64:67], v[80:83], v[92:95], v[64:67]
  s_waitcnt lgkmcnt(2)
  v_mfma_f32_16x16x32_bf16 v[40:43], v[96:99], v[112:115], v[40:43]
  v_mfma_f32_16x16x32_bf16 v[56:59], v[96:99], v[116:119], v[56:59]
  s_waitcnt lgkmcnt(1)
  v_mfma_f32_16x16x32_bf16 v[44:47], v[100:103], v[112:115], v[44:47]
  v_mfma_f32_16x16x32_bf16 v[60:63], v[100:103], v[116:119], v[60:63]
  s_waitcnt lgkmcnt(0)
  v_mfma_f32_16x16x32_bf16 v[48:51], v[104:107], v[112:115], v[48:51]
  v_mfma_f32_16x16x32_bf16 v[64:67], v[104:107], v[116:119], v[64:67]
  s_nop 7
  s_lshl_b32 s18, s8, 12
  s_add_u32 s18, s18, 90112
  v_add_u32 v5, s18, v2
  s_xor_b32 s18, s8, 1
  s_lshl_b32 s18, s18, 12
  s_add_u32 s18, s18, 90112
  v_add_u32 v6, s18, v2
  s_cmp_eq_u32 s16, 1
  s_cbranch_scc1 P4_k1_13
  ds_write_b128 v5, v[56:59] offset:0
  ds_write_b128 v5, v[60:63] offset:1024
  ds_write_b128 v5, v[64:67] offset:2048
  s_branch P4_k2_14
P4_k1_13:
  ds_write_b128 v5, v[40:43] offset:0
  ds_write_b128 v5, v[44:47] offset:1024
  ds_write_b128 v5, v[48:51] offset:2048
  v_mov_b32 v40, v56
  v_mov_b32 v41, v57
  v_mov_b32 v42, v58
  v_mov_b32 v43, v59
  v_mov_b32 v44, v60
  v_mov_b32 v45, v61
  v_mov_b32 v46, v62
  v_mov_b32 v47, v63
  v_mov_b32 v48, v64
  v_mov_b32 v49, v65
  v_mov_b32 v50, v66
  v_mov_b32 v51, v67
P4_k2_14:
  s_waitcnt vmcnt(0) lgkmcnt(0)
  s_barrier
  ds_read_b128 v[72:75], v6 offset:0
  ds_read_b128 v[76:79], v6 offset:1024
  ds_read_b128 v[80:83], v6 offset:2048
  v_lshlrev_b32 v30, 16, v30
  s_waitcnt lgkmcnt(0)
  v_add_f32 v40, v40, v72
  v_add_f32 v41, v41, v73
  v_add_f32 v42, v42, v74
  v_add_f32 v43, v43, v75
  v_add_f32 v40, v40, v30
  v_add_f32 v41, v41, v30
  v_add_f32 v42, v42, v30
  v_add_f32 v43, v43, v30
  v_lshlrev_b32 v88, 16, v32
  v_and_b32 v89, 0xffff0000, v32
  v_lshlrev_b32 v90, 16, v33
  v_and_b32 v91, 0xffff0000, v33
  v_mul_f32 v40, v40, v88
  v_mul_f32 v41, v41, v89
  v_mul_f32 v42, v42, v90
  v_mul_f32 v43, v43, v91
  v_cvt_pk_bf16_f32 v96, v40, v41
  v_cvt_pk_bf16_f32 v97, v42, v43
  v_add_f32 v44, v44, v76
  v_add_f32 v45, v45, v77
  v_add_f32 v46, v46, v78
  v_add_f32 v47, v47, v79
  v_add_f32 v44, v44, v30
  v_add_f32 v45, v45, v30
  v_add_f32 v46, v46, v30
  v_add_f32 v47, v47, v30
  v_lshlrev_b32 v88, 16, v34
  v_and_b32 v89, 0xffff0000, v34
  v_lshlrev_b32 v90, 16, v35
  v_and_b32 v91, 0xffff0000, v35
  v_mul_f32 v44, v44, v88
  v_mul_f32 v45, v45, v89
  v_mul_f32 v46, v46, v90
  v_mul_f32 v47, v47, v91
  v_cvt_pk_bf16_f32 v98, v44, v45
  v_cvt_pk_bf16_f32 v99, v46, v47
  v_add_f32 v48, v48, v80
  v_add_f32 v49, v49, v81
  v_add_f32 v50, v50, v82
  v_add_f32 v51, v51, v83
  v_add_f32 v48, v48, v30
  v_add_f32 v49, v49, v30
  v_add_f32 v50, v50, v30
  v_add_f32 v51, v51, v30
  v_lshlrev_b32 v88, 16, v36
  v_and_b32 v89, 0xffff0000, v36
  v_lshlrev_b32 v90, 16, v37
  v_and_b32 v91, 0xffff0000, v37
  v_mul_f32 v48, v48, v88
  v_mul_f32 v49, v49, v89
  v_mul_f32 v50, v50, v90
  v_mul_f32 v51, v51, v91
  v_cvt_pk_bf16_f32 v100, v48, v49
  v_cvt_pk_bf16_f32 v101, v50, v51
  s_add_u32 s40, s4, 25165824
  s_addc_u32 s41, s5, 0
  s_mov_b32 s42, 3670016
  s_mov_b32 s43, 0x20000
  v_and_b32 v5, 1, v3
  v_lshlrev_b32 v5, 1, v5
  v_lshrrev_b32 v6, 1, v3
  v_or_b32 v5, v5, v6
  v_lshlrev_b32 v5, 8, v5
  v_lshl_add_u32 v5, v4, 4, v5
  s_mul_i32 s18, s36, 28
  s_mul_i32 s19, s13, 3
  s_add_u32 s19, s19, s18
  s_lshl_b32 s37, s14, 1
  s_add_u32 s19, s19, s37
  s_lshl_b32 s19, s19, 10
  v_permlane16_swap_b32 v96, v98
  v_permlane16_swap_b32 v97, v99
  buffer_store_dwordx4 v[96:99], v5, s[40:43], s19 offen offset:0 sc1
  s_lshr_b32 s19, s13, 1
  s_add_u32 s19, s19, 24
  s_add_u32 s19, s19, s18
  s_lshl_b32 s19, s19, 10
  s_and_b32 s37, s13, 1
  s_lshl_b32 s37, s37, 9
  s_add_u32 s19, s19, s37
  v_lshrrev_b32 v6, 1, v3
  v_lshlrev_b32 v6, 8, v6
  v_lshl_add_u32 v6, v4, 4, v6
  v_and_b32 v7, 1, v3
  v_lshl_add_u32 v6, v7, 3, v6
  buffer_store_dwordx2 v[100:101], v6, s[40:43], s19 offen sc1
  s_waitcnt vmcnt(0)
  s_branch P4_end
P4_prod:
  s_and_b32 s9, s2, 3
  s_bfe_u32 s10, s2, 0x10002
  s_lshr_b32 s11, s2, 3
  s_and_b32 s12, s11, 7
  s_lshl_b32 s9, s9, 3
  s_add_u32 s12, s12, s9
  s_lshr_b32 s13, s11, 3
  s_lshl_b32 s10, s10, 2
  s_add_u32 s13, s13, s10
  s_sub_u32 s17, s8, 8
  s_lshl_b32 s18, s12, 6
  s_lshl_b32 s19, s17, 3
  s_add_u32 s18, s18, s19
  s_lshl_b32 s18, s18, 12
  s_add_u32 s28, s6, s18
  s_addc_u32 s29, s7, 0
  s_mov_b32 s30, 32768
  s_mov_b32 s31, 0x20000
  s_lshl_b32 s18, s17, 2
  v_add_u32 v16, s18, v3
  v_and_b32 v16, 7, v16
  v_and_b32 v17, 7, v1
  v_xor_b32 v16, v16, v17
  v_lshlrev_b32 v16, 4, v16
  v_lshrrev_b32 v17, 3, v1
  v_lshl_add_u32 v18, v17, 12, v16
  s_lshl_b32 s39, s17, 10
  s_add_u32 s39, s39, 14336
  s_mul_i32 s18, s13, 7
  s_lshl_b32 s18, s18, 16
  s_add_u32 s18, s18, 20971520
  s_add_u32 s24, s4, s18
  s_addc_u32 s25, s5, 0
  s_mov_b32 s26, 458752
  s_mov_b32 s27, 0x20000
  s_lshl_b32 s38, s17, 11
  s_lshl_b32 s18, s17, 16
  v_add_u32 v19, s18, v2
  s_lshl_b32 s58, s13, 12
  s_add_u32 s60, s4, 196608
  s_addc_u32 s61, s5, 0
  v_and_b32 v5, 31, v1
  v_lshlrev_b32 v5, 7, v5
  v_add_u32 v5, s58, v5
  s_mov_b32 s42, 0
  s_cmp_eq_u32 s17, 7
  s_cbranch_scc1 P4_q7_15
  s_add_u32 s46, s12, 0
  s_and_b32 s46, s46, 31
  s_lshl_b32 s46, s46, 11
  s_add_u32 m0, s38, 0
  s_nop 0
  buffer_load_dwordx4 v19, s[24:27], s46 offen sc1 lds
  buffer_load_dwordx4 v19, s[24:27], s46 offen offset:1024 sc1 lds
  s_add_u32 s46, s12, 1
  s_and_b32 s46, s46, 31
  s_bitcmp1_b32 s42, s46
  s_cbranch_scc1 P4_fok_17
  s_mov_b32 s59, 0
P4_fp_18:
  global_load_dword v6, v5, s[60:61] sc0 sc1
  s_waitcnt vmcnt(0)
  v_cmp_ne_u32 vcc, 0, v6
  s_nop 1
  s_mov_b32 s42, vcc_lo
  s_bitcmp1_b32 s42, s46
  s_cbranch_scc1 P4_fok_17
  s_add_u32 s59, s59, 1
  s_cmp_lt_u32 s59, 0x40000
  s_cbranch_scc1 P4_fp_18
P4_fok_17:
  s_lshl_b32 s46, s46, 11
  s_add_u32 m0, s38, 22528
  s_nop 0
  buffer_load_dwordx4 v19, s[24:27], s46 offen sc1 lds
  buffer_load_dwordx4 v19, s[24:27], s46 offen offset:1024 sc1 lds
  s_waitcnt vmcnt(2)
  s_barrier
  s_add_u32 s46, s12, 2
  s_and_b32 s46, s46, 31
  s_bitcmp1_b32 s42, s46
  s_cbranch_scc1 P4_fok_19
  s_mov_b32 s59, 0
P4_fp_20:
  global_load_dword v6, v5, s[60:61] sc0 sc1
  s_waitcnt vmcnt(0)
  v_cmp_ne_u32 vcc, 0, v6
  s_nop 1
  s_mov_b32 s42, vcc_lo
  s_bitcmp1_b32 s42, s46
  s_cbranch_scc1 P4_fok_19
  s_add_u32 s59, s59, 1
  s_cmp_lt_u32 s59, 0x40000
  s_cbranch_scc1 P4_fp_20
P4_fok_19:
  s_lshl_b32 s46, s46, 11
  s_add_u32 m0, s38, 45056
  s_nop 0
  buffer_load_dwordx4 v19, s[24:27], s46 offen sc1 lds
  buffer_load_dwordx4 v19, s[24:27], s46 offen offset:1024 sc1 lds
  s_add_u32 s46, s12, 3
  s_and_b32 s46, s46, 31
  s_bitcmp1_b32 s42, s46
  s_cbranch_scc1 P4_fok_21
  s_mov_b32 s59, 0
P4_fp_22:
  global_load_dword v6, v5, s[60:61] sc0 sc1
  s_waitcnt vmcnt(0)
  v_cmp_ne_u32 vcc, 0, v6
  s_nop 1
  s_mov_b32 s42, vcc_lo
  s_bitcmp1_b32 s42, s46
  s_cbranch_scc1 P4_fok_21
  s_add_u32 s59, s59, 1
  s_cmp_lt_u32 s59, 0x40000
  s_cbranch_scc1 P4_fp_22
P4_fok_21:
  s_lshl_b32 s46, s46, 11
  s_add_u32 m0, s38, 67584
  s_nop 0
  buffer_load_dwordx4 v19, s[24:27], s46 offen sc1 lds
  buffer_load_dwordx4 v19, s[24:27], s46 offen offset:1024 sc1 lds
  s_add_u32 s46, s12, 4
  s_and_b32 s46, s46, 31
  s_bitcmp1_b32 s42, s46
  s_cbranch_scc1 P4_fok_23
  s_mov_b32 s59, 0
P4_fp_24:
  global_load_dword v6, v5, s[60:61] sc0 sc1
  s_waitcnt vmcnt(0)
  v_cmp_ne_u32 vcc, 0, v6
  s_nop 1
  s_mov_b32 s42, vcc_lo
  s_bitcmp1_b32 s42, s46
  s_cbranch_scc1 P4_fok_23
  s_add_u32 s59, s59, 1
  s_cmp_lt_u32 s59, 0x40000
  s_cbranch_scc1 P4_fp_24
P4_fok_23:
  s_lshl_b32 s46, s46, 11
  s_add_u32 m0, s38, 90112
  s_nop 0
  buffer_load_dwordx4 v19, s[24:27], s46 offen sc1 lds
  buffer_load_dwordx4 v19, s[24:27], s46 offen offset:1024 sc1 lds
  s_add_u32 m0, s39, 90112
  s_add_u32 s47, s12, 4
  s_and_b32 s47, s47, 31
  s_lshl_b32 s47, s47, 7
  buffer_load_dwordx4 v18, s[28:31], s47 offen lds
  s_add_u32 s46, s12, 5
  s_and_b32 s46, s46, 31
  s_bitcmp1_b32 s42, s46
  s_cbranch_scc1 P4_fok_25
  s_mov_b32 s59, 0
P4_fp_26:
  global_load_dword v6, v5, s[60:61] sc0 sc1
  s_waitcnt vmcnt(0)
  v_cmp_ne_u32 vcc, 0, v6
  s_nop 1
  s_mov_b32 s42, vcc_lo
  s_bitcmp1_b32 s42, s46
  s_cbranch_scc1 P4_fok_25
  s_add_u32 s59, s59, 1
  s_cmp_lt_u32 s59, 0x40000
  s_cbranch_scc1 P4_fp_26
P4_fok_25:
  s_lshl_b32 s46, s46, 11
  s_add_u32 m0, s38, 112640
  s_nop 0
  buffer_load_dwordx4 v19, s[24:27], s46 offen sc1 lds
  buffer_load_dwordx4 v19, s[24:27], s46 offen offset:1024 sc1 lds
  s_add_u32 m0, s39, 112640
  s_add_u32 s47, s12, 5
  s_and_b32 s47, s47, 31
  s_lshl_b32 s47, s47, 7
  buffer_load_dwordx4 v18, s[28:31], s47 offen lds
  s_waitcnt vmcnt(8)
  s_barrier
  s_add_u32 s46, s12, 6
  s_and_b32 s46, s46, 31
  s_bitcmp1_b32 s42, s46
  s_cbranch_scc1 P4_fok_27
  s_mov_b32 s59, 0
P4_fp_28:
  global_load_dword v6, v5, s[60:61] sc0 sc1
  s_waitcnt vmcnt(0)
  v_cmp_ne_u32 vcc, 0, v6
  s_nop 1
  s_mov_b32 s42, vcc_lo
  s_bitcmp1_b32 s42, s46
  s_cbranch_scc1 P4_fok_27
  s_add_u32 s59, s59, 1
  s_cmp_lt_u32 s59, 0x40000
  s_cbranch_scc1 P4_fp_28
P4_fok_27:
  s_lshl_b32 s46, s46, 11
  s_add_u32 m0, s38, 135168
  s_nop 0
  buffer_load_dwordx4 v19, s[24:27], s46 offen sc1 lds
  buffer_load_dwordx4 v19, s[24:27], s46 offen offset:1024 sc1 lds
  s_add_u32 m0, s39, 135168
  s_add_u32 s47, s12, 6
  s_and_b32 s47, s47, 31
  s_lshl_b32 s47, s47, 7
  buffer_load_dwordx4 v18, s[28:31], s47 offen lds
  s_add_u32 s46, s12, 7
  s_and_b32 s46, s46, 31
  s_bitcmp1_b32 s42, s46
  s_cbranch_scc1 P4_fok_29
  s_mov_b32 s59, 0
P4_fp_30:
  global_load_dword v6, v5, s[60:61] sc0 sc1
  s_waitcnt vmcnt(0)
  v_cmp_ne_u32 vcc, 0, v6
  s_nop 1
  s_mov_b32 s42, vcc_lo
  s_bitcmp1_b32 s42, s46
  s_cbranch_scc1 P4_fok_29
  s_add_u32 s59, s59, 1
  s_cmp_lt_u32 s59, 0x40000
  s_cbranch_scc1 P4_fp_30
P4_fok_29:
  s_lshl_b32 s46, s46, 11
  s_add_u32 m0, s38, 0
  s_nop 0
  buffer_load_dwordx4 v19, s[24:27], s46 offen sc1 lds
  buffer_load_dwordx4 v19, s[24:27], s46 offen offset:1024 sc1 lds
  s_add_u32 m0, s39, 0
  s_add_u32 s47, s12, 7
  s_and_b32 s47, s47, 31
  s_lshl_b32 s47, s47, 7
  buffer_load_dwordx4 v18, s[28:31], s47 offen lds
  s_waitcnt vmcnt(9)
  s_barrier
  s_add_u32 s46, s12, 8
  s_and_b32 s46, s46, 31
  s_bitcmp1_b32 s42, s46
  s_cbranch_scc1 P4_fok_31
  s_mov_b32 s59, 0
P4_fp_32:
  global_load_dword v6, v5, s[60:61] sc0 sc1
  s_waitcnt vmcnt(0)
  v_cmp_ne_u32 vcc, 0, v6
  s_nop 1
  s_mov_b32 s42, vcc_lo
  s_bitcmp1_b32 s42, s46
  s_cbranch_scc1 P4_fok_31
  s_add_u32 s59, s59, 1
  s_cmp_lt_u32 s59, 0x40000
  s_cbranch_scc1 P4_fp_32
P4_fok_31:
  s_lshl_b32 s46, s46, 11
  s_add_u32 m0, s38, 22528
  s_nop 0
  buffer_load_dwordx4 v19, s[24:27], s46 offen sc1 lds
  buffer_load_dwordx4 v19, s[24:27], s46 offen offset:1024 sc1 lds
  s_add_u32 m0, s39, 22528
  s_add_u32 s47, s12, 8
  s_and_b32 s47, s47, 31
  s_lshl_b32 s47, s47, 7
  buffer_load_dwordx4 v18, s[28:31], s47 offen lds
  s_add_u32 s46, s12, 9
  s_and_b32 s46, s46, 31
  s_bitcmp1_b32 s42, s46
  s_cbranch_scc1 P4_fok_33
  s_mov_b32 s59, 0
P4_fp_34:
  global_load_dword v6, v5, s[60:61] sc0 sc1
  s_waitcnt vmcnt(0)
  v_cmp_ne_u32 vcc, 0, v6
  s_nop 1
  s_mov_b32 s42, vcc_lo
  s_bitcmp1_b32 s42, s46
  s_cbranch_scc1 P4_fok_33
  s_add_u32 s59, s59, 1
  s_cmp_lt_u32 s59, 0x40000
  s_cbranch_scc1 P4_fp_34
P4_fok_33:
  s_lshl_b32 s46, s46, 11
  s_add_u32 m0, s38, 45056
  s_nop 0
  buffer_load_dwordx4 v19, s[24:27], s46 offen sc1 lds
  buffer_load_dwordx4 v19, s[24:27], s46 offen offset:1024 sc1 lds
  s_add_u32 m0, s39, 45056
  s_add_u32 s47, s12, 9
  s_and_b32 s47, s47, 31
  s_lshl_b32 s47, s47, 7
  buffer_load_dwordx4 v18, s[28:31], s47 offen lds
  s_waitcnt vmcnt(9)
  s_barrier
  s_add_u32 s46, s12, 10
  s_and_b32 s46, s46, 31
  s_bitcmp1_b32 s42, s46
  s_cbranch_scc1 P4_fok_35
  s_mov_b32 s59, 0
P4_fp_36:
  global_load_dword v6, v5, s[60:61] sc0 sc1
  s_waitcnt vmcnt(0)
  v_cmp_ne_u32 vcc, 0, v6
  s_nop 1
  s_mov_b32 s42, vcc_lo
  s_bitcmp1_b32 s42, s46
  s_cbranch_scc1 P4_fok_35
  s_add_u32 s59, s59, 1
  s_cmp_lt_u32 s59, 0x40000
  s_cbranch_scc1 P4_fp_36
P4_fok_35:
  s_lshl_b32 s46, s46, 11
  s_add_u32 m0, s38, 67584
  s_nop 0
  buffer_load_dwordx4 v19, s[24:27], s46 offen sc1 lds
  buffer_load_dwordx4 v19, s[24:27], s46 offen offset:1024 sc1 lds
  s_add_u32 m0, s39, 67584
  s_add_u32 s47, s12, 10
  s_and_b32 s47, s47, 31
  s_lshl_b32 s47, s47, 7
  buffer_load_dwordx4 v18, s[28:31], s47 offen lds
  s_add_u32 s46, s12, 11
  s_and_b32 s46, s46, 31
  s_bitcmp1_b32 s42, s46
  s_cbranch_scc1 P4_fok_37
  s_mov_b32 s59, 0
P4_fp_38:
  global_load_dword v6, v5, s[60:61] sc0 sc1
  s_waitcnt vmcnt(0)
  v_cmp_ne_u32 vcc, 0, v6
  s_nop 1
  s_mov_b32 s42, vcc_lo
  s_bitcmp1_b32 s42, s46
  s_cbranch_scc1 P4_fok_37
  s_add_u32 s59, s59, 1
  s_cmp_lt_u32 s59, 0x40000
  s_cbranch_scc1 P4_fp_38
P4_fok_37:
  s_lshl_b32 s46, s46, 11
  s_add_u32 m0, s38, 90112
  s_nop 0
  buffer_load_dwordx4 v19, s[24:27], s46 offen sc1 lds
  buffer_load_dwordx4 v19, s[24:27], s46 offen offset:1024 sc1 lds
  s_add_u32 m0, s39, 90112
  s_add_u32 s47, s12, 11
  s_and_b32 s47, s47, 31
  s_lshl_b32 s47, s47, 7
  buffer_load_dwordx4 v18, s[28:31], s47 offen lds
  s_waitcnt vmcnt(9)
  s_barrier
  s_add_u32 s46, s12, 12
  s_and_b32 s46, s46, 31
  s_bitcmp1_b32 s42, s46
  s_cbranch_scc1 P4_fok_39
  s_mov_b32 s59, 0
P4_fp_40:
  global_load_dword v6, v5, s[60:61] sc0 sc1
  s_waitcnt vmcnt(0)
  v_cmp_ne_u32 vcc, 0, v6
  s_nop 1
  s_mov_b32 s42, vcc_lo
  s_bitcmp1_b32 s42, s46
  s_cbranch_scc1 P4_fok_39
  s_add_u32 s59, s59, 1
  s_cmp_lt_u32 s59, 0x40000
  s_cbranch_scc1 P4_fp_40
P4_fok_39:
  s_lshl_b32 s46, s46, 11
  s_add_u32 m0, s38, 112640
  s_nop 0
  buffer_load_dwordx4 v19, s[24:27], s46 offen sc1 lds
  buffer_load_dwordx4 v19, s[24:27], s46 offen offset:1024 sc1 lds
  s_add_u32 m0, s39, 112640
  s_add_u32 s47, s12, 12
  s_and_b32 s47, s47, 31
  s_lshl_b32 s47, s47, 7
  buffer_load_dwordx4 v18, s[28:31], s47 offen lds
  s_add_u32 s46, s12, 13
  s_and_b32 s46, s46, 31
  s_bitcmp1_b32 s42, s46
  s_cbranch_scc1 P4_fok_41
  s_mov_b32 s59, 0
P4_fp_42:
  global_load_dword v6, v5, s[60:61] sc0 sc1
  s_waitcnt vmcnt(0)
  v_cmp_ne_u32 vcc, 0, v6
  s_nop 1
  s_mov_b32 s42, vcc_lo
  s_bitcmp1_b32 s42, s46
  s_cbranch_scc1 P4_fok_41
  s_add_u32 s59, s59, 1
  s_cmp_lt_u32 s59, 0x40000
  s_cbranch_scc1 P4_fp_42
P4_fok_41:
  s_lshl_b32 s46, s46, 11
  s_add_u32 m0, s38, 135168
  s_nop 0
  buffer_load_dwordx4 v19, s[24:27], s46 offen sc1 lds
  buffer_load_dwordx4 v19, s[24:27], s46 offen offset:1024 sc1 lds
  s_add_u32 m0, s39, 135168
  s_add_u32 s47, s12, 13
  s_and_b32 s47, s47, 31
  s_lshl_b32 s47, s47, 7
  buffer_load_dwordx4 v18, s[28:31], s47 offen lds
  s_waitcnt vmcnt(9)
  s_barrier
  s_add_u32 s46, s12, 14
  s_and_b32 s46, s46, 31
  s_bitcmp1_b32 s42, s46
  s_cbranch_scc1 P4_fok_43
  s_mov_b32 s59, 0
P4_fp_44:
  global_load_dword v6, v5, s[60:61] sc0 sc1
  s_waitcnt vmcnt(0)
  v_cmp_ne_u32 vcc, 0, v6
  s_nop 1
  s_mov_b32 s42, vcc_lo
  s_bitcmp1_b32 s42, s46
  s_cbranch_scc1 P4_fok_43
  s_add_u32 s59, s59, 1
  s_cmp_lt_u32 s59, 0x40000
  s_cbranch_scc1 P4_fp_44
P4_fok_43:
  s_lshl_b32 s46, s46, 11
  s_add_u32 m0, s38, 0
  s_nop 0
  buffer_load_dwordx4 v19, s[24:27], s46 offen sc1 lds
  buffer_load_dwordx4 v19, s[24:27], s46 offen offset:1024 sc1 lds
  s_add_u32 m0, s39, 0
  s_add_u32 s47, s12, 14
  s_and_b32 s47, s47, 31
  s_lshl_b32 s47, s47, 7
  buffer_load_dwordx4 v18, s[28:31], s47 offen lds
  s_add_u32 s46, s12, 15
  s_and_b32 s46, s46, 31
  s_bitcmp1_b32 s42, s46
  s_cbranch_scc1 P4_fok_45
  s_mov_b32 s59, 0
P4_fp_46:
  global_load_dword v6, v5, s[60:61] sc0 sc1
  s_waitcnt vmcnt(0)
  v_cmp_ne_u32 vcc, 0, v6
  s_nop 1
  s_mov_b32 s42, vcc_lo
  s_bitcmp1_b32 s42, s46
  s_cbranch_scc1 P4_fok_45
  s_add_u32 s59, s59, 1
  s_cmp_lt_u32 s59, 0x40000
  s_cbranch_scc1 P4_fp_46
P4_fok_45:
  s_lshl_b32 s46, s46, 11
  s_add_u32 m0, s38, 22528
  s_nop 0
  buffer_load_dwordx4 v19, s[24:27], s46 offen sc1 lds
  buffer_load_dwordx4 v19, s[24:27], s46 offen offset:1024 sc1 lds
  s_add_u32 m0, s39, 22528
  s_add_u32 s47, s12, 15
  s_and_b32 s47, s47, 31
  s_lshl_b32 s47, s47, 7
  buffer_load_dwordx4 v18, s[28:31], s47 offen lds
  s_waitcnt vmcnt(9)
  s_barrier
  s_add_u32 s46, s12, 16
  s_and_b32 s46, s46, 31
  s_bitcmp1_b32 s42, s46
  s_cbranch_scc1 P4_fok_47
  s_mov_b32 s59, 0
P4_fp_48:
  global_load_dword v6, v5, s[60:61] sc0 sc1
  s_waitcnt vmcnt(0)
  v_cmp_ne_u32 vcc, 0, v6
  s_nop 1
  s_mov_b32 s42, vcc_lo
  s_bitcmp1_b32 s42, s46
  s_cbranch_scc1 P4_fok_47
  s_add_u32 s59, s59, 1
  s_cmp_lt_u32 s59, 0x40000
  s_cbranch_scc1 P4_fp_48
P4_fok_47:
  s_lshl_b32 s46, s46, 11
  s_add_u32 m0, s38, 45056
  s_nop 0
  buffer_load_dwordx4 v19, s[24:27], s46 offen sc1 lds
  buffer_load_dwordx4 v19, s[24:27], s46 offen offset:1024 sc1 lds
  s_add_u32 m0, s39, 45056
  s_add_u32 s47, s12, 16
  s_and_b32 s47, s47, 31
  s_lshl_b32 s47, s47, 7
  buffer_load_dwordx4 v18, s[28:31], s47 offen lds
  s_add_u32 s46, s12, 17
  s_and_b32 s46, s46, 31
  s_bitcmp1_b32 s42, s46
  s_cbranch_scc1 P4_fok_49
  s_mov_b32 s59, 0
P4_fp_50:
  global_load_dword v6, v5, s[60:61] sc0 sc1
  s_waitcnt vmcnt(0)
  v_cmp_ne_u32 vcc, 0, v6
  s_nop 1
  s_mov_b32 s42, vcc_lo
  s_bitcmp1_b32 s42, s46
  s_cbranch_scc1 P4_fok_49
  s_add_u32 s59, s59, 1
  s_cmp_lt_u32 s59, 0x40000
  s_cbranch_scc1 P4_fp_50
P4_fok_49:
  s_lshl_b32 s46, s46, 11
  s_add_u32 m0, s38, 67584
  s_nop 0
  buffer_load_dwordx4 v19, s[24:27], s46 offen sc1 lds
  buffer_load_dwordx4 v19, s[24:27], s46 offen offset:1024 sc1 lds
  s_add_u32 m0, s39, 67584
  s_add_u32 s47, s12, 17
  s_and_b32 s47, s47, 31
  s_lshl_b32 s47, s47, 7
  buffer_load_dwordx4 v18, s[28:31], s47 offen lds
  s_waitcnt vmcnt(9)
  s_barrier
  s_add_u32 s46, s12, 18
  s_and_b32 s46, s46, 31
  s_bitcmp1_b32 s42, s46
  s_cbranch_scc1 P4_fok_51
  s_mov_b32 s59, 0
P4_fp_52:
  global_load_dword v6, v5, s[60:61] sc0 sc1
  s_waitcnt vmcnt(0)
  v_cmp_ne_u32 vcc, 0, v6
  s_nop 1
  s_mov_b32 s42, vcc_lo
  s_bitcmp1_b32 s42, s46
  s_cbranch_scc1 P4_fok_51
  s_add_u32 s59, s59, 1
  s_cmp_lt_u32 s59, 0x40000
  s_cbranch_scc1 P4_fp_52
P4_fok_51:
  s_lshl_b32 s46, s46, 11
  s_add_u32 m0, s38, 90112
  s_nop 0
  buffer_load_dwordx4 v19, s[24:27], s46 offen sc1 lds
  buffer_load_dwordx4 v19, s[24:27], s46 offen offset:1024 sc1 lds
  s_add_u32 m0, s39, 90112
  s_add_u32 s47, s12, 18
  s_and_b32 s47, s47, 31
  s_lshl_b32 s47, s47, 7
  buffer_load_dwordx4 v18, s[28:31], s47 offen lds
  s_add_u32 s46, s12, 19
  s_and_b32 s46, s46, 31
  s_bitcmp1_b32 s42, s46
  s_cbranch_scc1 P4_fok_53
  s_mov_b32 s59, 0
P4_fp_54:
  global_load_dword v6, v5, s[60:61] sc0 sc1
  s_waitcnt vmcnt(0)
  v_cmp_ne_u32 vcc, 0, v6
  s_nop 1
  s_mov_b32 s42, vcc_lo
  s_bitcmp1_b32 s42, s46
  s_cbranch_scc1 P4_fok_53
  s_add_u32 s59, s59, 1
  s_cmp_lt_u32 s59, 0x40000
  s_cbranch_scc1 P4_fp_54
P4_fok_53:
  s_lshl_b32 s46, s46, 11
  s_add_u32 m0, s38, 112640
  s_nop 0
  buffer_load_dwordx4 v19, s[24:27], s46 offen sc1 lds
  buffer_load_dwordx4 v19, s[24:27], s46 offen offset:1024 sc1 lds
  s_add_u32 m0, s39, 112640
  s_add_u32 s47, s12, 19
  s_and_b32 s47, s47, 31
  s_lshl_b32 s47, s47, 7
  buffer_load_dwordx4 v18, s[28:31], s47 offen lds
  s_waitcnt vmcnt(9)
  s_barrier
  s_add_u32 s46, s12, 20
  s_and_b32 s46, s46, 31
  s_bitcmp1_b32 s42, s46
  s_cbranch_scc1 P4_fok_55
  s_mov_b32 s59, 0
P4_fp_56:
  global_load_dword v6, v5, s[60:61] sc0 sc1
  s_waitcnt vmcnt(0)
  v_cmp_ne_u32 vcc, 0, v6
  s_nop 1
  s_mov_b32 s42, vcc_lo
  s_bitcmp1_b32 s42, s46
  s_cbranch_scc1 P4_fok_55
  s_add_u32 s59, s59, 1
  s_cmp_lt_u32 s59, 0x40000
  s_cbranch_scc1 P4_fp_56
P4_fok_55:
  s_lshl_b32 s46, s46, 11
  s_add_u32 m0, s38, 135168
  s_nop 0
  buffer_load_dwordx4 v19, s[24:27], s46 offen sc1 lds
  buffer_load_dwordx4 v19, s[24:27], s46 offen offset:1024 sc1 lds
  s_add_u32 m0, s39, 135168
  s_add_u32 s47, s12, 20
  s_and_b32 s47, s47, 31
  s_lshl_b32 s47, s47, 7
  buffer_load_dwordx4 v18, s[28:31], s47 offen lds
  s_add_u32 s46, s12, 21
  s_and_b32 s46, s46, 31
  s_bitcmp1_b32 s42, s46
  s_cbranch_scc1 P4_fok_57
  s_mov_b32 s59, 0
P4_fp_58:
  global_load_dword v6, v5, s[60:61] sc0 sc1
  s_waitcnt vmcnt(0)
  v_cmp_ne_u32 vcc, 0, v6
  s_nop 1
  s_mov_b32 s42, vcc_lo
  s_bitcmp1_b32 s42, s46
  s_cbranch_scc1 P4_fok_57
  s_add_u32 s59, s59, 1
  s_cmp_lt_u32 s59, 0x40000
  s_cbranch_scc1 P4_fp_58
P4_fok_57:
  s_lshl_b32 s46, s46, 11
  s_add_u32 m0, s38, 0
  s_nop 0
  buffer_load_dwordx4 v19, s[24:27], s46 offen sc1 lds
  buffer_load_dwordx4 v19, s[24:27], s46 offen offset:1024 sc1 lds
  s_add_u32 m0, s39, 0
  s_add_u32 s47, s12, 21
  s_and_b32 s47, s47, 31
  s_lshl_b32 s47, s47, 7
  buffer_load_dwordx4 v18, s[28:31], s47 offen lds
  s_waitcnt vmcnt(9)
  s_barrier
  s_add_u32 s46, s12, 22
  s_and_b32 s46, s46, 31
  s_bitcmp1_b32 s42, s46
  s_cbranch_scc1 P4_fok_59
  s_mov_b32 s59, 0
P4_fp_60:
  global_load_dword v6, v5, s[60:61] sc0 sc1
  s_waitcnt vmcnt(0)
  v_cmp_ne_u32 vcc, 0, v6
  s_nop 1
  s_mov_b32 s42, vcc_lo
  s_bitcmp1_b32 s42, s46
  s_cbranch_scc1 P4_fok_59
  s_add_u32 s59, s59, 1
  s_cmp_lt_u32 s59, 0x40000
  s_cbranch_scc1 P4_fp_60
P4_fok_59:
  s_lshl_b32 s46, s46, 11
  s_add_u32 m0, s38, 22528
  s_nop 0
  buffer_load_dwordx4 v19, s[24:27], s46 offen sc1 lds
  buffer_load_dwordx4 v19, s[24:27], s46 offen offset:1024 sc1 lds
  s_add_u32 m0, s39, 22528
  s_add_u32 s47, s12, 22
  s_and_b32 s47, s47, 31
  s_lshl_b32 s47, s47, 7
  buffer_load_dwordx4 v18, s[28:31], s47 offen lds
  s_add_u32 s46, s12, 23
  s_and_b32 s46, s46, 31
  s_bitcmp1_b32 s42, s46
  s_cbranch_scc1 P4_fok_61
  s_mov_b32 s59, 0
P4_fp_62:
  global_load_dword v6, v5, s[60:61] sc0 sc1
  s_waitcnt vmcnt(0)
  v_cmp_ne_u32 vcc, 0, v6
  s_nop 1
  s_mov_b32 s42, vcc_lo
  s_bitcmp1_b32 s42, s46
  s_cbranch_scc1 P4_fok_61
  s_add_u32 s59, s59, 1
  s_cmp_lt_u32 s59, 0x40000
  s_cbranch_scc1 P4_fp_62
P4_fok_61:
  s_lshl_b32 s46, s46, 11
  s_add_u32 m0, s38, 45056
  s_nop 0
  buffer_load_dwordx4 v19, s[24:27], s46 offen sc1 lds
  buffer_load_dwordx4 v19, s[24:27], s46 offen offset:1024 sc1 lds
  s_add_u32 m0, s39, 45056
  s_add_u32 s47, s12, 23
  s_and_b32 s47, s47, 31
  s_lshl_b32 s47, s47, 7
  buffer_load_dwordx4 v18, s[28:31], s47 offen lds
  s_waitcnt vmcnt(9)
  s_barrier
  s_add_u32 s46, s12, 24
  s_and_b32 s46, s46, 31
  s_bitcmp1_b32 s42, s46
  s_cbranch_scc1 P4_fok_63
  s_mov_b32 s59, 0
P4_fp_64:
  global_load_dword v6, v5, s[60:61] sc0 sc1
  s_waitcnt vmcnt(0)
  v_cmp_ne_u32 vcc, 0, v6
  s_nop 1
  s_mov_b32 s42, vcc_lo
  s_bitcmp1_b32 s42, s46
  s_cbranch_scc1 P4_fok_63
  s_add_u32 s59, s59, 1
  s_cmp_lt_u32 s59, 0x40000
  s_cbranch_scc1 P4_fp_64
P4_fok_63:
  s_lshl_b32 s46, s46, 11
  s_add_u32 m0, s38, 67584
  s_nop 0
  buffer_load_dwordx4 v19, s[24:27], s46 offen sc1 lds
  buffer_load_dwordx4 v19, s[24:27], s46 offen offset:1024 sc1 lds
  s_add_u32 m0, s39, 67584
  s_add_u32 s47, s12, 24
  s_and_b32 s47, s47, 31
  s_lshl_b32 s47, s47, 7
  buffer_load_dwordx4 v18, s[28:31], s47 offen lds
  s_add_u32 s46, s12, 25
  s_and_b32 s46, s46, 31
  s_bitcmp1_b32 s42, s46
  s_cbranch_scc1 P4_fok_65
  s_mov_b32 s59, 0
P4_fp_66:
  global_load_dword v6, v5, s[60:61] sc0 sc1
  s_waitcnt vmcnt(0)
  v_cmp_ne_u32 vcc, 0, v6
  s_nop 1
  s_mov_b32 s42, vcc_lo
  s_bitcmp1_b32 s42, s46
  s_cbranch_scc1 P4_fok_65
  s_add_u32 s59, s59, 1
  s_cmp_lt_u32 s59, 0x40000
  s_cbranch_scc1 P4_fp_66
P4_fok_65:
  s_lshl_b32 s46, s46, 11
  s_add_u32 m0, s38, 90112
  s_nop 0
  buffer_load_dwordx4 v19, s[24:27], s46 offen sc1 lds
  buffer_load_dwordx4 v19, s[24:27], s46 offen offset:1024 sc1 lds
  s_add_u32 m0, s39, 90112
  s_add_u32 s47, s12, 25
  s_and_b32 s47, s47, 31
  s_lshl_b32 s47, s47, 7
  buffer_load_dwordx4 v18, s[28:31], s47 offen lds
  s_waitcnt vmcnt(9)
  s_barrier
  s_add_u32 s46, s12, 26
  s_and_b32 s46, s46, 31
  s_bitcmp1_b32 s42, s46
  s_cbranch_scc1 P4_fok_67
  s_mov_b32 s59, 0
P4_fp_68:
  global_load_dword v6, v5, s[60:61] sc0 sc1
  s_waitcnt vmcnt(0)
  v_cmp_ne_u32 vcc, 0, v6
  s_nop 1
  s_mov_b32 s42, vcc_lo
  s_bitcmp1_b32 s42, s46
  s_cbranch_scc1 P4_fok_67
  s_add_u32 s59, s59, 1
  s_cmp_lt_u32 s59, 0x40000
  s_cbranch_scc1 P4_fp_68
P4_fok_67:
  s_lshl_b32 s46, s46, 11
  s_add_u32 m0, s38, 112640
  s_nop 0
  buffer_load_dwordx4 v19, s[24:27], s46 offen sc1 lds
  buffer_load_dwordx4 v19, s[24:27], s46 offen offset:1024 sc1 lds
  s_add_u32 m0, s39, 112640
  s_add_u32 s47, s12, 26
  s_and_b32 s47, s47, 31
  s_lshl_b32 s47, s47, 7
  buffer_load_dwordx4 v18, s[28:31], s47 offen lds
  s_add_u32 s46, s12, 27
  s_and_b32 s46, s46, 31
  s_bitcmp1_b32 s42, s46
  s_cbranch_scc1 P4_fok_69
  s_mov_b32 s59, 0
P4_fp_70:
  global_load_dword v6, v5, s[60:61] sc0 sc1
  s_waitcnt vmcnt(0)
  v_cmp_ne_u32 vcc, 0, v6
  s_nop 1
  s_mov_b32 s42, vcc_lo
  s_bitcmp1_b32 s42, s46
  s_cbranch_scc1 P4_fok_69
  s_add_u32 s59, s59, 1
  s_cmp_lt_u32 s59, 0x40000
  s_cbranch_scc1 P4_fp_70
P4_fok_69:
  s_lshl_b32 s46, s46, 11
  s_add_u32 m0, s38, 135168
  s_nop 0
  buffer_load_dwordx4 v19, s[24:27], s46 offen sc1 lds
  buffer_load_dwordx4 v19, s[24:27], s46 offen offset:1024 sc1 lds
  s_add_u32 m0, s39, 135168
  s_add_u32 s47, s12, 27
  s_and_b32 s47, s47, 31
  s_lshl_b32 s47, s47, 7
  buffer_load_dwordx4 v18, s[28:31], s47 offen lds
  s_waitcnt vmcnt(9)
  s_barrier
  s_add_u32 s46, s12, 28
  s_and_b32 s46, s46, 31
  s_bitcmp1_b32 s42, s46
  s_cbranch_scc1 P4_fok_71
  s_mov_b32 s59, 0
P4_fp_72:
  global_load_dword v6, v5, s[60:61] sc0 sc1
  s_waitcnt vmcnt(0)
  v_cmp_ne_u32 vcc, 0, v6
  s_nop 1
  s_mov_b32 s42, vcc_lo
  s_bitcmp1_b32 s42, s46
  s_cbranch_scc1 P4_fok_71
  s_add_u32 s59, s59, 1
  s_cmp_lt_u32 s59, 0x40000
  s_cbranch_scc1 P4_fp_72
P4_fok_71:
  s_lshl_b32 s46, s46, 11
  s_add_u32 m0, s38, 0
  s_nop 0
  buffer_load_dwordx4 v19, s[24:27], s46 offen sc1 lds
  buffer_load_dwordx4 v19, s[24:27], s46 offen offset:1024 sc1 lds
  s_add_u32 m0, s39, 0
  s_add_u32 s47, s12, 28
  s_and_b32 s47, s47, 31
  s_lshl_b32 s47, s47, 7
  buffer_load_dwordx4 v18, s[28:31], s47 offen lds
  s_add_u32 s46, s12, 29
  s_and_b32 s46, s46, 31
  s_bitcmp1_b32 s42, s46
  s_cbranch_scc1 P4_fok_73
  s_mov_b32 s59, 0
P4_fp_74:
  global_load_dword v6, v5, s[60:61] sc0 sc1
  s_waitcnt vmcnt(0)
  v_cmp_ne_u32 vcc, 0, v6
  s_nop 1
  s_mov_b32 s42, vcc_lo
  s_bitcmp1_b32 s42, s46
  s_cbranch_scc1 P4_fok_73
  s_add_u32 s59, s59, 1
  s_cmp_lt_u32 s59, 0x40000
  s_cbranch_scc1 P4_fp_74
P4_fok_73:
  s_lshl_b32 s46, s46, 11
  s_add_u32 m0, s38, 22528
  s_nop 0
  buffer_load_dwordx4 v19, s[24:27], s46 offen sc1 lds
  buffer_load_dwordx4 v19, s[24:27], s46 offen offset:1024 sc1 lds
  s_add_u32 m0, s39, 22528
  s_add_u32 s47, s12, 29
  s_and_b32 s47, s47, 31
  s_lshl_b32 s47, s47, 7
  buffer_load_dwordx4 v18, s[28:31], s47 offen lds
  s_waitcnt vmcnt(9)
  s_barrier
  s_add_u32 s46, s12, 30
  s_and_b32 s46, s46, 31
  s_bitcmp1_b32 s42, s46
  s_cbranch_scc1 P4_fok_75
  s_mov_b32 s59, 0
P4_fp_76:
  global_load_dword v6, v5, s[60:61] sc0 sc1
  s_waitcnt vmcnt(0)
  v_cmp_ne_u32 vcc, 0, v6
  s_nop 1
  s_mov_b32 s42, vcc_lo
  s_bitcmp1_b32 s42, s46
  s_cbranch_scc1 P4_fok_75
  s_add_u32 s59, s59, 1
  s_cmp_lt_u32 s59, 0x40000
  s_cbranch_scc1 P4_fp_76
P4_fok_75:
  s_lshl_b32 s46, s46, 11
  s_add_u32 m0, s38, 45056
  s_nop 0
  buffer_load_dwordx4 v19, s[24:27], s46 offen sc1 lds
  buffer_load_dwordx4 v19, s[24:27], s46 offen offset:1024 sc1 lds
  s_add_u32 m0, s39, 45056
  s_add_u32 s47, s12, 30
  s_and_b32 s47, s47, 31
  s_lshl_b32 s47, s47, 7
  buffer_load_dwordx4 v18, s[28:31], s47 offen lds
  s_add_u32 s46, s12, 31
  s_and_b32 s46, s46, 31
  s_bitcmp1_b32 s42, s46
  s_cbranch_scc1 P4_fok_77
  s_mov_b32 s59, 0
P4_fp_78:
  global_load_dword v6, v5, s[60:61] sc0 sc1
  s_waitcnt vmcnt(0)
  v_cmp_ne_u32 vcc, 0, v6
  s_nop 1
  s_mov_b32 s42, vcc_lo
  s_bitcmp1_b32 s42, s46
  s_cbranch_scc1 P4_fok_77
  s_add_u32 s59, s59, 1
  s_cmp_lt_u32 s59, 0x40000
  s_cbranch_scc1 P4_fp_78
P4_fok_77:
  s_lshl_b32 s46, s46, 11
  s_add_u32 m0, s38, 67584
  s_nop 0
  buffer_load_dwordx4 v19, s[24:27], s46 offen sc1 lds
  buffer_load_dwordx4 v19, s[24:27], s46 offen offset:1024 sc1 lds
  s_add_u32 m0, s39, 67584
  s_add_u32 s47, s12, 31
  s_and_b32 s47, s47, 31
  s_lshl_b32 s47, s47, 7
  buffer_load_dwordx4 v18, s[28:31], s47 offen lds
  s_waitcnt vmcnt(9)
  s_barrier
  s_waitcnt vmcnt(3)
  s_barrier
  s_waitcnt vmcnt(0)
  s_barrier
  s_branch P4_qj_16
P4_q7_15:
  s_waitcnt vmcnt(3)
  s_barrier
  s_add_u32 m0, s39, 90112
  s_add_u32 s47, s12, 4
  s_and_b32 s47, s47, 31
  s_lshl_b32 s47, s47, 7
  buffer_load_dwordx4 v18, s[28:31], s47 offen lds
  s_add_u32 m0, s39, 112640
  s_add_u32 s47, s12, 5
  s_and_b32 s47, s47, 31
  s_lshl_b32 s47, s47, 7
  buffer_load_dwordx4 v18, s[28:31], s47 offen lds
  s_waitcnt vmcnt(3)
  s_barrier
  s_add_u32 m0, s39, 135168
  s_add_u32 s47, s12, 6
  s_and_b32 s47, s47, 31
  s_lshl_b32 s47, s47, 7
  buffer_load_dwordx4 v18, s[28:31], s47 offen lds
  s_add_u32 m0, s39, 0
  s_add_u32 s47, s12, 7
  s_and_b32 s47, s47, 31
  s_lshl_b32 s47, s47, 7
  buffer_load_dwordx4 v18, s[28:31], s47 offen lds
  s_waitcnt vmcnt(3)
  s_barrier
  s_add_u32 m0, s39, 22528
  s_add_u32 s47, s12, 8
  s_and_b32 s47, s47, 31
  s_lshl_b32 s47, s47, 7
  buffer_load_dwordx4 v18, s[28:31], s47 offen lds
  s_add_u32 m0, s39, 45056
  s_add_u32 s47, s12, 9
  s_and_b32 s47, s47, 31
  s_lshl_b32 s47, s47, 7
  buffer_load_dwordx4 v18, s[28:31], s47 offen lds
  s_waitcnt vmcnt(3)
  s_barrier
  s_add_u32 m0, s39, 67584
  s_add_u32 s47, s12, 10
  s_and_b32 s47, s47, 31
  s_lshl_b32 s47, s47, 7
  buffer_load_dwordx4 v18, s[28:31], s47 offen lds
  s_add_u32 m0, s39, 90112
  s_add_u32 s47, s12, 11
  s_and_b32 s47, s47, 31
  s_lshl_b32 s47, s47, 7
  buffer_load_dwordx4 v18, s[28:31], s47 offen lds
  s_waitcnt vmcnt(3)
  s_barrier
  s_add_u32 m0, s39, 112640
  s_add_u32 s47, s12, 12
  s_and_b32 s47, s47, 31
  s_lshl_b32 s47, s47, 7
  buffer_load_dwordx4 v18, s[28:31], s47 offen lds
  s_add_u32 m0, s39, 135168
  s_add_u32 s47, s12, 13
  s_and_b32 s47, s47, 31
  s_lshl_b32 s47, s47, 7
  buffer_load_dwordx4 v18, s[28:31], s47 offen lds
  s_waitcnt vmcnt(3)
  s_barrier
  s_add_u32 m0, s39, 0
  s_add_u32 s47, s12, 14
  s_and_b32 s47, s47, 31
  s_lshl_b32 s47, s47, 7
  buffer_load_dwordx4 v18, s[28:31], s47 offen lds
  s_add_u32 m0, s39, 22528
  s_add_u32 s47, s12, 15
  s_and_b32 s47, s47, 31
  s_lshl_b32 s47, s47, 7
  buffer_load_dwordx4 v18, s[28:31], s47 offen lds
  s_waitcnt vmcnt(3)
  s_barrier
  s_add_u32 m0, s39, 45056
  s_add_u32 s47, s12, 16
  s_and_b32 s47, s47, 31
  s_lshl_b32 s47, s47, 7
  buffer_load_dwordx4 v18, s[28:31], s47 offen lds
  s_add_u32 m0, s39, 67584
  s_add_u32 s47, s12, 17
  s_and_b32 s47, s47, 31
  s_lshl_b32 s47, s47, 7
  buffer_load_dwordx4 v18, s[28:31], s47 offen lds
  s_waitcnt vmcnt(3)
  s_barrier
  s_add_u32 m0, s39, 90112
  s_add_u32 s47, s12, 18
  s_and_b32 s47, s47, 31
  s_lshl_b32 s47, s47, 7
  buffer_load_dwordx4 v18, s[28:31], s47 offen lds
  s_add_u32 m0, s39, 112640
  s_add_u32 s47, s12, 19
  s_and_b32 s47, s47, 31
  s_lshl_b32 s47, s47, 7
  buffer_load_dwordx4 v18, s[28:31], s47 offen lds
  s_waitcnt vmcnt(3)
  s_barrier
  s_add_u32 m0, s39, 135168
  s_add_u32 s47, s12, 20
  s_and_b32 s47, s47, 31
  s_lshl_b32 s47, s47, 7
  buffer_load_dwordx4 v18, s[28:31], s47 offen lds
  s_add_u32 m0, s39, 0
  s_add_u32 s47, s12, 21
  s_and_b32 s47, s47, 31
  s_lshl_b32 s47, s47, 7
  buffer_load_dwordx4 v18, s[28:31], s47 offen lds
  s_waitcnt vmcnt(3)
  s_barrier
  s_add_u32 m0, s39, 22528
  s_add_u32 s47, s12, 22
  s_and_b32 s47, s47, 31
  s_lshl_b32 s47, s47, 7
  buffer_load_dwordx4 v18, s[28:31], s47 offen lds
  s_add_u32 m0, s39, 45056
  s_add_u32 s47, s12, 23
  s_and_b32 s47, s47, 31
  s_lshl_b32 s47, s47, 7
  buffer_load_dwordx4 v18, s[28:31], s47 offen lds
  s_waitcnt vmcnt(3)
  s_barrier
  s_add_u32 m0, s39, 67584
  s_add_u32 s47, s12, 24
  s_and_b32 s47, s47, 31
  s_lshl_b32 s47, s47, 7
  buffer_load_dwordx4 v18, s[28:31], s47 offen lds
  s_add_u32 m0, s39, 90112
  s_add_u32 s47, s12, 25
  s_and_b32 s47, s47, 31
  s_lshl_b32 s47, s47, 7
  buffer_load_dwordx4 v18, s[28:31], s47 offen lds
  s_waitcnt vmcnt(3)
  s_barrier
  s_add_u32 m0, s39, 112640
  s_add_u32 s47, s12, 26
  s_and_b32 s47, s47, 31
  s_lshl_b32 s47, s47, 7
  buffer_load_dwordx4 v18, s[28:31], s47 offen lds
  s_add_u32 m0, s39, 135168
  s_add_u32 s47, s12, 27
  s_and_b32 s47, s47, 31
  s_lshl_b32 s47, s47, 7
  buffer_load_dwordx4 v18, s[28:31], s47 offen lds
  s_waitcnt vmcnt(3)
  s_barrier
  s_add_u32 m0, s39, 0
  s_add_u32 s47, s12, 28
  s_and_b32 s47, s47, 31
  s_lshl_b32 s47, s47, 7
  buffer_load_dwordx4 v18, s[28:31], s47 offen lds
  s_add_u32 m0, s39, 22528
  s_add_u32 s47, s12, 29
  s_and_b32 s47, s47, 31
  s_lshl_b32 s47, s47, 7
  buffer_load_dwordx4 v18, s[28:31], s47 offen lds
  s_waitcnt vmcnt(3)
  s_barrier
  s_add_u32 m0, s39, 45056
  s_add_u32 s47, s12, 30
  s_and_b32 s47, s47, 31
  s_lshl_b32 s47, s47, 7
  buffer_load_dwordx4 v18, s[28:31], s47 offen lds
  s_add_u32 m0, s39, 67584
  s_add_u32 s47, s12, 31
  s_and_b32 s47, s47, 31
  s_lshl_b32 s47, s47, 7
  buffer_load_dwordx4 v18, s[28:31], s47 offen lds
  s_waitcnt vmcnt(3)
  s_barrier
  s_waitcnt vmcnt(1)
  s_barrier
  s_waitcnt vmcnt(0)
  s_barrier
P4_qj_16:
  s_sub_u32 s17, s8, 8
  s_and_b32 s20, s17, 3
  s_lshl_b32 s18, s12, 2
  s_lshl_b32 s19, s13, 2
  s_mov_b32 s38, 14680064
  s_mov_b32 s39, 25165824
  s_cmp_ge_u32 s17, 4
  s_cselect_b32 s18, s19, s18
  s_cselect_b32 s19, s38, s39
  s_add_u32 s18, s18, s20
  s_mul_i32 s18, s18, 28672
  s_add_u32 s18, s18, s19
  s_add_u32 s20, s4, s18
  s_addc_u32 s21, s5, 0
  s_mov_b32 s22, 28672
  s_mov_b32 s23, 0x20000
  s_lshl_b32 s36, s17, 10
  s_add_u32 s24, s4, 9437184
  s_addc_u32 s25, s5, 0
  s_mov_b32 s26, 2097152
  s_mov_b32 s27, 0x20000
  v_lshrrev_b32 v6, 3, v1
  v_and_b32 v7, 7, v1
  v_lshlrev_b32 v6, 12, v6
  v_lshl_add_u32 v6, v7, 4, v6
  s_lshl_b32 s18, s13, 6
  s_lshl_b32 s19, s17, 3
  s_add_u32 s18, s18, s19
  s_lshl_b32 s18, s18, 12
  s_lshl_b32 s19, s12, 7
  s_add_u32 s18, s18, s19
  s_lshl_b32 s19, s17, 10
  s_add_u32 m0, s19, 147456
  s_nop 0
  buffer_load_dwordx4 v6, s[24:27], s18 offen sc1 lds
  s_cmp_lt_u32 s17, 4
  s_cbranch_scc1 P5_pf_79
  s_add_u32 m0, s36, 0
  s_mov_b32 s37, 0
  buffer_load_dwordx4 v2, s[20:23], s37 offen sc1 lds
  s_add_u32 m0, s36, 8192
  s_mov_b32 s37, 1024
  buffer_load_dwordx4 v2, s[20:23], s37 offen sc1 lds
  s_add_u32 m0, s36, 16384
  s_mov_b32 s37, 2048
  buffer_load_dwordx4 v2, s[20:23], s37 offen sc1 lds
  s_add_u32 m0, s36, 24576
  s_mov_b32 s37, 3072
  buffer_load_dwordx4 v2, s[20:23], s37 offen sc1 lds
  s_add_u32 m0, s36, 32768
  s_mov_b32 s37, 4096
  buffer_load_dwordx4 v2, s[20:23], s37 offen sc1 lds
  s_add_u32 m0, s36, 40960
  s_mov_b32 s37, 5120
  buffer_load_dwordx4 v2, s[20:23], s37 offen sc1 lds
  s_add_u32 m0, s36, 49152
  s_mov_b32 s37, 6144
  buffer_load_dwordx4 v2, s[20:23], s37 offen sc1 lds
  s_add_u32 m0, s36, 57344
  s_mov_b32 s37, 7168
  buffer_load_dwordx4 v2, s[20:23], s37 offen sc1 lds
P5_pf_79:
  s_barrier
P4_end:
  s_barrier
  s_cmp_lg_u32 s8, 0
  s_cbranch_scc1 GB_skip_80
  s_add_u32 s60, s4, 393216
  s_addc_u32 s61, s5, 0
  s_lshl_b32 s58, s12, 12
  v_mov_b32 v5, s58
  v_mov_b32 v6, 1
  s_mov_b64 exec, 1
  global_atomic_add v5, v6, s[60:61] sc1
  s_mov_b32 s59, 0
  s_mov_b32 s58, 8
GB_poll_81:
  s_add_u32 s59, s59, 1
  s_cmp_gt_u32 s59, 0x40000
  s_cbranch_scc1 GB_out_82
  global_load_dword v6, v5, s[60:61] sc0 sc1
  s_waitcnt vmcnt(0)
  v_cmp_gt_u32 vcc, s58, v6
  s_cbranch_vccnz GB_poll_81
GB_out_82:
  s_mov_b64 exec, -1
GB_skip_80:
  s_barrier
  s_and_b32 s9, s2, 3
  s_bfe_u32 s10, s2, 0x10002
  s_lshr_b32 s11, s2, 3
  s_and_b32 s12, s11, 7
  s_lshl_b32 s9, s9, 3
  s_add_u32 s12, s12, s9
  s_lshr_b32 s13, s11, 3
  s_lshl_b32 s10, s10, 2
  s_add_u32 s13, s13, s10
  s_cmp_ge_u32 s8, 8
  s_cbranch_scc1 P5_prod
  s_and_b32 s14, s8, 1
  s_bfe_u32 s15, s8, 0x10001
  s_lshr_b32 s16, s8, 2
  s_mov_b32 s28, s4
  s_mov_b32 s29, s5
  s_mov_b32 s30, 12288
  s_mov_b32 s31, 0x20000
  s_mov_b32 s32, s54
  s_mov_b32 s33, s55
  s_mov_b32 s34, 2097152
  s_mov_b32 s35, 0x20000
  s_lshl_b32 s18, s13, 8
  s_lshl_b32 s19, s15, 7
  s_add_u32 s18, s18, s19
  s_add_u32 s18, s18, 10240
  v_lshlrev_b32 v5, 4, v3
  buffer_load_dwordx4 v[8:11], v5, s[28:31], s18 offen sc1
  buffer_load_dwordx4 v[12:15], v5, s[28:31], s18 offen offset:64 sc1
  s_lshl_b32 s18, s16, 13
  s_lshl_b32 s19, s14, 11
  s_add_u32 s19, s19, s18
  v_add_u32 v16, s19, v2
  s_lshl_b32 s19, s15, 11
  s_add_u32 s19, s19, s18
  s_add_u32 s19, s19, 4096
  v_add_u32 v17, s19, v2
  s_barrier
  v_add_u32 v18, 0, v16
  v_add_u32 v19, 0, v17
  ds_read_b128 v[72:75], v18 offset:0
  ds_read_b128 v[76:79], v18 offset:1024
  ds_read_b128 v[80:83], v19 offset:0
  ds_read_b128 v[84:87], v19 offset:1024
  v_add_u32 v20, 16384, v16
  v_add_u32 v21, 16384, v17
  ds_read_b128 v[88:91], v20 offset:0
  ds_read_b128 v[92:95], v20 offset:1024
  ds_read_b128 v[96:99], v21 offset:0
  ds_read_b128 v[100:103], v21 offset:1024
  s_waitcnt lgkmcnt(4)
  s_barrier
  v_mfma_f32_16x16x32_bf16 v[32:35], v[80:83], v[72:75], 0
  v_add_u32 v18, 32768, v16
  v_add_u32 v19, 32768, v17
  v_mfma_f32_16x16x32_bf16 v[40:43], v[80:83], v[76:79], 0
  ds_read_b128 v[104:107], v18 offset:0
  ds_read_b128 v[108:111], v18 offset:1024
  v_mfma_f32_16x16x32_bf16 v[36:39], v[84:87], v[72:75], 0
  ds_read_b128 v[112:115], v19 offset:0
  ds_read_b128 v[116:119], v19 offset:1024
  v_mfma_f32_16x16x32_bf16 v[44:47], v[84:87], v[76:79], 0
  s_waitcnt lgkmcnt(4)
  s_barrier
  v_mfma_f32_16x16x32_bf16 v[32:35], v[96:99], v[88:91], v[32:35]
  v_add_u32 v20, 49152, v16
  v_add_u32 v21, 49152, v17
  v_mfma_f32_16x16x32_bf16 v[40:43], v[96:99], v[92:95], v[40:43]
  ds_read_b128 v[72:75], v20 offset:0
  ds_read_b128 v[76:79], v20 offset:1024
  v_mfma_f32_16x16x32_bf16 v[36:39], v[100:103], v[88:91], v[36:39]
  ds_read_b128 v[80:83], v21 offset:0
  ds_read_b128 v[84:87], v21 offset:1024
  v_mfma_f32_16x16x32_bf16 v[44:47], v[100:103], v[92:95], v[44:47]
  s_waitcnt lgkmcnt(4)
  s_barrier
  v_mfma_f32_16x16x32_bf16 v[32:35], v[112:115], v[104:107], v[32:35]
  v_add_u32 v18, 65536, v16
  v_add_u32 v19, 65536, v17
  v_mfma_f32_16x16x32_bf16 v[40:43], v[112:115], v[108:111], v[40:43]
  ds_read_b128 v[88:91], v18 offset:0
  ds_read_b128 v[92:95], v18 offset:1024
  v_mfma_f32_16x16x32_bf16 v[36:39], v[116:119], v[104:107], v[36:39]
  ds_read_b128 v[96:99], v19 offset:0
  ds_read_b128 v[100:103], v19 offset:1024
  v_mfma_f32_16x16x32_bf16 v[44:47], v[116:119], v[108:111], v[44:47]
  s_waitcnt lgkmcnt(4)
  s_barrier
  v_mfma_f32_16x16x32_bf16 v[32:35], v[80:83], v[72:75], v[32:35]
  v_add_u32 v20, 81920, v16
  v_add_u32 v21, 81920, v17
  v_mfma_f32_16x16x32_bf16 v[40:43], v[80:83], v[76:79], v[40:43]
  ds_read_b128 v[104:107], v20 offset:0
  ds_read_b128 v[108:111], v20 offset:1024
  v_mfma_f32_16x16x32_bf16 v[36:39], v[84:87], v[72:75], v[36:39]
  ds_read_b128 v[112:115], v21 offset:0
  ds_read_b128 v[116:119], v21 offset:1024
  v_mfma_f32_16x16x32_bf16 v[44:47], v[84:87], v[76:79], v[44:47]
  s_waitcnt lgkmcnt(4)
  s_barrier
  v_mfma_f32_16x16x32_bf16 v[32:35], v[96:99], v[88:91], v[32:35]
  v_add_u32 v18, 98304, v16
  v_add_u32 v19, 98304, v17
  v_mfma_f32_16x16x32_bf16 v[40:43], v[96:99], v[92:95], v[40:43]
  ds_read_b128 v[72:75], v18 offset:0
  ds_read_b128 v[76:79], v18 offset:1024
  v_mfma_f32_16x16x32_bf16 v[36:39], v[100:103], v[88:91], v[36:39]
  ds_read_b128 v[80:83], v19 offset:0
  ds_read_b128 v[84:87], v19 offset:1024
  v_mfma_f32_16x16x32_bf16 v[44:47], v[100:103], v[92:95], v[44:47]
  s_waitcnt lgkmcnt(4)
  s_barrier
  v_mfma_f32_16x16x32_bf16 v[32:35], v[112:115], v[104:107], v[32:35]
  v_add_u32 v20, 114688, v16
  v_add_u32 v21, 114688, v17
  v_mfma_f32_16x16x32_bf16 v[40:43], v[112:115], v[108:111], v[40:43]
  ds_read_b128 v[88:91], v20 offset:0
  ds_read_b128 v[92:95], v20 offset:1024
  v_mfma_f32_16x16x32_bf16 v[36:39], v[116:119], v[104:107], v[36:39]
  ds_read_b128 v[96:99], v21 offset:0
  ds_read_b128 v[100:103], v21 offset:1024
  v_mfma_f32_16x16x32_bf16 v[44:47], v[116:119], v[108:111], v[44:47]
  s_waitcnt lgkmcnt(4)
  s_barrier
  v_mfma_f32_16x16x32_bf16 v[32:35], v[80:83], v[72:75], v[32:35]
  v_add_u32 v18, 131072, v16
  v_add_u32 v19, 131072, v17
  v_mfma_f32_16x16x32_bf16 v[40:43], v[80:83], v[76:79], v[40:43]
  ds_read_b128 v[104:107], v18 offset:0
  ds_read_b128 v[108:111], v18 offset:1024
  v_mfma_f32_16x16x32_bf16 v[36:39], v[84:87], v[72:75], v[36:39]
  ds_read_b128 v[112:115], v19 offset:0
  ds_read_b128 v[116:119], v19 offset:1024
  v_mfma_f32_16x16x32_bf16 v[44:47], v[84:87], v[76:79], v[44:47]
  s_waitcnt lgkmcnt(4)
  s_barrier
  v_mfma_f32_16x16x32_bf16 v[32:35], v[96:99], v[88:91], v[32:35]
  v_add_u32 v20, 0, v16
  v_add_u32 v21, 0, v17
  v_mfma_f32_16x16x32_bf16 v[40:43], v[96:99], v[92:95], v[40:43]
  ds_read_b128 v[72:75], v20 offset:0
  ds_read_b128 v[76:79], v20 offset:1024
  v_mfma_f32_16x16x32_bf16 v[36:39], v[100:103], v[88:91], v[36:39]
  ds_read_b128 v[80:83], v21 offset:0
  ds_read_b128 v[84:87], v21 offset:1024
  v_mfma_f32_16x16x32_bf16 v[44:47], v[100:103], v[92:95], v[44:47]
  s_waitcnt lgkmcnt(4)
  s_barrier
  v_mfma_f32_16x16x32_bf16 v[32:35], v[112:115], v[104:107], v[32:35]
  v_add_u32 v18, 16384, v16
  v_add_u32 v19, 16384, v17
  v_mfma_f32_16x16x32_bf16 v[40:43], v[112:115], v[108:111], v[40:43]
  ds_read_b128 v[88:91], v18 offset:0
  ds_read_b128 v[92:95], v18 offset:1024
  v_mfma_f32_16x16x32_bf16 v[36:39], v[116:119], v[104:107], v[36:39]
  ds_read_b128 v[96:99], v19 offset:0
  ds_read_b128 v[100:103], v19 offset:1024
  v_mfma_f32_16x16x32_bf16 v[44:47], v[116:119], v[108:111], v[44:47]
  s_waitcnt lgkmcnt(4)
  s_barrier
  v_mfma_f32_16x16x32_bf16 v[32:35], v[80:83], v[72:75], v[32:35]
  v_add_u32 v20, 32768, v16
  v_add_u32 v21, 32768, v17
  v_mfma_f32_16x16x32_bf16 v[40:43], v[80:83], v[76:79], v[40:43]
  ds_read_b128 v[104:107], v20 offset:0
  ds_read_b128 v[108:111], v20 offset:1024
  v_mfma_f32_16x16x32_bf16 v[36:39], v[84:87], v[72:75], v[36:39]
  ds_read_b128 v[112:115], v21 offset:0
  ds_read_b128 v[116:119], v21 offset:1024
  v_mfma_f32_16x16x32_bf16 v[44:47], v[84:87], v[76:79], v[44:47]
  s_waitcnt lgkmcnt(4)
  s_barrier
  v_mfma_f32_16x16x32_bf16 v[32:35], v[96:99], v[88:91], v[32:35]
  v_add_u32 v18, 49152, v16
  v_add_u32 v19, 49152, v17
  v_mfma_f32_16x16x32_bf16 v[40:43], v[96:99], v[92:95], v[40:43]
  ds_read_b128 v[72:75], v18 offset:0
  ds_read_b128 v[76:79], v18 offset:1024
  v_mfma_f32_16x16x32_bf16 v[36:39], v[100:103], v[88:91], v[36:39]
  ds_read_b128 v[80:83], v19 offset:0
  ds_read_b128 v[84:87], v19 offset:1024
  v_mfma_f32_16x16x32_bf16 v[44:47], v[100:103], v[92:95], v[44:47]
  s_waitcnt lgkmcnt(4)
  s_barrier
  v_mfma_f32_16x16x32_bf16 v[32:35], v[112:115], v[104:107], v[32:35]
  v_add_u32 v20, 65536, v16
  v_add_u32 v21, 65536, v17
  v_mfma_f32_16x16x32_bf16 v[40:43], v[112:115], v[108:111], v[40:43]
  ds_read_b128 v[88:91], v20 offset:0
  ds_read_b128 v[92:95], v20 offset:1024
  v_mfma_f32_16x16x32_bf16 v[36:39], v[116:119], v[104:107], v[36:39]
  ds_read_b128 v[96:99], v21 offset:0
  ds_read_b128 v[100:103], v21 offset:1024
  v_mfma_f32_16x16x32_bf16 v[44:47], v[116:119], v[108:111], v[44:47]
  s_waitcnt lgkmcnt(4)
  v_mfma_f32_16x16x32_bf16 v[32:35], v[80:83], v[72:75], v[32:35]
  v_mfma_f32_16x16x32_bf16 v[40:43], v[80:83], v[76:79], v[40:43]
  v_mfma_f32_16x16x32_bf16 v[36:39], v[84:87], v[72:75], v[36:39]
  v_mfma_f32_16x16x32_bf16 v[44:47], v[84:87], v[76:79], v[44:47]
  s_waitcnt lgkmcnt(0)
  v_mfma_f32_16x16x32_bf16 v[32:35], v[96:99], v[88:91], v[32:35]
  v_mfma_f32_16x16x32_bf16 v[40:43], v[96:99], v[92:95], v[40:43]
  v_mfma_f32_16x16x32_bf16 v[36:39], v[100:103], v[88:91], v[36:39]
  v_mfma_f32_16x16x32_bf16 v[44:47], v[100:103], v[92:95], v[44:47]
  s_nop 7
  s_lshl_b32 s18, s8, 11
  s_add_u32 s18, s18, 98304
  v_add_u32 v5, s18, v2
  s_xor_b32 s18, s8, 4
  s_lshl_b32 s18, s18, 11
  s_add_u32 s18, s18, 98304
  v_add_u32 v6, s18, v2
  s_cmp_eq_u32 s16, 1
  s_cbranch_scc1 P5_k1_83
  ds_write_b128 v5, v[40:43] offset:0
  ds_write_b128 v5, v[44:47] offset:1024
  s_branch P5_k2_84
P5_k1_83:
  ds_write_b128 v5, v[32:35] offset:0
  ds_write_b128 v5, v[36:39] offset:1024
  v_mov_b32 v32, v40
  v_mov_b32 v33, v41
  v_mov_b32 v34, v42
  v_mov_b32 v35, v43
  v_mov_b32 v36, v44
  v_mov_b32 v37, v45
  v_mov_b32 v38, v46
  v_mov_b32 v39, v47
P5_k2_84:
  v_bfe_u32 v7, v1, 2, 2
  v_lshl_add_u32 v7, v3, 2, v7
  v_lshlrev_b32 v7, 7, v7
  v_and_b32 v18, 3, v1
  v_lshl_add_u32 v7, v18, 3, v7
  s_lshl_b32 s18, s15, 12
  s_lshl_b32 s19, s14, 6
  s_add_u32 s18, s18, s19
  s_lshl_b32 s19, s16, 5
  s_add_u32 s18, s18, s19
  s_add_u32 s18, s18, 147456
  v_add_u32 v7, s18, v7
  ds_read_b64_tr_b16 v[56:57], v7 offset:0
  ds_read_b64_tr_b16 v[58:59], v7 offset:2048
  s_waitcnt vmcnt(0) lgkmcnt(0)
  s_barrier
  ds_read_b128 v[48:51], v6 offset:0
  ds_read_b128 v[52:55], v6 offset:1024
  s_waitcnt lgkmcnt(0)
  v_add_f32 v32, v32, v48
  v_add_f32 v33, v33, v49
  v_add_f32 v34, v34, v50
  v_add_f32 v35, v35, v51
  v_lshlrev_b32 v60, 16, v56
  v_and_b32 v61, 0xffff0000, v56
  v_lshlrev_b32 v62, 16, v57
  v_and_b32 v63, 0xffff0000, v57
  v_fma_f32 v32, v32, v8, v60
  v_fma_f32 v33, v33, v9, v61
  v_fma_f32 v34, v34, v10, v62
  v_fma_f32 v35, v35, v11, v63
  v_cvt_pk_bf16_f32 v64, v32, v33
  v_cvt_pk_bf16_f32 v65, v34, v35
  v_add_f32 v36, v36, v52
  v_add_f32 v37, v37, v53
  v_add_f32 v38, v38, v54
  v_add_f32 v39, v39, v55
  v_lshlrev_b32 v60, 16, v58
  v_and_b32 v61, 0xffff0000, v58
  v_lshlrev_b32 v62, 16, v59
  v_and_b32 v63, 0xffff0000, v59
  v_fma_f32 v36, v36, v12, v60
  v_fma_f32 v37, v37, v13, v61
  v_fma_f32 v38, v38, v14, v62
  v_fma_f32 v39, v39, v15, v63
  v_cvt_pk_bf16_f32 v66, v36, v37
  v_cvt_pk_bf16_f32 v67, v38, v39
  s_lshl_b32 s18, s14, 5
  s_lshl_b32 s19, s16, 4
  s_add_u32 s18, s18, s19
  v_add_u32 v5, s18, v4
  v_mul_u32_u24 v5, 144, v5
  v_lshl_add_u32 v5, v3, 3, v5
  s_lshl_b32 s18, s15, 6
  s_add_u32 s18, s18, 114688
  v_add_u32 v5, s18, v5
  ds_write_b64 v5, v[64:65] offset:0
  ds_write_b64 v5, v[66:67] offset:32
  s_waitcnt lgkmcnt(0)
  s_barrier
  v_lshrrev_b32 v6, 3, v1
  s_lshl_b32 s18, s8, 3
  v_add_u32 v6, s18, v6
  v_and_b32 v7, 7, v1
  v_mul_u32_u24 v5, 144, v6
  v_lshl_add_u32 v5, v7, 4, v5
  v_add_u32 v5, 114688, v5
  ds_read_b128 v[68:71], v5
  v_lshlrev_b32 v6, 10, v6
  v_lshl_add_u32 v6, v7, 4, v6
  s_lshl_b32 s18, s12, 16
  s_lshl_b32 s19, s13, 7
  s_add_u32 s18, s18, s19
  s_waitcnt lgkmcnt(0)
  buffer_store_dwordx4 v[68:71], v6, s[32:35], s18 offen
  s_endpgm
P5_prod:
  s_sub_u32 s17, s8, 8
  s_and_b32 s20, s17, 3
  s_lshl_b32 s18, s12, 2
  s_lshl_b32 s19, s13, 2
  s_mov_b32 s38, 14680064
  s_mov_b32 s39, 25165824
  s_cmp_ge_u32 s17, 4
  s_cselect_b32 s18, s19, s18
  s_cselect_b32 s19, s38, s39
  s_add_u32 s18, s18, s20
  s_mul_i32 s18, s18, 28672
  s_add_u32 s18, s18, s19
  s_add_u32 s20, s4, s18
  s_addc_u32 s21, s5, 0
  s_mov_b32 s22, 28672
  s_mov_b32 s23, 0x20000
  s_lshl_b32 s36, s17, 10
  s_cmp_ge_u32 s17, 4
  s_cbranch_scc1 P5_pp_85
  s_add_u32 m0, s36, 0
  s_mov_b32 s37, 0
  buffer_load_dwordx4 v2, s[20:23], s37 offen sc1 lds
  s_add_u32 m0, s36, 8192
  s_mov_b32 s37, 1024
  buffer_load_dwordx4 v2, s[20:23], s37 offen sc1 lds
  s_add_u32 m0, s36, 16384
  s_mov_b32 s37, 2048
  buffer_load_dwordx4 v2, s[20:23], s37 offen sc1 lds
  s_add_u32 m0, s36, 24576
  s_mov_b32 s37, 3072
  buffer_load_dwordx4 v2, s[20:23], s37 offen sc1 lds
  s_add_u32 m0, s36, 32768
  s_mov_b32 s37, 4096
  buffer_load_dwordx4 v2, s[20:23], s37 offen sc1 lds
  s_add_u32 m0, s36, 40960
  s_mov_b32 s37, 5120
  buffer_load_dwordx4 v2, s[20:23], s37 offen sc1 lds
  s_add_u32 m0, s36, 49152
  s_mov_b32 s37, 6144
  buffer_load_dwordx4 v2, s[20:23], s37 offen sc1 lds
  s_add_u32 m0, s36, 57344
  s_mov_b32 s37, 7168
  buffer_load_dwordx4 v2, s[20:23], s37 offen sc1 lds
P5_pp_85:
  s_waitcnt vmcnt(4)
  s_barrier
  s_add_u32 m0, s36, 65536
  s_mov_b32 s37, 8192
  buffer_load_dwordx4 v2, s[20:23], s37 offen sc1 lds
  s_add_u32 m0, s36, 73728
  s_mov_b32 s37, 9216
  buffer_load_dwordx4 v2, s[20:23], s37 offen sc1 lds
  s_add_u32 m0, s36, 81920
  s_mov_b32 s37, 10240
  buffer_load_dwordx4 v2, s[20:23], s37 offen sc1 lds
  s_add_u32 m0, s36, 90112
  s_mov_b32 s37, 11264
  buffer_load_dwordx4 v2, s[20:23], s37 offen sc1 lds
  s_add_u32 m0, s36, 98304
  s_mov_b32 s37, 12288
  buffer_load_dwordx4 v2, s[20:23], s37 offen sc1 lds
  s_add_u32 m0, s36, 106496
  s_mov_b32 s37, 13312
  buffer_load_dwordx4 v2, s[20:23], s37 offen sc1 lds
  s_add_u32 m0, s36, 114688
  s_mov_b32 s37, 14336
  buffer_load_dwordx4 v2, s[20:23], s37 offen sc1 lds
  s_add_u32 m0, s36, 122880
  s_mov_b32 s37, 15360
  buffer_load_dwordx4 v2, s[20:23], s37 offen sc1 lds
  s_add_u32 m0, s36, 131072
  s_mov_b32 s37, 16384
  buffer_load_dwordx4 v2, s[20:23], s37 offen sc1 lds
  s_add_u32 m0, s36, 139264
  s_mov_b32 s37, 17408
  buffer_load_dwordx4 v2, s[20:23], s37 offen sc1 lds
  s_waitcnt vmcnt(12)
  s_barrier
  s_add_u32 m0, s36, 0
  s_mov_b32 s37, 18432
  buffer_load_dwordx4 v2, s[20:23], s37 offen sc1 lds
  s_add_u32 m0, s36, 8192
  s_mov_b32 s37, 19456
  buffer_load_dwordx4 v2, s[20:23], s37 offen sc1 lds
  s_waitcnt vmcnt(12)
  s_barrier
  s_add_u32 m0, s36, 16384
  s_mov_b32 s37, 20480
  buffer_load_dwordx4 v2, s[20:23], s37 offen sc1 lds
  s_add_u32 m0, s36, 24576
  s_mov_b32 s37, 21504
  buffer_load_dwordx4 v2, s[20:23], s37 offen sc1 lds
  s_waitcnt vmcnt(12)
  s_barrier
  s_add_u32 m0, s36, 32768
  s_mov_b32 s37, 22528
  buffer_load_dwordx4 v2, s[20:23], s37 offen sc1 lds
  s_add_u32 m0, s36, 40960
  s_mov_b32 s37, 23552
  buffer_load_dwordx4 v2, s[20:23], s37 offen sc1 lds
  s_waitcnt vmcnt(12)
  s_barrier
  s_add_u32 m0, s36, 49152
  s_mov_b32 s37, 24576
  buffer_load_dwordx4 v2, s[20:23], s37 offen sc1 lds
  s_add_u32 m0, s36, 57344
  s_mov_b32 s37, 25600
  buffer_load_dwordx4 v2, s[20:23], s37 offen sc1 lds
  s_waitcnt vmcnt(12)
  s_barrier
  s_add_u32 m0, s36, 65536
  s_mov_b32 s37, 26624
  buffer_load_dwordx4 v2, s[20:23], s37 offen sc1 lds
  s_add_u32 m0, s36, 73728
  s_mov_b32 s37, 27648
  buffer_load_dwordx4 v2, s[20:23], s37 offen sc1 lds
  s_waitcnt vmcnt(12)
  s_barrier
  s_waitcnt vmcnt(10)
  s_barrier
  s_waitcnt vmcnt(8)
  s_barrier
  s_waitcnt vmcnt(6)
  s_barrier
  s_waitcnt vmcnt(4)
  s_barrier
  s_waitcnt vmcnt(2)
  s_barrier
  s_waitcnt vmcnt(0)
  s_barrier
  s_endpgm
CODE_END:
  s_endpgm

.section .rodata,"a"
.p2align 6
.amdhsa_kernel k1_prep_kernel
  .amdhsa_next_free_vgpr 96
  .amdhsa_next_free_sgpr 56
  .amdhsa_accum_offset 96
  .amdhsa_group_segment_fixed_size 0
  .amdhsa_kernarg_size 152
  .amdhsa_user_sgpr_count 2
  .amdhsa_user_sgpr_kernarg_segment_ptr 1
  .amdhsa_system_sgpr_workgroup_id_x 1
.end_amdhsa_kernel
.p2align 6
.amdhsa_kernel k2_conv_kernel
  .amdhsa_next_free_vgpr 128
  .amdhsa_next_free_sgpr 64
  .amdhsa_accum_offset 128
  .amdhsa_group_segment_fixed_size 0
  .amdhsa_kernarg_size 152
  .amdhsa_user_sgpr_count 2
  .amdhsa_user_sgpr_kernarg_segment_ptr 1
  .amdhsa_system_sgpr_workgroup_id_x 1
.end_amdhsa_kernel
.p2align 6
.amdhsa_kernel k3_mega_kernel
  .amdhsa_next_free_vgpr 128
  .amdhsa_next_free_sgpr 64
  .amdhsa_accum_offset 128
  .amdhsa_group_segment_fixed_size 0
  .amdhsa_kernarg_size 152
  .amdhsa_user_sgpr_count 2
  .amdhsa_user_sgpr_kernarg_segment_ptr 1
  .amdhsa_system_sgpr_workgroup_id_x 1
.end_amdhsa_kernel
```
